```python
import torch

def _softmax(x, axis=-1):
    return torch.softmax(x, dim=axis)
def _gelu(x):
    return torch.nn.functional.gelu(x, approximate="tanh")
def _silu(x):
    return torch.nn.functional.silu(x)
def _sigmoid(x):
    return torch.sigmoid(x)
def _layernorm(x, axis=-1, eps=1e-5):
    m = x.mean(dim=axis, keepdim=True)
    v = x.var(dim=axis, keepdim=True, unbiased=False)
    return (x - m) / torch.sqrt(v + eps)
def _scatter_add(tgt, idx, src, axis=0):
    return tgt.clone().index_add_(axis, idx, src)
def _segment_sum(src, seg, n):
    out = torch.zeros((n,) + src.shape[1:], dtype=src.dtype)
    return out.index_add_(0, seg, src)
def _pad(x, pw):
    flat = tuple(v for pair in reversed(pw) for v in pair)
    return torch.nn.functional.pad(x, flat)

kernel_name = 'gated_mix__softmax_full_mha__dense_activation_squared_relu__prompt'

def setup_inputs():

    _w = (lambda a: (lambda t: t.to(torch.bfloat16) if t.is_floating_point() else t)(torch.as_tensor(a)))
    def _A_setup():
        B, S, D = 1, 2048, 640
        return {
            "x": _w((lambda *s: torch.randn(*s, dtype=torch.bfloat16) * 0.05)(B, S, D)),
            "wqkv": _w((lambda *s: torch.randn(*s, dtype=torch.bfloat16) * 0.8)(D, 3 * D)),
            "wo": _w((lambda *s: torch.randn(*s, dtype=torch.bfloat16) * 0.1)(D, D)),
        }
    _A_in = _A_setup()

    def _B_setup():
        B, S, D, F = 1, 2048, 640, 1536
        return {
            "x": _w((lambda *s: torch.randn(*s, dtype=torch.bfloat16) * 0.05)(B, S, D)),
            "w1": _w((lambda *s: torch.randn(*s, dtype=torch.bfloat16) * 0.1)(D, F)),
            "b1": _w((lambda *s: torch.randn(*s, dtype=torch.bfloat16) * 0.1)(F)),
            "w2": _w((lambda *s: torch.randn(*s, dtype=torch.bfloat16) * 0.1)(F, D)),
            "b2": _w((lambda *s: torch.randn(*s, dtype=torch.bfloat16) * 0.05)(D)),
        }
    _B_in = _B_setup()

    return {
        "A_x": _A_in["x"],
        "A_wqkv": _A_in["wqkv"],
        "A_wo": _A_in["wo"],
        "B_x": _B_in["x"],
        "B_w1": _B_in["w1"],
        "B_b1": _B_in["b1"],
        "B_w2": _B_in["w2"],
        "B_b2": _B_in["b2"],
        "gate_w": _w((lambda *s: torch.randn(*s, dtype=torch.bfloat16) * 0.05)(640) * 16.0),
    }

def reference(A_x, A_wqkv, A_wo, B_x, B_w1, B_b1, B_w2, B_b2, gate_w):
    def _A_ref(x, wqkv, wo):
        B, S, D = x.shape
        H = 32; Dh = D // H
        qkv = (lambda x, *d: x.permute(*d))((x @ wqkv).reshape(B, S, 3, H, Dh), 2, 0, 3, 1, 4)
        q, k, v = qkv[0], qkv[1], qkv[2]
        scale = Dh ** -0.5
        scores = torch.einsum("bhqd,bhkd->bhqk", q, k) * scale
        p = _softmax(scores, axis=-1)
        o = torch.einsum("bhqk,bhkd->bhqd", p, v)
        return (lambda x, *d: x.permute(*d))(o, 0, 2, 1, 3).reshape(B, S, D) @ wo

    def _B_ref(x, w1, b1, w2, b2):
        h = torch.einsum("bsd,df->bsf", x, w1) + b1
        zero = torch.zeros_like(h)
        r = torch.where(h > zero, h, zero)
        h = r * r
        out = torch.einsum("bsf,fd->bsd", h, w2) + b2
        return out

    x = A_x
    g = _sigmoid((x * gate_w).sum(-1, keepdims=True))
    a = _A_ref(x, A_wqkv, A_wo)
    b = _B_ref(x, B_w1, B_b1, B_w2, B_b2)
    return g * a + (1 - g) * b
```

```asm
; @launch grid=(256,1,1) block=(512,1,1) lds=163840
.amdgcn_target "amdgcn-amd-amdhsa--gfx950"
.text
.globl gated_mix__softmax_full_mha__dense_activation_squared_relu__prompt_kernel
.p2align 8
.type gated_mix__softmax_full_mha__dense_activation_squared_relu__prompt_kernel,@function
gated_mix__softmax_full_mha__dense_activation_squared_relu__prompt_kernel:
    s_cmp_ge_u32 s2, 256
    s_cbranch_scc1 L_exit
    s_load_dwordx16 s[68:83], s[0:1], 0
    s_load_dwordx8 s[84:91], s[0:1], 64
    s_getpc_b64 s[66:67]
L_here:
    s_lshr_b32 s52, s2, 3
    s_lshl_b32 s52, s52, 11
    v_lshrrev_b32 v1, 5, v0
    v_lshlrev_b32 v1, 7, v1
    v_add_u32 v1, s52, v1
    v_min_u32 v1, L_exit-L_here, v1
    global_load_dword v251, v1, s[66:67]
    v_lshrrev_b32 v1, 6, v0
    s_and_b32 s61, s2, 7
    v_readfirstlane_b32 s48, v1
    s_lshr_b32 s62, s2, 3
    s_and_b32 s62, s62, 7
    s_lshr_b32 s63, s2, 6
    v_and_b32 v0, 63, v0
    s_mov_b32 s96, 0
    s_and_b32 s49, s61, 1
    s_lshl_b32 s49, s49, 3
    s_add_u32 s49, s49, s62
    s_lshr_b32 s50, s61, 1
    s_lshl_b32 s50, s50, 2
    s_add_u32 s50, s50, s63
    s_lshl_b32 s57, s48, 12
    s_mul_i32 s58, s49, 163840
    s_lshl_b32 s59, s50, 8
    v_lshrrev_b32 v32, 3, v0
    s_lshl_b32 s51, s48, 4
    v_add_u32 v32, s51, v32
    v_mul_u32_u24 v32, 1280, v32
    v_and_b32 v33, 7, v0
    v_lshrrev_b32 v34, 4, v0
    v_xor_b32 v33, v33, v34
    v_lshl_add_u32 v1, v33, 4, v32
    v_xor_b32 v33, 4, v33
    v_lshl_add_u32 v2, v33, 4, v32
    v_add_u32 v2, 9216, v2
    s_lshl_b32 s51, s48, 3
    v_add_u32 v32, s51, v34
    v_mul_u32_u24 v32, 3840, v32
    s_and_b32 s51, s48, 1
    s_lshl_b32 s51, s51, 2
    v_or_b32 v33, s51, v34
    v_bfe_u32 v35, v0, 1, 3
    v_xor_b32 v33, v33, v35
    v_lshlrev_b32 v33, 5, v33
    v_and_b32 v35, 1, v0
    v_lshl_add_u32 v33, v35, 4, v33
    v_add_u32 v3, v32, v33
    v_add_u32 v4, 14336, v3
    v_mov_b32 v244, 0
    v_lshlrev_b32 v36, 4, v0
    v_lshlrev_b32 v37, 2, v0
    s_waitcnt lgkmcnt(0)
    s_mov_b32 s8, s68
    s_mov_b32 s9, s69
    s_mov_b32 s10, 2621440
    s_mov_b32 s11, 0x00020000
    s_mov_b32 s12, s70
    s_mov_b32 s13, s71
    s_mov_b32 s14, 2457600
    s_mov_b32 s15, 0x00020000
    s_mov_b32 s28, s84
    s_mov_b32 s29, s85
    s_mov_b32 s30, 1280
    s_mov_b32 s31, 0x00020000
    s_mov_b32 s16, s76
    s_mov_b32 s17, s77
    s_mov_b32 s18, 1966080
    s_mov_b32 s19, 0x00020000
    s_mov_b32 s20, s90
    s_mov_b32 s21, s91
    s_mov_b32 s22, 19668992
    s_mov_b32 s23, 0x00020000
    s_mov_b32 s24, s86
    s_mov_b32 s25, s87
    s_mov_b32 s26, 2621440
    s_mov_b32 s27, 0x00020000
    s_mov_b32 s92, s88
    s_mov_b32 s93, s89
    s_mov_b32 s94, 256
    s_mov_b32 s95, 0x00020000
    s_mov_b64 s[36:37], s[72:73]
    s_mov_b64 s[38:39], s[78:79]
    s_mov_b64 s[40:41], s[80:81]
    s_mov_b64 s[42:43], s[82:83]
    s_mul_i32 s88, s62, 3
    s_mul_i32 s51, s63, 8
    s_add_u32 s88, s88, s51
    s_lshr_b32 s51, s61, 1
    s_mul_i32 s51, s51, 2
    s_add_u32 s88, s88, s51
    s_and_b32 s51, s61, 1
    s_mul_i32 s51, s51, 20
    s_add_u32 s88, s88, s51
    s_lshr_b32 s88, s88, 2
    s_mul_i32 s51, s88, 205
    s_lshr_b32 s51, s51, 11
    s_mul_i32 s51, s51, 10
    s_sub_u32 s88, s88, s51
    s_mov_b32 s90, s88
    s_lshr_b32 s89, s48, 2
    s_add_u32 s89, s89, s88
    s_sub_u32 s51, s89, 10
    s_min_u32 s89, s89, s51
    s_add_u32 m0, s57, 0
    s_lshl_b32 s78, s88, 7
    s_add_u32 s78, s78, s58
    buffer_load_dwordx4 v1, s[8:11], s78 offen lds
    buffer_load_dwordx4 v2, s[8:11], s78 offen offset:1024 lds
    s_add_u32 m0, s57, 2048
    s_mul_i32 s78, s88, 245760
    s_add_u32 s78, s78, s59
    buffer_load_dwordx4 v3, s[12:15], s78 offen lds
    s_add_u32 s88, s88, 1
    s_cmp_eq_u32 s88, 10
    s_cselect_b32 s88, 0, s88
    buffer_load_dwordx4 v4, s[12:15], s78 offen offset:1024 lds
    s_lshr_b32 s51, s2, 3
    s_lshl_b32 s51, s51, 3
    s_add_u32 s51, s51, s48
    s_lshr_b32 s53, s61, 1
    s_mul_i32 s52, s51, 9216
    s_mul_i32 s53, s53, 768
    s_add_u32 s52, s52, s53
    v_lshrrev_b32 v32, 3, v0
    v_min_u32 v32, 2, v32
    v_mul_u32_u24 v32, 3072, v32
    v_and_b32 v33, 7, v0
    v_min_u32 v33, 5, v33
    v_lshl_add_u32 v250, v33, 7, v32
    v_add_u32 v250, s52, v250
    s_cmp_lg_u32 s48, 0
    s_cbranch_scc1 L_w0_1
    v_lshlrev_b32 v38, 15, v0
    v_mov_b32 v39, 0
    s_lshl_b32 s51, s2, 7
    s_add_u32 s51, s51, 19570688
    s_mov_b64 exec, 3
    buffer_store_dword v39, v38, s[20:23], s51 offen sc1
    s_mov_b64 exec, -1
L_w0_1:
    v_mov_b32 v38, 163832
    v_mov_b32 v39, 0
    ds_write_b32 v38, v39
    s_mul_i32 s79, s48, 3072
    s_mul_i32 s80, s50, 192
    s_and_b32 s51, s48, 3
    s_lshl_b32 s51, s51, 13
    v_bfe_u32 v32, v0, 3, 1
    v_lshlrev_b32 v32, 10, v32
    v_and_b32 v33, 7, v0
    v_lshl_add_u32 v32, v33, 7, v32
    v_add_u32 v32, s51, v32
    v_lshrrev_b32 v33, 4, v0
    v_bfe_u32 v34, v0, 1, 3
    v_xor_b32 v34, v33, v34
    v_lshl_add_u32 v8, v34, 4, v32
    v_xor_b32 v9, 64, v8
    v_bfe_u32 v34, v0, 2, 2
    v_lshlrev_b32 v32, 12, v33
    v_lshl_add_u32 v32, v34, 8, v32
    v_and_b32 v35, 3, v0
    v_lshl_add_u32 v32, v35, 3, v32
    v_bfe_u32 v38, v0, 4, 1
    v_lshl_add_u32 v39, v38, 2, v34
    s_lshr_b32 s51, s48, 2
    s_lshl_b32 s52, s51, 2
    v_xor_b32 v39, s52, v39
    v_xor_b32 v10, 0, v39
    v_lshl_add_u32 v10, v10, 5, v32
    v_xor_b32 v11, 1, v39
    v_lshl_add_u32 v11, v11, 5, v32
    v_xor_b32 v12, 2, v39
    v_lshl_add_u32 v12, v12, 5, v32
    v_xor_b32 v13, 3, v39
    v_lshl_add_u32 v13, v13, 5, v32
    v_lshrrev_b32 v32, 5, v0
    v_lshlrev_b32 v32, 4, v32
    v_lshl_add_u32 v32, v38, 2, v32
    v_add_u32 v32, v32, v34
    v_mul_u32_u24 v32, 192, v32
    v_lshl_add_u32 v32, v35, 3, v32
    v_add_u32 v32, 0x10000, v32
    s_mul_i32 s52, s51, 3
    s_add_u32 s53, s52, 0
    v_xor_b32 v14, s53, v38
    v_lshl_add_u32 v14, v14, 5, v32
    s_add_u32 s53, s52, 1
    v_xor_b32 v15, s53, v38
    v_lshl_add_u32 v15, v15, 5, v32
    s_add_u32 s53, s52, 2
    v_xor_b32 v16, s53, v38
    v_lshl_add_u32 v16, v16, 5, v32
    s_mov_b32 s64, s38
    s_mov_b32 s65, s39
    s_mov_b32 s66, 3072
    s_mov_b32 s67, 0x00020000
    s_lshr_b32 s51, s48, 2
    s_mul_i32 s53, s51, 96
    s_add_u32 s52, s80, s53
    v_lshrrev_b32 v33, 4, v0
    v_lshlrev_b32 v33, 3, v33
    buffer_load_dwordx2 v[18:19], v33, s[64:67], s52 offen offset:0
    buffer_load_dwordx2 v[20:21], v33, s[64:67], s52 offen offset:32
    buffer_load_dwordx2 v[22:23], v33, s[64:67], s52 offen offset:64
    v_add_u32 v32, 0, v0
    v_mul_u32_u24 v33, 5462, v32
    v_lshrrev_b32 v33, 16, v33
    v_mul_u32_u24 v34, 12, v33
    v_sub_u32 v34, v32, v34
    v_bfe_u32 v35, v33, 2, 1
    v_bfe_u32 v38, v33, 3, 1
    v_and_b32 v39, 3, v33
    v_lshl_add_u32 v39, v35, 3, v39
    v_lshl_add_u32 v39, v38, 2, v39
    s_and_b32 s51, s48, 3
    s_lshl_b32 s51, s51, 4
    v_add_u32 v39, s51, v39
    v_mul_u32_u24 v39, 3072, v39
    v_lshlrev_b32 v35, 1, v35
    v_xor_b32 v34, v34, v35
    v_lshl_add_u32 v5, v34, 4, v39
    v_add_u32 v32, 64, v0
    v_mul_u32_u24 v33, 5462, v32
    v_lshrrev_b32 v33, 16, v33
    v_mul_u32_u24 v34, 12, v33
    v_sub_u32 v34, v32, v34
    v_bfe_u32 v35, v33, 2, 1
    v_bfe_u32 v38, v33, 3, 1
    v_and_b32 v39, 3, v33
    v_lshl_add_u32 v39, v35, 3, v39
    v_lshl_add_u32 v39, v38, 2, v39
    s_and_b32 s51, s48, 3
    s_lshl_b32 s51, s51, 4
    v_add_u32 v39, s51, v39
    v_mul_u32_u24 v39, 3072, v39
    v_lshlrev_b32 v35, 1, v35
    v_xor_b32 v34, v34, v35
    v_lshl_add_u32 v6, v34, 4, v39
    v_subrev_u32 v6, 1024, v6
    v_add_u32 v32, 128, v0
    v_mul_u32_u24 v33, 5462, v32
    v_lshrrev_b32 v33, 16, v33
    v_mul_u32_u24 v34, 12, v33
    v_sub_u32 v34, v32, v34
    v_bfe_u32 v35, v33, 2, 1
    v_bfe_u32 v38, v33, 3, 1
    v_and_b32 v39, 3, v33
    v_lshl_add_u32 v39, v35, 3, v39
    v_lshl_add_u32 v39, v38, 2, v39
    s_and_b32 s51, s48, 3
    s_lshl_b32 s51, s51, 4
    v_add_u32 v39, s51, v39
    v_mul_u32_u24 v39, 3072, v39
    v_lshlrev_b32 v35, 1, v35
    v_xor_b32 v34, v34, v35
    v_lshl_add_u32 v7, v34, 4, v39
    v_subrev_u32 v7, 2048, v7
    s_waitcnt lgkmcnt(0)
    s_lshl_b32 s68, s61, 2
    s_add_u32 s68, s68, s63
    s_mov_b32 s69, s62
    s_lshr_b32 s72, s48, 1
    s_lshl_b32 s72, s72, 9
    s_mul_i32 s51, s48, 1280
    s_add_u32 s72, s72, s51
    s_mul_i32 s70, s68, 163840
    s_add_u32 s70, s70, s51
    s_add_u32 s70, s70, 2621440
    s_lshr_b32 s71, s48, 2
    s_mov_b64 s[46:47], -1
    s_lshl_b32 s91, s69, 1
    s_lshl_b32 s52, s69, 3
    s_add_u32 s52, s52, s48
    s_mul_i32 s52, s52, 1280
    s_mul_i32 s97, s68, 81920
    s_add_u32 s97, s97, s52
    s_lshl_b32 s73, s61, 2
    s_add_u32 s73, s73, s63
    s_mov_b32 s74, s62
    s_and_b32 s51, s48, 1
    s_lshr_b32 s52, s48, 1
    s_mul_i32 s52, s52, 17
    s_mul_i32 s75, s74, 68
    s_add_u32 s75, s75, s52
    s_add_u32 s75, s75, s51
    s_mul_i32 s75, s75, 5120
    s_add_u32 s75, s75, 16777216
    s_lshl_b32 s76, s73, 1
    s_add_u32 s76, s76, s51
    s_mul_i32 s76, s76, 139264
    s_lshl_b32 s52, s52, 10
    s_add_u32 s76, s76, s52
    s_add_u32 s76, s76, 7864320
    s_mul_i32 s77, s48, 5120
    s_and_b32 s51, s48, 3
    s_lshl_b32 s51, s51, 1
    s_lshl_b32 s52, s69, 3
    s_add_u32 s51, s51, s52
    s_add_u32 s51, s51, s71
    s_lshl_b32 s6, s51, 7
    s_add_u32 s6, s6, 19562496
    s_mul_i32 s51, s51, 139264
    s_add_u32 s51, s51, 7876608
    s_lshr_b32 s52, s68, 1
    s_mul_i32 s53, s52, 52
    s_lshr_b32 s53, s53, 8
    s_mul_i32 s53, s53, 12
    s_add_u32 s52, s52, s53
    s_lshl_b32 s52, s52, 10
    s_add_u32 s4, s51, s52
    s_and_b32 s52, s68, 1
    s_lshl_b32 s52, s52, 9
    s_add_u32 s4, s4, s52
    s_lshr_b32 s52, s68, 3
    s_add_u32 s52, s52, 16
    s_mul_i32 s53, s52, 52
    s_lshr_b32 s53, s53, 8
    s_mul_i32 s53, s53, 12
    s_add_u32 s52, s52, s53
    s_lshl_b32 s52, s52, 10
    s_add_u32 s5, s51, s52
    s_and_b32 s52, s68, 1
    s_lshl_b32 s52, s52, 3
    s_add_u32 s5, s5, s52
    s_bfe_u32 s52, s68, 0x20001
    s_lshl_b32 s52, s52, 8
    s_add_u32 s5, s5, s52
    s_mov_b32 s54, s2
    s_lshr_b32 s55, s54, 2
    s_and_b32 s56, s54, 3
    s_mul_i32 s82, s56, 320
    s_cmp_ge_u32 s55, 48
    s_cselect_b32 s32, s36, s40
    s_cselect_b32 s33, s37, s41
    s_mov_b32 s34, 1966080
    s_cselect_b32 s34, 819200, s34
    s_mov_b32 s35, 0x00020000
    s_lshl_b32 s51, s55, 5
    s_mul_i32 s52, s55, 40
    s_sub_u32 s52, s52, 1920
    s_cmp_ge_u32 s55, 48
    s_cselect_b32 s51, s52, s51
    s_cselect_b32 s53, 20, 16
    s_mul_i32 s52, s55, 160
    s_sub_u32 s52, s52, 10224
    s_cmp_ge_u32 s55, 64
    s_cselect_b32 s51, s52, s51
    s_cselect_b32 s53, 80, s53
    s_cselect_b32 s52, 20, 4
    s_lshl_b32 s83, s48, 6
    v_add_u32 v228, s83, v0
    v_mul_u32_u24 v229, 3277, v228
    v_lshrrev_b32 v229, 16, v229
    v_mul_u32_u24 v230, 20, v229
    v_sub_u32 v230, v228, v230
    v_and_b32 v228, 3, v229
    v_bfe_u32 v231, v229, 2, 2
    v_mad_u32_u24 v228, v231, s52, v228
    v_lshrrev_b32 v231, 4, v229
    v_mad_u32_u24 v228, v231, s53, v228
    v_add_u32 v228, s51, v228
    v_mul_u32_u24 v228, 1280, v228
    v_lshl_add_u32 v28, v230, 4, v228
    v_add_u32 v228, s83, v0
    v_add_u32 v228, 512, v228
    v_mul_u32_u24 v229, 3277, v228
    v_lshrrev_b32 v229, 16, v229
    v_mul_u32_u24 v230, 20, v229
    v_sub_u32 v230, v228, v230
    v_and_b32 v228, 3, v229
    v_bfe_u32 v231, v229, 2, 2
    v_mad_u32_u24 v228, v231, s52, v228
    v_lshrrev_b32 v231, 4, v229
    v_mad_u32_u24 v228, v231, s53, v228
    v_add_u32 v228, s51, v228
    v_mul_u32_u24 v228, 1280, v228
    v_lshl_add_u32 v29, v230, 4, v228
    s_mul_i32 s51, s55, 43
    s_lshr_b32 s51, s51, 9
    s_mul_i32 s51, s51, 5
    s_add_u32 s51, s51, s55
    s_sub_u32 s52, s55, 48
    s_mul_i32 s53, s52, 52
    s_lshr_b32 s53, s53, 8
    s_mul_i32 s53, s53, 12
    s_add_u32 s52, s52, s53
    s_add_u32 s52, s52, 12
    s_cmp_ge_u32 s55, 48
    s_cselect_b32 s55, s52, s51
    s_mul_i32 s56, s56, 136
    s_add_u32 s55, s55, s56
    v_lshrrev_b32 v229, 4, v0
    v_bfe_u32 v230, v0, 2, 2
    v_lshl_add_u32 v229, v229, 3, v230
    v_mul_u32_u24 v229, 320, v229
    v_and_b32 v228, 3, v0
    s_add_u32 s51, s48, 0
    s_cmp_ge_u32 s51, 5
    s_cselect_b32 s52, 1, 0
    s_mul_i32 s53, s52, 5
    s_sub_u32 s51, s51, s53
    s_lshr_b32 s53, s51, 1
    s_lshl_b32 s53, s53, 6
    s_and_b32 s56, s51, 1
    s_lshl_b32 s56, s56, 3
    s_add_u32 s53, s53, s56
    s_mul_i32 s56, s52, 160
    s_add_u32 s53, s53, s56
    s_add_u32 s53, s53, 92160
    s_cmp_eq_u32 s51, 4
    s_cselect_b32 s56, 3, 4
    v_lshlrev_b32 v230, s56, v228
    v_add3_u32 v30, v230, v229, s53
    s_mul_i32 s52, s52, 68
    s_add_u32 s52, s52, s55
    s_mul_i32 s52, s52, 5120
    s_lshl_b32 s51, s51, 10
    s_add_u32 s52, s52, s51
    s_add_u32 s83, s52, 16777216
    s_add_u32 s51, s48, 8
    s_cmp_ge_u32 s51, 5
    s_cselect_b32 s52, 1, 0
    s_mul_i32 s53, s52, 5
    s_sub_u32 s51, s51, s53
    s_lshr_b32 s53, s51, 1
    s_lshl_b32 s53, s53, 6
    s_and_b32 s56, s51, 1
    s_lshl_b32 s56, s56, 3
    s_add_u32 s53, s53, s56
    s_mul_i32 s56, s52, 160
    s_add_u32 s53, s53, s56
    s_add_u32 s53, s53, 92160
    s_cmp_eq_u32 s51, 4
    s_cselect_b32 s56, 3, 4
    v_lshlrev_b32 v230, s56, v228
    v_add3_u32 v31, v230, v229, s53
    s_mul_i32 s52, s52, 68
    s_add_u32 s52, s52, s55
    s_mul_i32 s52, s52, 5120
    s_lshl_b32 s51, s51, 10
    s_add_u32 s52, s52, s51
    s_add_u32 s84, s52, 16777216
    s_cmp_ge_u32 s50, 10
    s_cbranch_scc1 L_epv_2
    s_and_b32 s52, s48, 3
    s_lshl_b32 s54, s49, 2
    s_add_u32 s54, s52, s54
    s_cmp_ge_u32 s50, 5
    s_cselect_b32 s51, 5, 0
    s_cselect_b32 s60, 1.0, 0x3ea52b5c
    s_cselect_b32 s52, 1, 0
    s_cselect_b32 s53, 2621440, 0
    s_lshl_b32 s55, 81920, s52
    s_lshl_b32 s56, 1280, s52
    s_mul_i32 s81, s56, s54
    s_add_u32 s81, s81, s53
    s_sub_u32 s51, s50, s51
    s_lshl_b32 s51, s51, 5
    s_lshr_b32 s52, s48, 2
    s_lshl_b32 s52, s52, 4
    s_add_u32 s51, s51, s52
    v_and_b32 v239, 9, v0
    v_bfe_u32 v236, v0, 1, 1
    v_lshl_add_u32 v239, v236, 2, v239
    v_bfe_u32 v236, v0, 2, 1
    v_lshl_add_u32 v239, v236, 1, v239
    v_lshlrev_b32 v239, 4, v239
    v_lshrrev_b32 v236, 4, v0
    v_add_u32 v236, s51, v236
    s_mov_b32 s54, 0x43120
    v_add_u32 v237, 0, v236
    v_mul_u32_u24 v238, 205, v237
    v_lshrrev_b32 v238, 10, v238
    v_mul_u32_u24 v24, 5, v238
    v_sub_u32 v237, v237, v24
    v_lshlrev_b32 v237, 2, v237
    v_bfe_u32 v237, s54, v237, 4
    v_mul_lo_u32 v24, v238, s55
    v_lshl_add_u32 v24, v237, 8, v24
    v_add_u32 v24, v24, v239
    v_add_u32 v237, 4, v236
    v_mul_u32_u24 v238, 205, v237
    v_lshrrev_b32 v238, 10, v238
    v_mul_u32_u24 v25, 5, v238
    v_sub_u32 v237, v237, v25
    v_lshlrev_b32 v237, 2, v237
    v_bfe_u32 v237, s54, v237, 4
    v_mul_lo_u32 v25, v238, s55
    v_lshl_add_u32 v25, v237, 8, v25
    v_add_u32 v25, v25, v239
    v_add_u32 v237, 8, v236
    v_mul_u32_u24 v238, 205, v237
    v_lshrrev_b32 v238, 10, v238
    v_mul_u32_u24 v26, 5, v238
    v_sub_u32 v237, v237, v26
    v_lshlrev_b32 v237, 2, v237
    v_bfe_u32 v237, s54, v237, 4
    v_mul_lo_u32 v26, v238, s55
    v_lshl_add_u32 v26, v237, 8, v26
    v_add_u32 v26, v26, v239
    v_add_u32 v237, 12, v236
    v_mul_u32_u24 v238, 205, v237
    v_lshrrev_b32 v238, 10, v238
    v_mul_u32_u24 v27, 5, v238
    v_sub_u32 v237, v237, v27
    v_lshlrev_b32 v237, 2, v237
    v_bfe_u32 v237, s54, v237, 4
    v_mul_lo_u32 v27, v238, s55
    v_lshl_add_u32 v27, v237, 8, v27
    v_add_u32 v27, v27, v239
    s_branch L_epe_3
L_epv_2:
    s_and_b32 s52, s48, 3
    s_lshl_b32 s54, s49, 2
    s_add_u32 s54, s52, s54
    s_sub_u32 s51, s50, 10
    s_lshl_b32 s51, s51, 7
    s_lshr_b32 s52, s48, 2
    s_lshl_b32 s52, s52, 6
    s_add_u32 s51, s51, s52
    s_mul_i32 s81, s54, 2560
    s_add_u32 s81, s81, 2622720
    s_mov_b32 s55, 163840
    v_lshrrev_b32 v239, 4, v0
    v_mul_u32_u24 v239, 320, v239
    v_and_b32 v236, 15, v0
    v_add_u32 v236, s51, v236
    v_add_u32 v237, 0, v236
    v_mul_u32_u24 v238, 3277, v237
    v_lshrrev_b32 v238, 16, v238
    v_mul_u32_u24 v24, 20, v238
    v_sub_u32 v237, v237, v24
    v_mul_lo_u32 v24, v238, s55
    v_and_b32 v238, 0x13, v237
    v_bfe_u32 v240, v237, 2, 1
    v_lshl_add_u32 v238, v240, 3, v238
    v_bfe_u32 v240, v237, 3, 1
    v_lshl_add_u32 v238, v240, 2, v238
    v_lshl_add_u32 v24, v238, 4, v24
    v_add_u32 v24, v24, v239
    v_add_u32 v237, 16, v236
    v_mul_u32_u24 v238, 3277, v237
    v_lshrrev_b32 v238, 16, v238
    v_mul_u32_u24 v25, 20, v238
    v_sub_u32 v237, v237, v25
    v_mul_lo_u32 v25, v238, s55
    v_and_b32 v238, 0x13, v237
    v_bfe_u32 v240, v237, 2, 1
    v_lshl_add_u32 v238, v240, 3, v238
    v_bfe_u32 v240, v237, 3, 1
    v_lshl_add_u32 v238, v240, 2, v238
    v_lshl_add_u32 v25, v238, 4, v25
    v_add_u32 v25, v25, v239
    v_add_u32 v237, 32, v236
    v_mul_u32_u24 v238, 3277, v237
    v_lshrrev_b32 v238, 16, v238
    v_mul_u32_u24 v26, 20, v238
    v_sub_u32 v237, v237, v26
    v_mul_lo_u32 v26, v238, s55
    v_and_b32 v238, 0x13, v237
    v_bfe_u32 v240, v237, 2, 1
    v_lshl_add_u32 v238, v240, 3, v238
    v_bfe_u32 v240, v237, 3, 1
    v_lshl_add_u32 v238, v240, 2, v238
    v_lshl_add_u32 v26, v238, 4, v26
    v_add_u32 v26, v26, v239
    v_add_u32 v237, 48, v236
    v_mul_u32_u24 v238, 3277, v237
    v_lshrrev_b32 v238, 16, v238
    v_mul_u32_u24 v27, 20, v238
    v_sub_u32 v237, v237, v27
    v_mul_lo_u32 v27, v238, s55
    v_and_b32 v238, 0x13, v237
    v_bfe_u32 v240, v237, 2, 1
    v_lshl_add_u32 v238, v240, 3, v238
    v_bfe_u32 v240, v237, 3, 1
    v_lshl_add_u32 v238, v240, 2, v238
    v_lshl_add_u32 v27, v238, 4, v27
    v_add_u32 v27, v27, v239
L_epe_3:
    s_add_u32 m0, s57, 32768
    s_lshl_b32 s78, s88, 7
    s_add_u32 s78, s78, s58
    buffer_load_dwordx4 v1, s[8:11], s78 offen lds
    buffer_load_dwordx4 v2, s[8:11], s78 offen offset:1024 lds
    s_add_u32 m0, s57, 34816
    s_mul_i32 s78, s88, 245760
    s_add_u32 s78, s78, s59
    buffer_load_dwordx4 v3, s[12:15], s78 offen lds
    s_add_u32 s88, s88, 1
    s_cmp_eq_u32 s88, 10
    s_cselect_b32 s88, 0, s88
    buffer_load_dwordx4 v4, s[12:15], s78 offen offset:1024 lds
    s_cmp_eq_u32 s50, 15
    s_cbranch_scc1 L_xpass_5
    s_cmp_ge_u32 s50, 10
    s_cbranch_scc1 L_vpass_4
    s_cmp_eq_u32 s48, 0
    s_cbranch_scc1 L_wv_7
    s_waitcnt vmcnt(7)
L_wv_7:
    s_waitcnt vmcnt(8)
    s_barrier
    ds_read_b128 v[96:99], v8 offset:0
    ds_read_b128 v[100:103], v8 offset:4096
    ds_read_b64_tr_b16 v[32:33], v10 offset:2048
    ds_read_b64_tr_b16 v[34:35], v10 offset:3072
    ds_read_b64_tr_b16 v[36:37], v11 offset:2048
    ds_read_b64_tr_b16 v[38:39], v11 offset:3072
    s_add_u32 m0, s57, 65536
    s_lshl_b32 s78, s88, 7
    s_add_u32 s78, s78, s58
    buffer_load_dwordx4 v1, s[8:11], s78 offen lds
    ds_read_b64_tr_b16 v[40:41], v12 offset:2048
    ds_read_b64_tr_b16 v[42:43], v12 offset:3072
    buffer_load_dwordx4 v2, s[8:11], s78 offen offset:1024 lds
    ds_read_b64_tr_b16 v[44:45], v13 offset:2048
    ds_read_b64_tr_b16 v[46:47], v13 offset:3072
    s_add_u32 m0, s57, 67584
    s_mul_i32 s78, s88, 245760
    s_add_u32 s78, s78, s59
    buffer_load_dwordx4 v3, s[12:15], s78 offen lds
    s_add_u32 s88, s88, 1
    s_cmp_eq_u32 s88, 10
    s_cselect_b32 s88, 0, s88
    buffer_load_dwordx4 v4, s[12:15], s78 offen offset:1024 lds
    ds_read_b128 v[104:107], v9 offset:0
    ds_read_b128 v[108:111], v9 offset:4096
    s_waitcnt lgkmcnt(8)
    v_mfma_f32_16x16x32_bf16 v[64:67], v[32:35], v[96:99], 0
    ds_read_b64_tr_b16 v[48:49], v10 offset:18432
    v_mfma_f32_16x16x32_bf16 v[80:83], v[32:35], v[100:103], 0
    ds_read_b64_tr_b16 v[50:51], v10 offset:19456
    s_waitcnt lgkmcnt(8)
    v_mfma_f32_16x16x32_bf16 v[68:71], v[36:39], v[96:99], 0
    ds_read_b64_tr_b16 v[52:53], v11 offset:18432
    v_mfma_f32_16x16x32_bf16 v[84:87], v[36:39], v[100:103], 0
    ds_read_b64_tr_b16 v[54:55], v11 offset:19456
    s_waitcnt lgkmcnt(8)
    v_mfma_f32_16x16x32_bf16 v[72:75], v[40:43], v[96:99], 0
    ds_read_b64_tr_b16 v[56:57], v12 offset:18432
    v_mfma_f32_16x16x32_bf16 v[88:91], v[40:43], v[100:103], 0
    ds_read_b64_tr_b16 v[58:59], v12 offset:19456
    s_waitcnt lgkmcnt(8)
    v_mfma_f32_16x16x32_bf16 v[76:79], v[44:47], v[96:99], 0
    ds_read_b64_tr_b16 v[60:61], v13 offset:18432
    v_mfma_f32_16x16x32_bf16 v[92:95], v[44:47], v[100:103], 0
    ds_read_b64_tr_b16 v[62:63], v13 offset:19456
    s_waitcnt vmcnt(4)
    s_barrier
    ds_read_b128 v[112:115], v8 offset:32768
    ds_read_b128 v[116:119], v8 offset:36864
    s_waitcnt lgkmcnt(8)
    v_mfma_f32_16x16x32_bf16 v[64:67], v[48:51], v[104:107], v[64:67]
    ds_read_b64_tr_b16 v[32:33], v10 offset:34816
    v_mfma_f32_16x16x32_bf16 v[80:83], v[48:51], v[108:111], v[80:83]
    ds_read_b64_tr_b16 v[34:35], v10 offset:35840
    s_waitcnt lgkmcnt(8)
    v_mfma_f32_16x16x32_bf16 v[68:71], v[52:55], v[104:107], v[68:71]
    ds_read_b64_tr_b16 v[36:37], v11 offset:34816
    v_mfma_f32_16x16x32_bf16 v[84:87], v[52:55], v[108:111], v[84:87]
    ds_read_b64_tr_b16 v[38:39], v11 offset:35840
    s_add_u32 m0, s57, 98304
    s_lshl_b32 s78, s88, 7
    s_add_u32 s78, s78, s58
    buffer_load_dwordx4 v1, s[8:11], s78 offen lds
    s_waitcnt lgkmcnt(8)
    v_mfma_f32_16x16x32_bf16 v[72:75], v[56:59], v[104:107], v[72:75]
    ds_read_b64_tr_b16 v[40:41], v12 offset:34816
    v_mfma_f32_16x16x32_bf16 v[88:91], v[56:59], v[108:111], v[88:91]
    ds_read_b64_tr_b16 v[42:43], v12 offset:35840
    buffer_load_dwordx4 v2, s[8:11], s78 offen offset:1024 lds
    s_waitcnt lgkmcnt(8)
    v_mfma_f32_16x16x32_bf16 v[76:79], v[60:63], v[104:107], v[76:79]
    ds_read_b64_tr_b16 v[44:45], v13 offset:34816
    v_mfma_f32_16x16x32_bf16 v[92:95], v[60:63], v[108:111], v[92:95]
    ds_read_b64_tr_b16 v[46:47], v13 offset:35840
    s_add_u32 m0, s57, 100352
    s_mul_i32 s78, s88, 245760
    s_add_u32 s78, s78, s59
    buffer_load_dwordx4 v3, s[12:15], s78 offen lds
    ds_read_b128 v[120:123], v9 offset:32768
    ds_read_b128 v[124:127], v9 offset:36864
    v_xor_b32 v8, 0x10000, v8
    v_xor_b32 v9, 0x10000, v9
    s_waitcnt lgkmcnt(8)
    v_mfma_f32_16x16x32_bf16 v[64:67], v[32:35], v[112:115], v[64:67]
    ds_read_b64_tr_b16 v[48:49], v10 offset:51200
    v_mfma_f32_16x16x32_bf16 v[80:83], v[32:35], v[116:119], v[80:83]
    ds_read_b64_tr_b16 v[50:51], v10 offset:52224
    v_xor_b32 v10, 0x10000, v10
    s_waitcnt lgkmcnt(8)
    v_mfma_f32_16x16x32_bf16 v[68:71], v[36:39], v[112:115], v[68:71]
    ds_read_b64_tr_b16 v[52:53], v11 offset:51200
    v_mfma_f32_16x16x32_bf16 v[84:87], v[36:39], v[116:119], v[84:87]
    ds_read_b64_tr_b16 v[54:55], v11 offset:52224
    v_xor_b32 v11, 0x10000, v11
    s_add_u32 s88, s88, 1
    s_cmp_eq_u32 s88, 10
    s_cselect_b32 s88, 0, s88
    buffer_load_dwordx4 v4, s[12:15], s78 offen offset:1024 lds
    s_waitcnt lgkmcnt(8)
    v_mfma_f32_16x16x32_bf16 v[72:75], v[40:43], v[112:115], v[72:75]
    ds_read_b64_tr_b16 v[56:57], v12 offset:51200
    v_mfma_f32_16x16x32_bf16 v[88:91], v[40:43], v[116:119], v[88:91]
    ds_read_b64_tr_b16 v[58:59], v12 offset:52224
    v_xor_b32 v12, 0x10000, v12
    s_cmp_lg_u32 s48, 0
    s_cbranch_scc1 L_w0_9
    s_and_b32 s51, s2, 31
    s_lshl_b32 s51, s51, 2
    s_add_u32 s51, s51, 128
    v_mov_b32 v246, s51
    v_mov_b32 v247, 1
    s_mov_b64 exec, 1
    buffer_atomic_add v247, v246, s[92:95], 0 offen sc1
    s_mov_b64 exec, -1
L_w0_9:
    s_waitcnt lgkmcnt(8)
    v_mfma_f32_16x16x32_bf16 v[76:79], v[44:47], v[112:115], v[76:79]
    ds_read_b64_tr_b16 v[60:61], v13 offset:51200
    v_mfma_f32_16x16x32_bf16 v[92:95], v[44:47], v[116:119], v[92:95]
    ds_read_b64_tr_b16 v[62:63], v13 offset:52224
    v_xor_b32 v13, 0x10000, v13
    s_cmp_eq_u32 s48, 0
    s_cbranch_scc1 L_wv_10
    s_waitcnt vmcnt(4)
L_wv_10:
    s_waitcnt vmcnt(5)
    s_barrier
    ds_read_b128 v[128:131], v8 offset:0
    ds_read_b128 v[132:135], v8 offset:4096
    s_waitcnt lgkmcnt(8)
    v_mfma_f32_16x16x32_bf16 v[64:67], v[48:51], v[120:123], v[64:67]
    ds_read_b64_tr_b16 v[32:33], v10 offset:2048
    v_mfma_f32_16x16x32_bf16 v[80:83], v[48:51], v[124:127], v[80:83]
    ds_read_b64_tr_b16 v[34:35], v10 offset:3072
    s_waitcnt lgkmcnt(8)
    v_mfma_f32_16x16x32_bf16 v[68:71], v[52:55], v[120:123], v[68:71]
    ds_read_b64_tr_b16 v[36:37], v11 offset:2048
    v_mfma_f32_16x16x32_bf16 v[84:87], v[52:55], v[124:127], v[84:87]
    ds_read_b64_tr_b16 v[38:39], v11 offset:3072
    s_add_u32 m0, s57, 0
    s_lshl_b32 s78, s88, 7
    s_add_u32 s78, s78, s58
    buffer_load_dwordx4 v1, s[8:11], s78 offen lds
    s_waitcnt lgkmcnt(8)
    v_mfma_f32_16x16x32_bf16 v[72:75], v[56:59], v[120:123], v[72:75]
    ds_read_b64_tr_b16 v[40:41], v12 offset:2048
    v_mfma_f32_16x16x32_bf16 v[88:91], v[56:59], v[124:127], v[88:91]
    ds_read_b64_tr_b16 v[42:43], v12 offset:3072
    buffer_load_dwordx4 v2, s[8:11], s78 offen offset:1024 lds
    s_waitcnt lgkmcnt(8)
    v_mfma_f32_16x16x32_bf16 v[76:79], v[60:63], v[120:123], v[76:79]
    ds_read_b64_tr_b16 v[44:45], v13 offset:2048
    v_mfma_f32_16x16x32_bf16 v[92:95], v[60:63], v[124:127], v[92:95]
    ds_read_b64_tr_b16 v[46:47], v13 offset:3072
    s_add_u32 m0, s57, 2048
    s_mul_i32 s78, s88, 245760
    s_add_u32 s78, s78, s59
    buffer_load_dwordx4 v3, s[12:15], s78 offen lds
    ds_read_b128 v[136:139], v9 offset:0
    ds_read_b128 v[140:143], v9 offset:4096
    s_waitcnt lgkmcnt(8)
    v_mfma_f32_16x16x32_bf16 v[64:67], v[32:35], v[128:131], v[64:67]
    ds_read_b64_tr_b16 v[48:49], v10 offset:18432
    v_mfma_f32_16x16x32_bf16 v[80:83], v[32:35], v[132:135], v[80:83]
    ds_read_b64_tr_b16 v[50:51], v10 offset:19456
    s_waitcnt lgkmcnt(8)
    v_mfma_f32_16x16x32_bf16 v[68:71], v[36:39], v[128:131], v[68:71]
    ds_read_b64_tr_b16 v[52:53], v11 offset:18432
    v_mfma_f32_16x16x32_bf16 v[84:87], v[36:39], v[132:135], v[84:87]
    ds_read_b64_tr_b16 v[54:55], v11 offset:19456
    s_add_u32 s88, s88, 1
    s_cmp_eq_u32 s88, 10
    s_cselect_b32 s88, 0, s88
    buffer_load_dwordx4 v4, s[12:15], s78 offen offset:1024 lds
    s_waitcnt lgkmcnt(8)
    v_mfma_f32_16x16x32_bf16 v[72:75], v[40:43], v[128:131], v[72:75]
    ds_read_b64_tr_b16 v[56:57], v12 offset:18432
    v_mfma_f32_16x16x32_bf16 v[88:91], v[40:43], v[132:135], v[88:91]
    ds_read_b64_tr_b16 v[58:59], v12 offset:19456
    s_waitcnt lgkmcnt(8)
    v_mfma_f32_16x16x32_bf16 v[76:79], v[44:47], v[128:131], v[76:79]
    ds_read_b64_tr_b16 v[60:61], v13 offset:18432
    v_mfma_f32_16x16x32_bf16 v[92:95], v[44:47], v[132:135], v[92:95]
    ds_read_b64_tr_b16 v[62:63], v13 offset:19456
    s_cmp_eq_u32 s48, 0
    s_cbranch_scc1 L_wv_12
    s_waitcnt vmcnt(4)
L_wv_12:
    s_waitcnt vmcnt(5)
    s_barrier
    ds_read_b128 v[144:147], v8 offset:32768
    ds_read_b128 v[148:151], v8 offset:36864
    s_waitcnt lgkmcnt(8)
    v_mfma_f32_16x16x32_bf16 v[64:67], v[48:51], v[136:139], v[64:67]
    ds_read_b64_tr_b16 v[32:33], v10 offset:34816
    v_mfma_f32_16x16x32_bf16 v[80:83], v[48:51], v[140:143], v[80:83]
    ds_read_b64_tr_b16 v[34:35], v10 offset:35840
    s_waitcnt lgkmcnt(8)
    v_mfma_f32_16x16x32_bf16 v[68:71], v[52:55], v[136:139], v[68:71]
    ds_read_b64_tr_b16 v[36:37], v11 offset:34816
    v_mfma_f32_16x16x32_bf16 v[84:87], v[52:55], v[140:143], v[84:87]
    ds_read_b64_tr_b16 v[38:39], v11 offset:35840
    s_add_u32 m0, s57, 32768
    s_lshl_b32 s78, s88, 7
    s_add_u32 s78, s78, s58
    buffer_load_dwordx4 v1, s[8:11], s78 offen lds
    s_waitcnt lgkmcnt(8)
    v_mfma_f32_16x16x32_bf16 v[72:75], v[56:59], v[136:139], v[72:75]
    ds_read_b64_tr_b16 v[40:41], v12 offset:34816
    v_mfma_f32_16x16x32_bf16 v[88:91], v[56:59], v[140:143], v[88:91]
    ds_read_b64_tr_b16 v[42:43], v12 offset:35840
    buffer_load_dwordx4 v2, s[8:11], s78 offen offset:1024 lds
    s_waitcnt lgkmcnt(8)
    v_mfma_f32_16x16x32_bf16 v[76:79], v[60:63], v[136:139], v[76:79]
    ds_read_b64_tr_b16 v[44:45], v13 offset:34816
    v_mfma_f32_16x16x32_bf16 v[92:95], v[60:63], v[140:143], v[92:95]
    ds_read_b64_tr_b16 v[46:47], v13 offset:35840
    s_add_u32 m0, s57, 34816
    s_mul_i32 s78, s88, 245760
    s_add_u32 s78, s78, s59
    buffer_load_dwordx4 v3, s[12:15], s78 offen lds
    ds_read_b128 v[152:155], v9 offset:32768
    ds_read_b128 v[156:159], v9 offset:36864
    v_xor_b32 v8, 0x10000, v8
    v_xor_b32 v9, 0x10000, v9
    s_waitcnt lgkmcnt(8)
    v_mfma_f32_16x16x32_bf16 v[64:67], v[32:35], v[144:147], v[64:67]
    ds_read_b64_tr_b16 v[48:49], v10 offset:51200
    v_mfma_f32_16x16x32_bf16 v[80:83], v[32:35], v[148:151], v[80:83]
    ds_read_b64_tr_b16 v[50:51], v10 offset:52224
    v_xor_b32 v10, 0x10000, v10
    s_waitcnt lgkmcnt(8)
    v_mfma_f32_16x16x32_bf16 v[68:71], v[36:39], v[144:147], v[68:71]
    ds_read_b64_tr_b16 v[52:53], v11 offset:51200
    v_mfma_f32_16x16x32_bf16 v[84:87], v[36:39], v[148:151], v[84:87]
    ds_read_b64_tr_b16 v[54:55], v11 offset:52224
    v_xor_b32 v11, 0x10000, v11
    s_add_u32 s88, s88, 1
    s_cmp_eq_u32 s88, 10
    s_cselect_b32 s88, 0, s88
    buffer_load_dwordx4 v4, s[12:15], s78 offen offset:1024 lds
    s_waitcnt lgkmcnt(8)
    v_mfma_f32_16x16x32_bf16 v[72:75], v[40:43], v[144:147], v[72:75]
    ds_read_b64_tr_b16 v[56:57], v12 offset:51200
    v_mfma_f32_16x16x32_bf16 v[88:91], v[40:43], v[148:151], v[88:91]
    ds_read_b64_tr_b16 v[58:59], v12 offset:52224
    v_xor_b32 v12, 0x10000, v12
    s_waitcnt lgkmcnt(8)
    v_mfma_f32_16x16x32_bf16 v[76:79], v[44:47], v[144:147], v[76:79]
    ds_read_b64_tr_b16 v[60:61], v13 offset:51200
    v_mfma_f32_16x16x32_bf16 v[92:95], v[44:47], v[148:151], v[92:95]
    ds_read_b64_tr_b16 v[62:63], v13 offset:52224
    v_xor_b32 v13, 0x10000, v13
    s_waitcnt vmcnt(4)
    s_barrier
    ds_read_b128 v[160:163], v8 offset:0
    ds_read_b128 v[164:167], v8 offset:4096
    s_waitcnt lgkmcnt(8)
    v_mfma_f32_16x16x32_bf16 v[64:67], v[48:51], v[152:155], v[64:67]
    ds_read_b64_tr_b16 v[32:33], v10 offset:2048
    v_mfma_f32_16x16x32_bf16 v[80:83], v[48:51], v[156:159], v[80:83]
    ds_read_b64_tr_b16 v[34:35], v10 offset:3072
    s_waitcnt lgkmcnt(8)
    v_mfma_f32_16x16x32_bf16 v[68:71], v[52:55], v[152:155], v[68:71]
    ds_read_b64_tr_b16 v[36:37], v11 offset:2048
    v_mfma_f32_16x16x32_bf16 v[84:87], v[52:55], v[156:159], v[84:87]
    ds_read_b64_tr_b16 v[38:39], v11 offset:3072
    s_add_u32 m0, s57, 65536
    s_lshl_b32 s78, s88, 7
    s_add_u32 s78, s78, s58
    buffer_load_dwordx4 v1, s[8:11], s78 offen lds
    s_waitcnt lgkmcnt(8)
    v_mfma_f32_16x16x32_bf16 v[72:75], v[56:59], v[152:155], v[72:75]
    ds_read_b64_tr_b16 v[40:41], v12 offset:2048
    v_mfma_f32_16x16x32_bf16 v[88:91], v[56:59], v[156:159], v[88:91]
    ds_read_b64_tr_b16 v[42:43], v12 offset:3072
    buffer_load_dwordx4 v2, s[8:11], s78 offen offset:1024 lds
    s_waitcnt lgkmcnt(8)
    v_mfma_f32_16x16x32_bf16 v[76:79], v[60:63], v[152:155], v[76:79]
    ds_read_b64_tr_b16 v[44:45], v13 offset:2048
    v_mfma_f32_16x16x32_bf16 v[92:95], v[60:63], v[156:159], v[92:95]
    ds_read_b64_tr_b16 v[46:47], v13 offset:3072
    ds_read_b128 v[168:171], v9 offset:0
    ds_read_b128 v[172:175], v9 offset:4096
    s_waitcnt lgkmcnt(8)
    v_mfma_f32_16x16x32_bf16 v[64:67], v[32:35], v[160:163], v[64:67]
    ds_read_b64_tr_b16 v[48:49], v10 offset:18432
    v_mfma_f32_16x16x32_bf16 v[80:83], v[32:35], v[164:167], v[80:83]
    ds_read_b64_tr_b16 v[50:51], v10 offset:19456
    s_waitcnt lgkmcnt(8)
    v_mfma_f32_16x16x32_bf16 v[68:71], v[36:39], v[160:163], v[68:71]
    ds_read_b64_tr_b16 v[52:53], v11 offset:18432
    v_mfma_f32_16x16x32_bf16 v[84:87], v[36:39], v[164:167], v[84:87]
    ds_read_b64_tr_b16 v[54:55], v11 offset:19456
    s_add_u32 m0, s57, 67584
    s_mul_i32 s78, s88, 245760
    s_add_u32 s78, s78, s59
    buffer_load_dwordx4 v3, s[12:15], s78 offen lds
    s_waitcnt lgkmcnt(8)
    v_mfma_f32_16x16x32_bf16 v[72:75], v[40:43], v[160:163], v[72:75]
    ds_read_b64_tr_b16 v[56:57], v12 offset:18432
    v_mfma_f32_16x16x32_bf16 v[88:91], v[40:43], v[164:167], v[88:91]
    ds_read_b64_tr_b16 v[58:59], v12 offset:19456
    s_add_u32 s88, s88, 1
    s_cmp_eq_u32 s88, 10
    s_cselect_b32 s88, 0, s88
    buffer_load_dwordx4 v4, s[12:15], s78 offen offset:1024 lds
    s_waitcnt lgkmcnt(8)
    v_mfma_f32_16x16x32_bf16 v[76:79], v[44:47], v[160:163], v[76:79]
    ds_read_b64_tr_b16 v[60:61], v13 offset:18432
    v_mfma_f32_16x16x32_bf16 v[92:95], v[44:47], v[164:167], v[92:95]
    ds_read_b64_tr_b16 v[62:63], v13 offset:19456
    buffer_load_dword v254, v250, s[16:19], 0 offen
    s_waitcnt vmcnt(5)
    s_barrier
    ds_read_b128 v[176:179], v8 offset:32768
    ds_read_b128 v[180:183], v8 offset:36864
    s_waitcnt lgkmcnt(8)
    v_mfma_f32_16x16x32_bf16 v[64:67], v[48:51], v[168:171], v[64:67]
    ds_read_b64_tr_b16 v[32:33], v10 offset:34816
    v_mfma_f32_16x16x32_bf16 v[80:83], v[48:51], v[172:175], v[80:83]
    ds_read_b64_tr_b16 v[34:35], v10 offset:35840
    s_waitcnt lgkmcnt(8)
    v_mfma_f32_16x16x32_bf16 v[68:71], v[52:55], v[168:171], v[68:71]
    ds_read_b64_tr_b16 v[36:37], v11 offset:34816
    v_mfma_f32_16x16x32_bf16 v[84:87], v[52:55], v[172:175], v[84:87]
    ds_read_b64_tr_b16 v[38:39], v11 offset:35840
    s_add_u32 m0, s57, 98304
    s_lshl_b32 s78, s88, 7
    s_add_u32 s78, s78, s58
    buffer_load_dwordx4 v1, s[8:11], s78 offen lds
    s_waitcnt lgkmcnt(8)
    v_mfma_f32_16x16x32_bf16 v[72:75], v[56:59], v[168:171], v[72:75]
    ds_read_b64_tr_b16 v[40:41], v12 offset:34816
    v_mfma_f32_16x16x32_bf16 v[88:91], v[56:59], v[172:175], v[88:91]
    ds_read_b64_tr_b16 v[42:43], v12 offset:35840
    buffer_load_dwordx4 v2, s[8:11], s78 offen offset:1024 lds
    s_waitcnt lgkmcnt(8)
    v_mfma_f32_16x16x32_bf16 v[76:79], v[60:63], v[168:171], v[76:79]
    ds_read_b64_tr_b16 v[44:45], v13 offset:34816
    v_mfma_f32_16x16x32_bf16 v[92:95], v[60:63], v[172:175], v[92:95]
    ds_read_b64_tr_b16 v[46:47], v13 offset:35840
    ds_read_b128 v[184:187], v9 offset:32768
    ds_read_b128 v[188:191], v9 offset:36864
    v_xor_b32 v8, 0x10000, v8
    v_xor_b32 v9, 0x10000, v9
    s_waitcnt lgkmcnt(8)
    v_mfma_f32_16x16x32_bf16 v[64:67], v[32:35], v[176:179], v[64:67]
    ds_read_b64_tr_b16 v[48:49], v10 offset:51200
    v_mfma_f32_16x16x32_bf16 v[80:83], v[32:35], v[180:183], v[80:83]
    ds_read_b64_tr_b16 v[50:51], v10 offset:52224
    v_xor_b32 v10, 0x10000, v10
    s_waitcnt lgkmcnt(8)
    v_mfma_f32_16x16x32_bf16 v[68:71], v[36:39], v[176:179], v[68:71]
    ds_read_b64_tr_b16 v[52:53], v11 offset:51200
    v_mfma_f32_16x16x32_bf16 v[84:87], v[36:39], v[180:183], v[84:87]
    ds_read_b64_tr_b16 v[54:55], v11 offset:52224
    v_xor_b32 v11, 0x10000, v11
    s_add_u32 m0, s57, 100352
    s_mul_i32 s78, s88, 245760
    s_add_u32 s78, s78, s59
    buffer_load_dwordx4 v3, s[12:15], s78 offen lds
    s_waitcnt lgkmcnt(8)
    v_mfma_f32_16x16x32_bf16 v[72:75], v[40:43], v[176:179], v[72:75]
    ds_read_b64_tr_b16 v[56:57], v12 offset:51200
    v_mfma_f32_16x16x32_bf16 v[88:91], v[40:43], v[180:183], v[88:91]
    ds_read_b64_tr_b16 v[58:59], v12 offset:52224
    v_xor_b32 v12, 0x10000, v12
    s_add_u32 s88, s88, 1
    s_cmp_eq_u32 s88, 10
    s_cselect_b32 s88, 0, s88
    buffer_load_dwordx4 v4, s[12:15], s78 offen offset:1024 lds
    s_waitcnt lgkmcnt(8)
    v_mfma_f32_16x16x32_bf16 v[76:79], v[44:47], v[176:179], v[76:79]
    ds_read_b64_tr_b16 v[60:61], v13 offset:51200
    v_mfma_f32_16x16x32_bf16 v[92:95], v[44:47], v[180:183], v[92:95]
    ds_read_b64_tr_b16 v[62:63], v13 offset:52224
    v_xor_b32 v13, 0x10000, v13
    s_cmp_lg_u32 s48, 0
    s_cbranch_scc1 L_w0_14
    v_lshlrev_b32 v244, 2, v0
    v_or_b32 v244, 128, v244
    buffer_load_dword v246, v244, s[92:95], 0 offen sc1
L_w0_14:
    s_cmp_eq_u32 s48, 0
    s_cbranch_scc1 L_wv_15
    s_waitcnt vmcnt(5)
L_wv_15:
    s_waitcnt vmcnt(6)
    s_barrier
    ds_read_b128 v[192:195], v8 offset:0
    ds_read_b128 v[196:199], v8 offset:4096
    s_waitcnt lgkmcnt(8)
    v_mfma_f32_16x16x32_bf16 v[64:67], v[48:51], v[184:187], v[64:67]
    ds_read_b64_tr_b16 v[32:33], v10 offset:2048
    v_mfma_f32_16x16x32_bf16 v[80:83], v[48:51], v[188:191], v[80:83]
    ds_read_b64_tr_b16 v[34:35], v10 offset:3072
    s_waitcnt lgkmcnt(8)
    v_mfma_f32_16x16x32_bf16 v[68:71], v[52:55], v[184:187], v[68:71]
    ds_read_b64_tr_b16 v[36:37], v11 offset:2048
    v_mfma_f32_16x16x32_bf16 v[84:87], v[52:55], v[188:191], v[84:87]
    ds_read_b64_tr_b16 v[38:39], v11 offset:3072
    s_add_u32 m0, s57, 0
    s_lshl_b32 s78, s88, 7
    s_add_u32 s78, s78, s58
    buffer_load_dwordx4 v1, s[8:11], s78 offen lds
    s_waitcnt lgkmcnt(8)
    v_mfma_f32_16x16x32_bf16 v[72:75], v[56:59], v[184:187], v[72:75]
    ds_read_b64_tr_b16 v[40:41], v12 offset:2048
    v_mfma_f32_16x16x32_bf16 v[88:91], v[56:59], v[188:191], v[88:91]
    ds_read_b64_tr_b16 v[42:43], v12 offset:3072
    buffer_load_dwordx4 v2, s[8:11], s78 offen offset:1024 lds
    s_waitcnt lgkmcnt(8)
    v_mfma_f32_16x16x32_bf16 v[76:79], v[60:63], v[184:187], v[76:79]
    ds_read_b64_tr_b16 v[44:45], v13 offset:2048
    v_mfma_f32_16x16x32_bf16 v[92:95], v[60:63], v[188:191], v[92:95]
    ds_read_b64_tr_b16 v[46:47], v13 offset:3072
    ds_read_b128 v[200:203], v9 offset:0
    ds_read_b128 v[204:207], v9 offset:4096
    s_waitcnt lgkmcnt(8)
    v_mfma_f32_16x16x32_bf16 v[64:67], v[32:35], v[192:195], v[64:67]
    ds_read_b64_tr_b16 v[48:49], v10 offset:18432
    v_mfma_f32_16x16x32_bf16 v[80:83], v[32:35], v[196:199], v[80:83]
    ds_read_b64_tr_b16 v[50:51], v10 offset:19456
    s_waitcnt lgkmcnt(8)
    v_mfma_f32_16x16x32_bf16 v[68:71], v[36:39], v[192:195], v[68:71]
    ds_read_b64_tr_b16 v[52:53], v11 offset:18432
    v_mfma_f32_16x16x32_bf16 v[84:87], v[36:39], v[196:199], v[84:87]
    ds_read_b64_tr_b16 v[54:55], v11 offset:19456
    s_add_u32 m0, s57, 2048
    s_mul_i32 s78, s88, 245760
    s_add_u32 s78, s78, s59
    buffer_load_dwordx4 v3, s[12:15], s78 offen lds
    s_waitcnt lgkmcnt(8)
    v_mfma_f32_16x16x32_bf16 v[72:75], v[40:43], v[192:195], v[72:75]
    ds_read_b64_tr_b16 v[56:57], v12 offset:18432
    v_mfma_f32_16x16x32_bf16 v[88:91], v[40:43], v[196:199], v[88:91]
    ds_read_b64_tr_b16 v[58:59], v12 offset:19456
    s_add_u32 s88, s88, 1
    s_cmp_eq_u32 s88, 10
    s_cselect_b32 s88, 0, s88
    buffer_load_dwordx4 v4, s[12:15], s78 offen offset:1024 lds
    s_waitcnt lgkmcnt(8)
    v_mfma_f32_16x16x32_bf16 v[76:79], v[44:47], v[192:195], v[76:79]
    ds_read_b64_tr_b16 v[60:61], v13 offset:18432
    v_mfma_f32_16x16x32_bf16 v[92:95], v[44:47], v[196:199], v[92:95]
    ds_read_b64_tr_b16 v[62:63], v13 offset:19456
    s_cmp_eq_u32 s48, 0
    s_cbranch_scc1 L_wv_17
    s_waitcnt vmcnt(4)
L_wv_17:
    s_waitcnt vmcnt(5)
    s_barrier
    ds_read_b128 v[208:211], v8 offset:32768
    ds_read_b128 v[212:215], v8 offset:36864
    s_waitcnt lgkmcnt(8)
    v_mfma_f32_16x16x32_bf16 v[64:67], v[48:51], v[200:203], v[64:67]
    ds_read_b64_tr_b16 v[32:33], v10 offset:34816
    v_mfma_f32_16x16x32_bf16 v[80:83], v[48:51], v[204:207], v[80:83]
    ds_read_b64_tr_b16 v[34:35], v10 offset:35840
    s_waitcnt lgkmcnt(8)
    v_mfma_f32_16x16x32_bf16 v[68:71], v[52:55], v[200:203], v[68:71]
    ds_read_b64_tr_b16 v[36:37], v11 offset:34816
    v_mfma_f32_16x16x32_bf16 v[84:87], v[52:55], v[204:207], v[84:87]
    ds_read_b64_tr_b16 v[38:39], v11 offset:35840
    s_add_u32 m0, s57, 32768
    s_lshl_b32 s78, s88, 7
    s_add_u32 s78, s78, s58
    buffer_load_dwordx4 v1, s[8:11], s78 offen lds
    s_waitcnt lgkmcnt(8)
    v_mfma_f32_16x16x32_bf16 v[72:75], v[56:59], v[200:203], v[72:75]
    ds_read_b64_tr_b16 v[40:41], v12 offset:34816
    v_mfma_f32_16x16x32_bf16 v[88:91], v[56:59], v[204:207], v[88:91]
    ds_read_b64_tr_b16 v[42:43], v12 offset:35840
    buffer_load_dwordx4 v2, s[8:11], s78 offen offset:1024 lds
    s_waitcnt lgkmcnt(8)
    v_mfma_f32_16x16x32_bf16 v[76:79], v[60:63], v[200:203], v[76:79]
    ds_read_b64_tr_b16 v[44:45], v13 offset:34816
    v_mfma_f32_16x16x32_bf16 v[92:95], v[60:63], v[204:207], v[92:95]
    ds_read_b64_tr_b16 v[46:47], v13 offset:35840
    ds_read_b128 v[216:219], v9 offset:32768
    ds_read_b128 v[220:223], v9 offset:36864
    v_xor_b32 v8, 0x10000, v8
    v_xor_b32 v9, 0x10000, v9
    s_waitcnt lgkmcnt(8)
    v_mfma_f32_16x16x32_bf16 v[64:67], v[32:35], v[208:211], v[64:67]
    ds_read_b64_tr_b16 v[48:49], v10 offset:51200
    v_mfma_f32_16x16x32_bf16 v[80:83], v[32:35], v[212:215], v[80:83]
    ds_read_b64_tr_b16 v[50:51], v10 offset:52224
    v_xor_b32 v10, 0x10000, v10
    s_waitcnt lgkmcnt(8)
    v_mfma_f32_16x16x32_bf16 v[68:71], v[36:39], v[208:211], v[68:71]
    ds_read_b64_tr_b16 v[52:53], v11 offset:51200
    v_mfma_f32_16x16x32_bf16 v[84:87], v[36:39], v[212:215], v[84:87]
    ds_read_b64_tr_b16 v[54:55], v11 offset:52224
    v_xor_b32 v11, 0x10000, v11
    s_add_u32 m0, s57, 34816
    s_mul_i32 s78, s88, 245760
    s_add_u32 s78, s78, s59
    buffer_load_dwordx4 v3, s[12:15], s78 offen lds
    s_waitcnt lgkmcnt(8)
    v_mfma_f32_16x16x32_bf16 v[72:75], v[40:43], v[208:211], v[72:75]
    ds_read_b64_tr_b16 v[56:57], v12 offset:51200
    v_mfma_f32_16x16x32_bf16 v[88:91], v[40:43], v[212:215], v[88:91]
    ds_read_b64_tr_b16 v[58:59], v12 offset:52224
    v_xor_b32 v12, 0x10000, v12
    s_add_u32 s88, s88, 1
    s_cmp_eq_u32 s88, 10
    s_cselect_b32 s88, 0, s88
    buffer_load_dwordx4 v4, s[12:15], s78 offen offset:1024 lds
    s_waitcnt lgkmcnt(8)
    v_mfma_f32_16x16x32_bf16 v[76:79], v[44:47], v[208:211], v[76:79]
    ds_read_b64_tr_b16 v[60:61], v13 offset:51200
    v_mfma_f32_16x16x32_bf16 v[92:95], v[44:47], v[212:215], v[92:95]
    ds_read_b64_tr_b16 v[62:63], v13 offset:52224
    v_xor_b32 v13, 0x10000, v13
    s_cmp_lg_u32 s48, 0
    s_cbranch_scc1 L_w0_19
    s_waitcnt vmcnt(8)
L_spin_20:
    v_cmp_le_u32 vcc, 8, v246
    s_nop 1
    s_cmp_eq_u64 vcc, -1
    s_cbranch_scc1 L_got_21
    s_add_u32 s96, s96, 1
    s_cmp_gt_u32 s96, 0x100000
    s_cbranch_scc1 L_got_21
    s_sleep 1
    buffer_load_dword v246, v244, s[92:95], 0 offen sc1
    s_waitcnt vmcnt(0)
    s_branch L_spin_20
L_got_21:
L_w0_19:
    s_waitcnt vmcnt(4)
    s_barrier
    ds_read_b128 v[224:227], v8 offset:0
    ds_read_b128 v[228:231], v8 offset:4096
    s_waitcnt lgkmcnt(8)
    v_mfma_f32_16x16x32_bf16 v[64:67], v[48:51], v[216:219], v[64:67]
    ds_read_b64_tr_b16 v[32:33], v10 offset:2048
    v_mfma_f32_16x16x32_bf16 v[80:83], v[48:51], v[220:223], v[80:83]
    ds_read_b64_tr_b16 v[34:35], v10 offset:3072
    s_waitcnt lgkmcnt(8)
    v_mfma_f32_16x16x32_bf16 v[68:71], v[52:55], v[216:219], v[68:71]
    ds_read_b64_tr_b16 v[36:37], v11 offset:2048
    v_mfma_f32_16x16x32_bf16 v[84:87], v[52:55], v[220:223], v[84:87]
    ds_read_b64_tr_b16 v[38:39], v11 offset:3072
    s_add_u32 m0, s79, 65536
    s_mul_i32 s78, s89, 196608
    s_add_u32 s78, s78, s80
    buffer_load_dwordx4 v5, s[16:19], s78 offen lds
    s_waitcnt lgkmcnt(8)
    v_mfma_f32_16x16x32_bf16 v[72:75], v[56:59], v[216:219], v[72:75]
    ds_read_b64_tr_b16 v[40:41], v12 offset:2048
    v_mfma_f32_16x16x32_bf16 v[88:91], v[56:59], v[220:223], v[88:91]
    ds_read_b64_tr_b16 v[42:43], v12 offset:3072
    s_add_u32 s89, s89, 2
    s_sub_u32 s87, s89, 10
    s_min_u32 s89, s89, s87
    buffer_load_dwordx4 v6, s[16:19], s78 offen offset:1024 lds
    s_waitcnt lgkmcnt(8)
    v_mfma_f32_16x16x32_bf16 v[76:79], v[60:63], v[216:219], v[76:79]
    ds_read_b64_tr_b16 v[44:45], v13 offset:2048
    v_mfma_f32_16x16x32_bf16 v[92:95], v[60:63], v[220:223], v[92:95]
    ds_read_b64_tr_b16 v[46:47], v13 offset:3072
    ds_read_b128 v[232:235], v9 offset:0
    ds_read_b128 v[236:239], v9 offset:4096
    s_waitcnt lgkmcnt(8)
    v_mfma_f32_16x16x32_bf16 v[64:67], v[32:35], v[224:227], v[64:67]
    ds_read_b64_tr_b16 v[48:49], v10 offset:18432
    v_mfma_f32_16x16x32_bf16 v[80:83], v[32:35], v[228:231], v[80:83]
    ds_read_b64_tr_b16 v[50:51], v10 offset:19456
    s_waitcnt lgkmcnt(8)
    v_mfma_f32_16x16x32_bf16 v[68:71], v[36:39], v[224:227], v[68:71]
    ds_read_b64_tr_b16 v[52:53], v11 offset:18432
    v_mfma_f32_16x16x32_bf16 v[84:87], v[36:39], v[228:231], v[84:87]
    ds_read_b64_tr_b16 v[54:55], v11 offset:19456
    buffer_load_dwordx4 v7, s[16:19], s78 offen offset:2048 lds
    s_waitcnt lgkmcnt(8)
    v_mfma_f32_16x16x32_bf16 v[72:75], v[40:43], v[224:227], v[72:75]
    ds_read_b64_tr_b16 v[56:57], v12 offset:18432
    v_mfma_f32_16x16x32_bf16 v[88:91], v[40:43], v[228:231], v[88:91]
    ds_read_b64_tr_b16 v[58:59], v12 offset:19456
    s_waitcnt lgkmcnt(8)
    v_mfma_f32_16x16x32_bf16 v[76:79], v[44:47], v[224:227], v[76:79]
    ds_read_b64_tr_b16 v[60:61], v13 offset:18432
    v_mfma_f32_16x16x32_bf16 v[92:95], v[44:47], v[228:231], v[92:95]
    ds_read_b64_tr_b16 v[62:63], v13 offset:19456
    s_waitcnt vmcnt(3)
    s_barrier
    ds_read_b128 v[240:243], v8 offset:32768
    ds_read_b128 v[244:247], v8 offset:36864
    s_waitcnt lgkmcnt(8)
    v_mfma_f32_16x16x32_bf16 v[64:67], v[48:51], v[232:235], v[64:67]
    ds_read_b64_tr_b16 v[32:33], v10 offset:34816
    v_mfma_f32_16x16x32_bf16 v[80:83], v[48:51], v[236:239], v[80:83]
    ds_read_b64_tr_b16 v[34:35], v10 offset:35840
    s_waitcnt lgkmcnt(8)
    v_mfma_f32_16x16x32_bf16 v[68:71], v[52:55], v[232:235], v[68:71]
    ds_read_b64_tr_b16 v[36:37], v11 offset:34816
    v_mfma_f32_16x16x32_bf16 v[84:87], v[52:55], v[236:239], v[84:87]
    ds_read_b64_tr_b16 v[38:39], v11 offset:35840
    s_add_u32 m0, s79, 98304
    s_mul_i32 s78, s89, 196608
    s_add_u32 s78, s78, s80
    buffer_load_dwordx4 v5, s[16:19], s78 offen lds
    s_waitcnt lgkmcnt(8)
    v_mfma_f32_16x16x32_bf16 v[72:75], v[56:59], v[232:235], v[72:75]
    ds_read_b64_tr_b16 v[40:41], v12 offset:34816
    v_mfma_f32_16x16x32_bf16 v[88:91], v[56:59], v[236:239], v[88:91]
    ds_read_b64_tr_b16 v[42:43], v12 offset:35840
    s_add_u32 s89, s89, 2
    s_sub_u32 s87, s89, 10
    s_min_u32 s89, s89, s87
    buffer_load_dwordx4 v6, s[16:19], s78 offen offset:1024 lds
    s_waitcnt lgkmcnt(8)
    v_mfma_f32_16x16x32_bf16 v[76:79], v[60:63], v[232:235], v[76:79]
    ds_read_b64_tr_b16 v[44:45], v13 offset:34816
    v_mfma_f32_16x16x32_bf16 v[92:95], v[60:63], v[236:239], v[92:95]
    ds_read_b64_tr_b16 v[46:47], v13 offset:35840
    ds_read_b128 v[248:251], v9 offset:32768
    ds_read_b128 v[252:255], v9 offset:36864
    s_waitcnt lgkmcnt(8)
    v_mfma_f32_16x16x32_bf16 v[64:67], v[32:35], v[240:243], v[64:67]
    ds_read_b64_tr_b16 v[48:49], v10 offset:51200
    v_mfma_f32_16x16x32_bf16 v[80:83], v[32:35], v[244:247], v[80:83]
    ds_read_b64_tr_b16 v[50:51], v10 offset:52224
    s_waitcnt lgkmcnt(8)
    v_mfma_f32_16x16x32_bf16 v[68:71], v[36:39], v[240:243], v[68:71]
    ds_read_b64_tr_b16 v[52:53], v11 offset:51200
    v_mfma_f32_16x16x32_bf16 v[84:87], v[36:39], v[244:247], v[84:87]
    ds_read_b64_tr_b16 v[54:55], v11 offset:52224
    buffer_load_dwordx4 v7, s[16:19], s78 offen offset:2048 lds
    s_waitcnt lgkmcnt(8)
    v_mfma_f32_16x16x32_bf16 v[72:75], v[40:43], v[240:243], v[72:75]
    ds_read_b64_tr_b16 v[56:57], v12 offset:51200
    v_mfma_f32_16x16x32_bf16 v[88:91], v[40:43], v[244:247], v[88:91]
    ds_read_b64_tr_b16 v[58:59], v12 offset:52224
    s_waitcnt lgkmcnt(8)
    v_mfma_f32_16x16x32_bf16 v[76:79], v[44:47], v[240:243], v[76:79]
    ds_read_b64_tr_b16 v[60:61], v13 offset:51200
    v_mfma_f32_16x16x32_bf16 v[92:95], v[44:47], v[244:247], v[92:95]
    ds_read_b64_tr_b16 v[62:63], v13 offset:52224
    s_waitcnt vmcnt(3)
    s_barrier
    s_waitcnt lgkmcnt(6)
    v_mfma_f32_16x16x32_bf16 v[64:67], v[48:51], v[248:251], v[64:67]
    ds_read_b64_tr_b16 v[32:33], v14 offset:0
    v_mfma_f32_16x16x32_bf16 v[80:83], v[48:51], v[252:255], v[80:83]
    ds_read_b64_tr_b16 v[34:35], v14 offset:1536
    s_waitcnt lgkmcnt(6)
    v_mfma_f32_16x16x32_bf16 v[68:71], v[52:55], v[248:251], v[68:71]
    ds_read_b64_tr_b16 v[36:37], v15 offset:0
    v_mfma_f32_16x16x32_bf16 v[84:87], v[52:55], v[252:255], v[84:87]
    ds_read_b64_tr_b16 v[38:39], v15 offset:1536
    s_add_u32 m0, s79, 0
    s_mul_i32 s78, s89, 196608
    s_add_u32 s78, s78, s80
    buffer_load_dwordx4 v5, s[16:19], s78 offen lds
    s_waitcnt lgkmcnt(6)
    v_mfma_f32_16x16x32_bf16 v[72:75], v[56:59], v[248:251], v[72:75]
    ds_read_b64_tr_b16 v[40:41], v16 offset:0
    v_mfma_f32_16x16x32_bf16 v[88:91], v[56:59], v[252:255], v[88:91]
    ds_read_b64_tr_b16 v[42:43], v16 offset:1536
    s_add_u32 s89, s89, 2
    s_sub_u32 s87, s89, 10
    s_min_u32 s89, s89, s87
    buffer_load_dwordx4 v6, s[16:19], s78 offen offset:1024 lds
    s_waitcnt lgkmcnt(6)
    v_mfma_f32_16x16x32_bf16 v[76:79], v[60:63], v[248:251], v[76:79]
    v_mfma_f32_16x16x32_bf16 v[92:95], v[60:63], v[252:255], v[92:95]
    buffer_load_dwordx4 v7, s[16:19], s78 offen offset:2048 lds
    s_nop 5
    s_cmp_ge_u32 s50, 5
    s_cbranch_scc1 L_noscale_22
    v_mul_f32 v64, s60, v64
    v_mul_f32 v65, s60, v65
    v_mul_f32 v66, s60, v66
    v_mul_f32 v67, s60, v67
    v_mul_f32 v68, s60, v68
    v_mul_f32 v69, s60, v69
    v_mul_f32 v70, s60, v70
    v_mul_f32 v71, s60, v71
    v_mul_f32 v72, s60, v72
    v_mul_f32 v73, s60, v73
    v_mul_f32 v74, s60, v74
    v_mul_f32 v75, s60, v75
    v_mul_f32 v76, s60, v76
    v_mul_f32 v77, s60, v77
    v_mul_f32 v78, s60, v78
    v_mul_f32 v79, s60, v79
    v_mul_f32 v80, s60, v80
    v_mul_f32 v81, s60, v81
    v_mul_f32 v82, s60, v82
    v_mul_f32 v83, s60, v83
    v_mul_f32 v84, s60, v84
    v_mul_f32 v85, s60, v85
    v_mul_f32 v86, s60, v86
    v_mul_f32 v87, s60, v87
    v_mul_f32 v88, s60, v88
    v_mul_f32 v89, s60, v89
    v_mul_f32 v90, s60, v90
    v_mul_f32 v91, s60, v91
    v_mul_f32 v92, s60, v92
    v_mul_f32 v93, s60, v93
    v_mul_f32 v94, s60, v94
    v_mul_f32 v95, s60, v95
L_noscale_22:
    v_cvt_pk_bf16_f32 v44, v64, v65
    v_cvt_pk_bf16_f32 v45, v66, v67
    v_cvt_pk_bf16_f32 v46, v80, v81
    v_cvt_pk_bf16_f32 v47, v82, v83
    buffer_store_dwordx4 v[44:47], v24, s[20:23], s81 offen sc1
    v_cvt_pk_bf16_f32 v60, v68, v69
    v_cvt_pk_bf16_f32 v61, v70, v71
    v_cvt_pk_bf16_f32 v62, v84, v85
    v_cvt_pk_bf16_f32 v63, v86, v87
    buffer_store_dwordx4 v[60:63], v25, s[20:23], s81 offen sc1
    v_cvt_pk_bf16_f32 v76, v76, v77
    v_cvt_pk_bf16_f32 v77, v78, v79
    v_cvt_pk_bf16_f32 v78, v92, v93
    v_cvt_pk_bf16_f32 v79, v94, v95
    v_cvt_pk_bf16_f32 v92, v72, v73
    v_cvt_pk_bf16_f32 v93, v74, v75
    v_cvt_pk_bf16_f32 v94, v88, v89
    v_cvt_pk_bf16_f32 v95, v90, v91
    s_branch L_join_6
L_vpass_4:
    s_cmp_eq_u32 s48, 0
    s_cbranch_scc1 L_wv_23
    s_waitcnt vmcnt(7)
L_wv_23:
    s_waitcnt vmcnt(8)
    s_barrier
    ds_read_b128 v[96:99], v8 offset:0
    ds_read_b128 v[100:103], v8 offset:4096
    ds_read_b64_tr_b16 v[32:33], v10 offset:2048
    ds_read_b64_tr_b16 v[34:35], v10 offset:3072
    ds_read_b64_tr_b16 v[36:37], v11 offset:2048
    ds_read_b64_tr_b16 v[38:39], v11 offset:3072
    s_add_u32 m0, s57, 65536
    s_lshl_b32 s78, s88, 7
    s_add_u32 s78, s78, s58
    buffer_load_dwordx4 v1, s[8:11], s78 offen lds
    ds_read_b64_tr_b16 v[40:41], v12 offset:2048
    ds_read_b64_tr_b16 v[42:43], v12 offset:3072
    buffer_load_dwordx4 v2, s[8:11], s78 offen offset:1024 lds
    ds_read_b64_tr_b16 v[44:45], v13 offset:2048
    ds_read_b64_tr_b16 v[46:47], v13 offset:3072
    s_add_u32 m0, s57, 67584
    s_mul_i32 s78, s88, 245760
    s_add_u32 s78, s78, s59
    buffer_load_dwordx4 v3, s[12:15], s78 offen lds
    s_add_u32 s88, s88, 1
    s_cmp_eq_u32 s88, 10
    s_cselect_b32 s88, 0, s88
    buffer_load_dwordx4 v4, s[12:15], s78 offen offset:1024 lds
    ds_read_b128 v[104:107], v9 offset:0
    ds_read_b128 v[108:111], v9 offset:4096
    s_waitcnt lgkmcnt(8)
    v_mfma_f32_16x16x32_bf16 v[64:67], v[96:99], v[32:35], 0
    ds_read_b64_tr_b16 v[48:49], v10 offset:18432
    v_mfma_f32_16x16x32_bf16 v[80:83], v[100:103], v[32:35], 0
    ds_read_b64_tr_b16 v[50:51], v10 offset:19456
    s_waitcnt lgkmcnt(8)
    v_mfma_f32_16x16x32_bf16 v[68:71], v[96:99], v[36:39], 0
    ds_read_b64_tr_b16 v[52:53], v11 offset:18432
    v_mfma_f32_16x16x32_bf16 v[84:87], v[100:103], v[36:39], 0
    ds_read_b64_tr_b16 v[54:55], v11 offset:19456
    s_waitcnt lgkmcnt(8)
    v_mfma_f32_16x16x32_bf16 v[72:75], v[96:99], v[40:43], 0
    ds_read_b64_tr_b16 v[56:57], v12 offset:18432
    v_mfma_f32_16x16x32_bf16 v[88:91], v[100:103], v[40:43], 0
    ds_read_b64_tr_b16 v[58:59], v12 offset:19456
    s_waitcnt lgkmcnt(8)
    v_mfma_f32_16x16x32_bf16 v[76:79], v[96:99], v[44:47], 0
    ds_read_b64_tr_b16 v[60:61], v13 offset:18432
    v_mfma_f32_16x16x32_bf16 v[92:95], v[100:103], v[44:47], 0
    ds_read_b64_tr_b16 v[62:63], v13 offset:19456
    s_waitcnt vmcnt(4)
    s_barrier
    ds_read_b128 v[112:115], v8 offset:32768
    ds_read_b128 v[116:119], v8 offset:36864
    s_waitcnt lgkmcnt(8)
    v_mfma_f32_16x16x32_bf16 v[64:67], v[104:107], v[48:51], v[64:67]
    ds_read_b64_tr_b16 v[32:33], v10 offset:34816
    v_mfma_f32_16x16x32_bf16 v[80:83], v[108:111], v[48:51], v[80:83]
    ds_read_b64_tr_b16 v[34:35], v10 offset:35840
    s_waitcnt lgkmcnt(8)
    v_mfma_f32_16x16x32_bf16 v[68:71], v[104:107], v[52:55], v[68:71]
    ds_read_b64_tr_b16 v[36:37], v11 offset:34816
    v_mfma_f32_16x16x32_bf16 v[84:87], v[108:111], v[52:55], v[84:87]
    ds_read_b64_tr_b16 v[38:39], v11 offset:35840
    s_add_u32 m0, s57, 98304
    s_lshl_b32 s78, s88, 7
    s_add_u32 s78, s78, s58
    buffer_load_dwordx4 v1, s[8:11], s78 offen lds
    s_waitcnt lgkmcnt(8)
    v_mfma_f32_16x16x32_bf16 v[72:75], v[104:107], v[56:59], v[72:75]
    ds_read_b64_tr_b16 v[40:41], v12 offset:34816
    v_mfma_f32_16x16x32_bf16 v[88:91], v[108:111], v[56:59], v[88:91]
    ds_read_b64_tr_b16 v[42:43], v12 offset:35840
    buffer_load_dwordx4 v2, s[8:11], s78 offen offset:1024 lds
    s_waitcnt lgkmcnt(8)
    v_mfma_f32_16x16x32_bf16 v[76:79], v[104:107], v[60:63], v[76:79]
    ds_read_b64_tr_b16 v[44:45], v13 offset:34816
    v_mfma_f32_16x16x32_bf16 v[92:95], v[108:111], v[60:63], v[92:95]
    ds_read_b64_tr_b16 v[46:47], v13 offset:35840
    s_add_u32 m0, s57, 100352
    s_mul_i32 s78, s88, 245760
    s_add_u32 s78, s78, s59
    buffer_load_dwordx4 v3, s[12:15], s78 offen lds
    ds_read_b128 v[120:123], v9 offset:32768
    ds_read_b128 v[124:127], v9 offset:36864
    v_xor_b32 v8, 0x10000, v8
    v_xor_b32 v9, 0x10000, v9
    s_waitcnt lgkmcnt(8)
    v_mfma_f32_16x16x32_bf16 v[64:67], v[112:115], v[32:35], v[64:67]
    ds_read_b64_tr_b16 v[48:49], v10 offset:51200
    v_mfma_f32_16x16x32_bf16 v[80:83], v[116:119], v[32:35], v[80:83]
    ds_read_b64_tr_b16 v[50:51], v10 offset:52224
    v_xor_b32 v10, 0x10000, v10
    s_waitcnt lgkmcnt(8)
    v_mfma_f32_16x16x32_bf16 v[68:71], v[112:115], v[36:39], v[68:71]
    ds_read_b64_tr_b16 v[52:53], v11 offset:51200
    v_mfma_f32_16x16x32_bf16 v[84:87], v[116:119], v[36:39], v[84:87]
    ds_read_b64_tr_b16 v[54:55], v11 offset:52224
    v_xor_b32 v11, 0x10000, v11
    s_add_u32 s88, s88, 1
    s_cmp_eq_u32 s88, 10
    s_cselect_b32 s88, 0, s88
    buffer_load_dwordx4 v4, s[12:15], s78 offen offset:1024 lds
    s_waitcnt lgkmcnt(8)
    v_mfma_f32_16x16x32_bf16 v[72:75], v[112:115], v[40:43], v[72:75]
    ds_read_b64_tr_b16 v[56:57], v12 offset:51200
    v_mfma_f32_16x16x32_bf16 v[88:91], v[116:119], v[40:43], v[88:91]
    ds_read_b64_tr_b16 v[58:59], v12 offset:52224
    v_xor_b32 v12, 0x10000, v12
    s_cmp_lg_u32 s48, 0
    s_cbranch_scc1 L_w0_25
    s_and_b32 s51, s2, 31
    s_lshl_b32 s51, s51, 2
    s_add_u32 s51, s51, 128
    v_mov_b32 v246, s51
    v_mov_b32 v247, 1
    s_mov_b64 exec, 1
    buffer_atomic_add v247, v246, s[92:95], 0 offen sc1
    s_mov_b64 exec, -1
L_w0_25:
    s_waitcnt lgkmcnt(8)
    v_mfma_f32_16x16x32_bf16 v[76:79], v[112:115], v[44:47], v[76:79]
    ds_read_b64_tr_b16 v[60:61], v13 offset:51200
    v_mfma_f32_16x16x32_bf16 v[92:95], v[116:119], v[44:47], v[92:95]
    ds_read_b64_tr_b16 v[62:63], v13 offset:52224
    v_xor_b32 v13, 0x10000, v13
    s_cmp_eq_u32 s48, 0
    s_cbranch_scc1 L_wv_26
    s_waitcnt vmcnt(4)
L_wv_26:
    s_waitcnt vmcnt(5)
    s_barrier
    ds_read_b128 v[128:131], v8 offset:0
    ds_read_b128 v[132:135], v8 offset:4096
    s_waitcnt lgkmcnt(8)
    v_mfma_f32_16x16x32_bf16 v[64:67], v[120:123], v[48:51], v[64:67]
    ds_read_b64_tr_b16 v[32:33], v10 offset:2048
    v_mfma_f32_16x16x32_bf16 v[80:83], v[124:127], v[48:51], v[80:83]
    ds_read_b64_tr_b16 v[34:35], v10 offset:3072
    s_waitcnt lgkmcnt(8)
    v_mfma_f32_16x16x32_bf16 v[68:71], v[120:123], v[52:55], v[68:71]
    ds_read_b64_tr_b16 v[36:37], v11 offset:2048
    v_mfma_f32_16x16x32_bf16 v[84:87], v[124:127], v[52:55], v[84:87]
    ds_read_b64_tr_b16 v[38:39], v11 offset:3072
    s_add_u32 m0, s57, 0
    s_lshl_b32 s78, s88, 7
    s_add_u32 s78, s78, s58
    buffer_load_dwordx4 v1, s[8:11], s78 offen lds
    s_waitcnt lgkmcnt(8)
    v_mfma_f32_16x16x32_bf16 v[72:75], v[120:123], v[56:59], v[72:75]
    ds_read_b64_tr_b16 v[40:41], v12 offset:2048
    v_mfma_f32_16x16x32_bf16 v[88:91], v[124:127], v[56:59], v[88:91]
    ds_read_b64_tr_b16 v[42:43], v12 offset:3072
    buffer_load_dwordx4 v2, s[8:11], s78 offen offset:1024 lds
    s_waitcnt lgkmcnt(8)
    v_mfma_f32_16x16x32_bf16 v[76:79], v[120:123], v[60:63], v[76:79]
    ds_read_b64_tr_b16 v[44:45], v13 offset:2048
    v_mfma_f32_16x16x32_bf16 v[92:95], v[124:127], v[60:63], v[92:95]
    ds_read_b64_tr_b16 v[46:47], v13 offset:3072
    s_add_u32 m0, s57, 2048
    s_mul_i32 s78, s88, 245760
    s_add_u32 s78, s78, s59
    buffer_load_dwordx4 v3, s[12:15], s78 offen lds
    ds_read_b128 v[136:139], v9 offset:0
    ds_read_b128 v[140:143], v9 offset:4096
    s_waitcnt lgkmcnt(8)
    v_mfma_f32_16x16x32_bf16 v[64:67], v[128:131], v[32:35], v[64:67]
    ds_read_b64_tr_b16 v[48:49], v10 offset:18432
    v_mfma_f32_16x16x32_bf16 v[80:83], v[132:135], v[32:35], v[80:83]
    ds_read_b64_tr_b16 v[50:51], v10 offset:19456
    s_waitcnt lgkmcnt(8)
    v_mfma_f32_16x16x32_bf16 v[68:71], v[128:131], v[36:39], v[68:71]
    ds_read_b64_tr_b16 v[52:53], v11 offset:18432
    v_mfma_f32_16x16x32_bf16 v[84:87], v[132:135], v[36:39], v[84:87]
    ds_read_b64_tr_b16 v[54:55], v11 offset:19456
    s_add_u32 s88, s88, 1
    s_cmp_eq_u32 s88, 10
    s_cselect_b32 s88, 0, s88
    buffer_load_dwordx4 v4, s[12:15], s78 offen offset:1024 lds
    s_waitcnt lgkmcnt(8)
    v_mfma_f32_16x16x32_bf16 v[72:75], v[128:131], v[40:43], v[72:75]
    ds_read_b64_tr_b16 v[56:57], v12 offset:18432
    v_mfma_f32_16x16x32_bf16 v[88:91], v[132:135], v[40:43], v[88:91]
    ds_read_b64_tr_b16 v[58:59], v12 offset:19456
    s_waitcnt lgkmcnt(8)
    v_mfma_f32_16x16x32_bf16 v[76:79], v[128:131], v[44:47], v[76:79]
    ds_read_b64_tr_b16 v[60:61], v13 offset:18432
    v_mfma_f32_16x16x32_bf16 v[92:95], v[132:135], v[44:47], v[92:95]
    ds_read_b64_tr_b16 v[62:63], v13 offset:19456
    s_cmp_eq_u32 s48, 0
    s_cbranch_scc1 L_wv_28
    s_waitcnt vmcnt(4)
L_wv_28:
    s_waitcnt vmcnt(5)
    s_barrier
    ds_read_b128 v[144:147], v8 offset:32768
    ds_read_b128 v[148:151], v8 offset:36864
    s_waitcnt lgkmcnt(8)
    v_mfma_f32_16x16x32_bf16 v[64:67], v[136:139], v[48:51], v[64:67]
    ds_read_b64_tr_b16 v[32:33], v10 offset:34816
    v_mfma_f32_16x16x32_bf16 v[80:83], v[140:143], v[48:51], v[80:83]
    ds_read_b64_tr_b16 v[34:35], v10 offset:35840
    s_waitcnt lgkmcnt(8)
    v_mfma_f32_16x16x32_bf16 v[68:71], v[136:139], v[52:55], v[68:71]
    ds_read_b64_tr_b16 v[36:37], v11 offset:34816
    v_mfma_f32_16x16x32_bf16 v[84:87], v[140:143], v[52:55], v[84:87]
    ds_read_b64_tr_b16 v[38:39], v11 offset:35840
    s_add_u32 m0, s57, 32768
    s_lshl_b32 s78, s88, 7
    s_add_u32 s78, s78, s58
    buffer_load_dwordx4 v1, s[8:11], s78 offen lds
    s_waitcnt lgkmcnt(8)
    v_mfma_f32_16x16x32_bf16 v[72:75], v[136:139], v[56:59], v[72:75]
    ds_read_b64_tr_b16 v[40:41], v12 offset:34816
    v_mfma_f32_16x16x32_bf16 v[88:91], v[140:143], v[56:59], v[88:91]
    ds_read_b64_tr_b16 v[42:43], v12 offset:35840
    buffer_load_dwordx4 v2, s[8:11], s78 offen offset:1024 lds
    s_waitcnt lgkmcnt(8)
    v_mfma_f32_16x16x32_bf16 v[76:79], v[136:139], v[60:63], v[76:79]
    ds_read_b64_tr_b16 v[44:45], v13 offset:34816
    v_mfma_f32_16x16x32_bf16 v[92:95], v[140:143], v[60:63], v[92:95]
    ds_read_b64_tr_b16 v[46:47], v13 offset:35840
    s_add_u32 m0, s57, 34816
    s_mul_i32 s78, s88, 245760
    s_add_u32 s78, s78, s59
    buffer_load_dwordx4 v3, s[12:15], s78 offen lds
    ds_read_b128 v[152:155], v9 offset:32768
    ds_read_b128 v[156:159], v9 offset:36864
    v_xor_b32 v8, 0x10000, v8
    v_xor_b32 v9, 0x10000, v9
    s_waitcnt lgkmcnt(8)
    v_mfma_f32_16x16x32_bf16 v[64:67], v[144:147], v[32:35], v[64:67]
    ds_read_b64_tr_b16 v[48:49], v10 offset:51200
    v_mfma_f32_16x16x32_bf16 v[80:83], v[148:151], v[32:35], v[80:83]
    ds_read_b64_tr_b16 v[50:51], v10 offset:52224
    v_xor_b32 v10, 0x10000, v10
    s_waitcnt lgkmcnt(8)
    v_mfma_f32_16x16x32_bf16 v[68:71], v[144:147], v[36:39], v[68:71]
    ds_read_b64_tr_b16 v[52:53], v11 offset:51200
    v_mfma_f32_16x16x32_bf16 v[84:87], v[148:151], v[36:39], v[84:87]
    ds_read_b64_tr_b16 v[54:55], v11 offset:52224
    v_xor_b32 v11, 0x10000, v11
    s_add_u32 s88, s88, 1
    s_cmp_eq_u32 s88, 10
    s_cselect_b32 s88, 0, s88
    buffer_load_dwordx4 v4, s[12:15], s78 offen offset:1024 lds
    s_waitcnt lgkmcnt(8)
    v_mfma_f32_16x16x32_bf16 v[72:75], v[144:147], v[40:43], v[72:75]
    ds_read_b64_tr_b16 v[56:57], v12 offset:51200
    v_mfma_f32_16x16x32_bf16 v[88:91], v[148:151], v[40:43], v[88:91]
    ds_read_b64_tr_b16 v[58:59], v12 offset:52224
    v_xor_b32 v12, 0x10000, v12
    s_waitcnt lgkmcnt(8)
    v_mfma_f32_16x16x32_bf16 v[76:79], v[144:147], v[44:47], v[76:79]
    ds_read_b64_tr_b16 v[60:61], v13 offset:51200
    v_mfma_f32_16x16x32_bf16 v[92:95], v[148:151], v[44:47], v[92:95]
    ds_read_b64_tr_b16 v[62:63], v13 offset:52224
    v_xor_b32 v13, 0x10000, v13
    s_waitcnt vmcnt(4)
    s_barrier
    ds_read_b128 v[160:163], v8 offset:0
    ds_read_b128 v[164:167], v8 offset:4096
    s_waitcnt lgkmcnt(8)
    v_mfma_f32_16x16x32_bf16 v[64:67], v[152:155], v[48:51], v[64:67]
    ds_read_b64_tr_b16 v[32:33], v10 offset:2048
    v_mfma_f32_16x16x32_bf16 v[80:83], v[156:159], v[48:51], v[80:83]
    ds_read_b64_tr_b16 v[34:35], v10 offset:3072
    s_waitcnt lgkmcnt(8)
    v_mfma_f32_16x16x32_bf16 v[68:71], v[152:155], v[52:55], v[68:71]
    ds_read_b64_tr_b16 v[36:37], v11 offset:2048
    v_mfma_f32_16x16x32_bf16 v[84:87], v[156:159], v[52:55], v[84:87]
    ds_read_b64_tr_b16 v[38:39], v11 offset:3072
    s_add_u32 m0, s57, 65536
    s_lshl_b32 s78, s88, 7
    s_add_u32 s78, s78, s58
    buffer_load_dwordx4 v1, s[8:11], s78 offen lds
    s_waitcnt lgkmcnt(8)
    v_mfma_f32_16x16x32_bf16 v[72:75], v[152:155], v[56:59], v[72:75]
    ds_read_b64_tr_b16 v[40:41], v12 offset:2048
    v_mfma_f32_16x16x32_bf16 v[88:91], v[156:159], v[56:59], v[88:91]
    ds_read_b64_tr_b16 v[42:43], v12 offset:3072
    buffer_load_dwordx4 v2, s[8:11], s78 offen offset:1024 lds
    s_waitcnt lgkmcnt(8)
    v_mfma_f32_16x16x32_bf16 v[76:79], v[152:155], v[60:63], v[76:79]
    ds_read_b64_tr_b16 v[44:45], v13 offset:2048
    v_mfma_f32_16x16x32_bf16 v[92:95], v[156:159], v[60:63], v[92:95]
    ds_read_b64_tr_b16 v[46:47], v13 offset:3072
    ds_read_b128 v[168:171], v9 offset:0
    ds_read_b128 v[172:175], v9 offset:4096
    s_waitcnt lgkmcnt(8)
    v_mfma_f32_16x16x32_bf16 v[64:67], v[160:163], v[32:35], v[64:67]
    ds_read_b64_tr_b16 v[48:49], v10 offset:18432
    v_mfma_f32_16x16x32_bf16 v[80:83], v[164:167], v[32:35], v[80:83]
    ds_read_b64_tr_b16 v[50:51], v10 offset:19456
    s_waitcnt lgkmcnt(8)
    v_mfma_f32_16x16x32_bf16 v[68:71], v[160:163], v[36:39], v[68:71]
    ds_read_b64_tr_b16 v[52:53], v11 offset:18432
    v_mfma_f32_16x16x32_bf16 v[84:87], v[164:167], v[36:39], v[84:87]
    ds_read_b64_tr_b16 v[54:55], v11 offset:19456
    s_add_u32 m0, s57, 67584
    s_mul_i32 s78, s88, 245760
    s_add_u32 s78, s78, s59
    buffer_load_dwordx4 v3, s[12:15], s78 offen lds
    s_waitcnt lgkmcnt(8)
    v_mfma_f32_16x16x32_bf16 v[72:75], v[160:163], v[40:43], v[72:75]
    ds_read_b64_tr_b16 v[56:57], v12 offset:18432
    v_mfma_f32_16x16x32_bf16 v[88:91], v[164:167], v[40:43], v[88:91]
    ds_read_b64_tr_b16 v[58:59], v12 offset:19456
    s_add_u32 s88, s88, 1
    s_cmp_eq_u32 s88, 10
    s_cselect_b32 s88, 0, s88
    buffer_load_dwordx4 v4, s[12:15], s78 offen offset:1024 lds
    s_waitcnt lgkmcnt(8)
    v_mfma_f32_16x16x32_bf16 v[76:79], v[160:163], v[44:47], v[76:79]
    ds_read_b64_tr_b16 v[60:61], v13 offset:18432
    v_mfma_f32_16x16x32_bf16 v[92:95], v[164:167], v[44:47], v[92:95]
    ds_read_b64_tr_b16 v[62:63], v13 offset:19456
    buffer_load_dword v254, v250, s[16:19], 0 offen
    s_waitcnt vmcnt(5)
    s_barrier
    ds_read_b128 v[176:179], v8 offset:32768
    ds_read_b128 v[180:183], v8 offset:36864
    s_waitcnt lgkmcnt(8)
    v_mfma_f32_16x16x32_bf16 v[64:67], v[168:171], v[48:51], v[64:67]
    ds_read_b64_tr_b16 v[32:33], v10 offset:34816
    v_mfma_f32_16x16x32_bf16 v[80:83], v[172:175], v[48:51], v[80:83]
    ds_read_b64_tr_b16 v[34:35], v10 offset:35840
    s_waitcnt lgkmcnt(8)
    v_mfma_f32_16x16x32_bf16 v[68:71], v[168:171], v[52:55], v[68:71]
    ds_read_b64_tr_b16 v[36:37], v11 offset:34816
    v_mfma_f32_16x16x32_bf16 v[84:87], v[172:175], v[52:55], v[84:87]
    ds_read_b64_tr_b16 v[38:39], v11 offset:35840
    s_add_u32 m0, s57, 98304
    s_lshl_b32 s78, s88, 7
    s_add_u32 s78, s78, s58
    buffer_load_dwordx4 v1, s[8:11], s78 offen lds
    s_waitcnt lgkmcnt(8)
    v_mfma_f32_16x16x32_bf16 v[72:75], v[168:171], v[56:59], v[72:75]
    ds_read_b64_tr_b16 v[40:41], v12 offset:34816
    v_mfma_f32_16x16x32_bf16 v[88:91], v[172:175], v[56:59], v[88:91]
    ds_read_b64_tr_b16 v[42:43], v12 offset:35840
    buffer_load_dwordx4 v2, s[8:11], s78 offen offset:1024 lds
    s_waitcnt lgkmcnt(8)
    v_mfma_f32_16x16x32_bf16 v[76:79], v[168:171], v[60:63], v[76:79]
    ds_read_b64_tr_b16 v[44:45], v13 offset:34816
    v_mfma_f32_16x16x32_bf16 v[92:95], v[172:175], v[60:63], v[92:95]
    ds_read_b64_tr_b16 v[46:47], v13 offset:35840
    ds_read_b128 v[184:187], v9 offset:32768
    ds_read_b128 v[188:191], v9 offset:36864
    v_xor_b32 v8, 0x10000, v8
    v_xor_b32 v9, 0x10000, v9
    s_waitcnt lgkmcnt(8)
    v_mfma_f32_16x16x32_bf16 v[64:67], v[176:179], v[32:35], v[64:67]
    ds_read_b64_tr_b16 v[48:49], v10 offset:51200
    v_mfma_f32_16x16x32_bf16 v[80:83], v[180:183], v[32:35], v[80:83]
    ds_read_b64_tr_b16 v[50:51], v10 offset:52224
    v_xor_b32 v10, 0x10000, v10
    s_waitcnt lgkmcnt(8)
    v_mfma_f32_16x16x32_bf16 v[68:71], v[176:179], v[36:39], v[68:71]
    ds_read_b64_tr_b16 v[52:53], v11 offset:51200
    v_mfma_f32_16x16x32_bf16 v[84:87], v[180:183], v[36:39], v[84:87]
    ds_read_b64_tr_b16 v[54:55], v11 offset:52224
    v_xor_b32 v11, 0x10000, v11
    s_add_u32 m0, s57, 100352
    s_mul_i32 s78, s88, 245760
    s_add_u32 s78, s78, s59
    buffer_load_dwordx4 v3, s[12:15], s78 offen lds
    s_waitcnt lgkmcnt(8)
    v_mfma_f32_16x16x32_bf16 v[72:75], v[176:179], v[40:43], v[72:75]
    ds_read_b64_tr_b16 v[56:57], v12 offset:51200
    v_mfma_f32_16x16x32_bf16 v[88:91], v[180:183], v[40:43], v[88:91]
    ds_read_b64_tr_b16 v[58:59], v12 offset:52224
    v_xor_b32 v12, 0x10000, v12
    s_add_u32 s88, s88, 1
    s_cmp_eq_u32 s88, 10
    s_cselect_b32 s88, 0, s88
    buffer_load_dwordx4 v4, s[12:15], s78 offen offset:1024 lds
    s_waitcnt lgkmcnt(8)
    v_mfma_f32_16x16x32_bf16 v[76:79], v[176:179], v[44:47], v[76:79]
    ds_read_b64_tr_b16 v[60:61], v13 offset:51200
    v_mfma_f32_16x16x32_bf16 v[92:95], v[180:183], v[44:47], v[92:95]
    ds_read_b64_tr_b16 v[62:63], v13 offset:52224
    v_xor_b32 v13, 0x10000, v13
    s_cmp_lg_u32 s48, 0
    s_cbranch_scc1 L_w0_30
    v_lshlrev_b32 v244, 2, v0
    v_or_b32 v244, 128, v244
    buffer_load_dword v246, v244, s[92:95], 0 offen sc1
L_w0_30:
    s_cmp_eq_u32 s48, 0
    s_cbranch_scc1 L_wv_31
    s_waitcnt vmcnt(5)
L_wv_31:
    s_waitcnt vmcnt(6)
    s_barrier
    ds_read_b128 v[192:195], v8 offset:0
    ds_read_b128 v[196:199], v8 offset:4096
    s_waitcnt lgkmcnt(8)
    v_mfma_f32_16x16x32_bf16 v[64:67], v[184:187], v[48:51], v[64:67]
    ds_read_b64_tr_b16 v[32:33], v10 offset:2048
    v_mfma_f32_16x16x32_bf16 v[80:83], v[188:191], v[48:51], v[80:83]
    ds_read_b64_tr_b16 v[34:35], v10 offset:3072
    s_waitcnt lgkmcnt(8)
    v_mfma_f32_16x16x32_bf16 v[68:71], v[184:187], v[52:55], v[68:71]
    ds_read_b64_tr_b16 v[36:37], v11 offset:2048
    v_mfma_f32_16x16x32_bf16 v[84:87], v[188:191], v[52:55], v[84:87]
    ds_read_b64_tr_b16 v[38:39], v11 offset:3072
    s_add_u32 m0, s57, 0
    s_lshl_b32 s78, s88, 7
    s_add_u32 s78, s78, s58
    buffer_load_dwordx4 v1, s[8:11], s78 offen lds
    s_waitcnt lgkmcnt(8)
    v_mfma_f32_16x16x32_bf16 v[72:75], v[184:187], v[56:59], v[72:75]
    ds_read_b64_tr_b16 v[40:41], v12 offset:2048
    v_mfma_f32_16x16x32_bf16 v[88:91], v[188:191], v[56:59], v[88:91]
    ds_read_b64_tr_b16 v[42:43], v12 offset:3072
    buffer_load_dwordx4 v2, s[8:11], s78 offen offset:1024 lds
    s_waitcnt lgkmcnt(8)
    v_mfma_f32_16x16x32_bf16 v[76:79], v[184:187], v[60:63], v[76:79]
    ds_read_b64_tr_b16 v[44:45], v13 offset:2048
    v_mfma_f32_16x16x32_bf16 v[92:95], v[188:191], v[60:63], v[92:95]
    ds_read_b64_tr_b16 v[46:47], v13 offset:3072
    ds_read_b128 v[200:203], v9 offset:0
    ds_read_b128 v[204:207], v9 offset:4096
    s_waitcnt lgkmcnt(8)
    v_mfma_f32_16x16x32_bf16 v[64:67], v[192:195], v[32:35], v[64:67]
    ds_read_b64_tr_b16 v[48:49], v10 offset:18432
    v_mfma_f32_16x16x32_bf16 v[80:83], v[196:199], v[32:35], v[80:83]
    ds_read_b64_tr_b16 v[50:51], v10 offset:19456
    s_waitcnt lgkmcnt(8)
    v_mfma_f32_16x16x32_bf16 v[68:71], v[192:195], v[36:39], v[68:71]
    ds_read_b64_tr_b16 v[52:53], v11 offset:18432
    v_mfma_f32_16x16x32_bf16 v[84:87], v[196:199], v[36:39], v[84:87]
    ds_read_b64_tr_b16 v[54:55], v11 offset:19456
    s_add_u32 m0, s57, 2048
    s_mul_i32 s78, s88, 245760
    s_add_u32 s78, s78, s59
    buffer_load_dwordx4 v3, s[12:15], s78 offen lds
    s_waitcnt lgkmcnt(8)
    v_mfma_f32_16x16x32_bf16 v[72:75], v[192:195], v[40:43], v[72:75]
    ds_read_b64_tr_b16 v[56:57], v12 offset:18432
    v_mfma_f32_16x16x32_bf16 v[88:91], v[196:199], v[40:43], v[88:91]
    ds_read_b64_tr_b16 v[58:59], v12 offset:19456
    s_add_u32 s88, s88, 1
    s_cmp_eq_u32 s88, 10
    s_cselect_b32 s88, 0, s88
    buffer_load_dwordx4 v4, s[12:15], s78 offen offset:1024 lds
    s_waitcnt lgkmcnt(8)
    v_mfma_f32_16x16x32_bf16 v[76:79], v[192:195], v[44:47], v[76:79]
    ds_read_b64_tr_b16 v[60:61], v13 offset:18432
    v_mfma_f32_16x16x32_bf16 v[92:95], v[196:199], v[44:47], v[92:95]
    ds_read_b64_tr_b16 v[62:63], v13 offset:19456
    s_cmp_eq_u32 s48, 0
    s_cbranch_scc1 L_wv_33
    s_waitcnt vmcnt(4)
L_wv_33:
    s_waitcnt vmcnt(5)
    s_barrier
    ds_read_b128 v[208:211], v8 offset:32768
    ds_read_b128 v[212:215], v8 offset:36864
    s_waitcnt lgkmcnt(8)
    v_mfma_f32_16x16x32_bf16 v[64:67], v[200:203], v[48:51], v[64:67]
    ds_read_b64_tr_b16 v[32:33], v10 offset:34816
    v_mfma_f32_16x16x32_bf16 v[80:83], v[204:207], v[48:51], v[80:83]
    ds_read_b64_tr_b16 v[34:35], v10 offset:35840
    s_waitcnt lgkmcnt(8)
    v_mfma_f32_16x16x32_bf16 v[68:71], v[200:203], v[52:55], v[68:71]
    ds_read_b64_tr_b16 v[36:37], v11 offset:34816
    v_mfma_f32_16x16x32_bf16 v[84:87], v[204:207], v[52:55], v[84:87]
    ds_read_b64_tr_b16 v[38:39], v11 offset:35840
    s_add_u32 m0, s57, 32768
    s_lshl_b32 s78, s88, 7
    s_add_u32 s78, s78, s58
    buffer_load_dwordx4 v1, s[8:11], s78 offen lds
    s_waitcnt lgkmcnt(8)
    v_mfma_f32_16x16x32_bf16 v[72:75], v[200:203], v[56:59], v[72:75]
    ds_read_b64_tr_b16 v[40:41], v12 offset:34816
    v_mfma_f32_16x16x32_bf16 v[88:91], v[204:207], v[56:59], v[88:91]
    ds_read_b64_tr_b16 v[42:43], v12 offset:35840
    buffer_load_dwordx4 v2, s[8:11], s78 offen offset:1024 lds
    s_waitcnt lgkmcnt(8)
    v_mfma_f32_16x16x32_bf16 v[76:79], v[200:203], v[60:63], v[76:79]
    ds_read_b64_tr_b16 v[44:45], v13 offset:34816
    v_mfma_f32_16x16x32_bf16 v[92:95], v[204:207], v[60:63], v[92:95]
    ds_read_b64_tr_b16 v[46:47], v13 offset:35840
    ds_read_b128 v[216:219], v9 offset:32768
    ds_read_b128 v[220:223], v9 offset:36864
    v_xor_b32 v8, 0x10000, v8
    v_xor_b32 v9, 0x10000, v9
    s_waitcnt lgkmcnt(8)
    v_mfma_f32_16x16x32_bf16 v[64:67], v[208:211], v[32:35], v[64:67]
    ds_read_b64_tr_b16 v[48:49], v10 offset:51200
    v_mfma_f32_16x16x32_bf16 v[80:83], v[212:215], v[32:35], v[80:83]
    ds_read_b64_tr_b16 v[50:51], v10 offset:52224
    v_xor_b32 v10, 0x10000, v10
    s_waitcnt lgkmcnt(8)
    v_mfma_f32_16x16x32_bf16 v[68:71], v[208:211], v[36:39], v[68:71]
    ds_read_b64_tr_b16 v[52:53], v11 offset:51200
    v_mfma_f32_16x16x32_bf16 v[84:87], v[212:215], v[36:39], v[84:87]
    ds_read_b64_tr_b16 v[54:55], v11 offset:52224
    v_xor_b32 v11, 0x10000, v11
    s_add_u32 m0, s57, 34816
    s_mul_i32 s78, s88, 245760
    s_add_u32 s78, s78, s59
    buffer_load_dwordx4 v3, s[12:15], s78 offen lds
    s_waitcnt lgkmcnt(8)
    v_mfma_f32_16x16x32_bf16 v[72:75], v[208:211], v[40:43], v[72:75]
    ds_read_b64_tr_b16 v[56:57], v12 offset:51200
    v_mfma_f32_16x16x32_bf16 v[88:91], v[212:215], v[40:43], v[88:91]
    ds_read_b64_tr_b16 v[58:59], v12 offset:52224
    v_xor_b32 v12, 0x10000, v12
    s_add_u32 s88, s88, 1
    s_cmp_eq_u32 s88, 10
    s_cselect_b32 s88, 0, s88
    buffer_load_dwordx4 v4, s[12:15], s78 offen offset:1024 lds
    s_waitcnt lgkmcnt(8)
    v_mfma_f32_16x16x32_bf16 v[76:79], v[208:211], v[44:47], v[76:79]
    ds_read_b64_tr_b16 v[60:61], v13 offset:51200
    v_mfma_f32_16x16x32_bf16 v[92:95], v[212:215], v[44:47], v[92:95]
    ds_read_b64_tr_b16 v[62:63], v13 offset:52224
    v_xor_b32 v13, 0x10000, v13
    s_cmp_lg_u32 s48, 0
    s_cbranch_scc1 L_w0_35
    s_waitcnt vmcnt(8)
L_spin_36:
    v_cmp_le_u32 vcc, 8, v246
    s_nop 1
    s_cmp_eq_u64 vcc, -1
    s_cbranch_scc1 L_got_37
    s_add_u32 s96, s96, 1
    s_cmp_gt_u32 s96, 0x100000
    s_cbranch_scc1 L_got_37
    s_sleep 1
    buffer_load_dword v246, v244, s[92:95], 0 offen sc1
    s_waitcnt vmcnt(0)
    s_branch L_spin_36
L_got_37:
L_w0_35:
    s_waitcnt vmcnt(4)
    s_barrier
    ds_read_b128 v[224:227], v8 offset:0
    ds_read_b128 v[228:231], v8 offset:4096
    s_waitcnt lgkmcnt(8)
    v_mfma_f32_16x16x32_bf16 v[64:67], v[216:219], v[48:51], v[64:67]
    ds_read_b64_tr_b16 v[32:33], v10 offset:2048
    v_mfma_f32_16x16x32_bf16 v[80:83], v[220:223], v[48:51], v[80:83]
    ds_read_b64_tr_b16 v[34:35], v10 offset:3072
    s_waitcnt lgkmcnt(8)
    v_mfma_f32_16x16x32_bf16 v[68:71], v[216:219], v[52:55], v[68:71]
    ds_read_b64_tr_b16 v[36:37], v11 offset:2048
    v_mfma_f32_16x16x32_bf16 v[84:87], v[220:223], v[52:55], v[84:87]
    ds_read_b64_tr_b16 v[38:39], v11 offset:3072
    s_add_u32 m0, s79, 65536
    s_mul_i32 s78, s89, 196608
    s_add_u32 s78, s78, s80
    buffer_load_dwordx4 v5, s[16:19], s78 offen lds
    s_waitcnt lgkmcnt(8)
    v_mfma_f32_16x16x32_bf16 v[72:75], v[216:219], v[56:59], v[72:75]
    ds_read_b64_tr_b16 v[40:41], v12 offset:2048
    v_mfma_f32_16x16x32_bf16 v[88:91], v[220:223], v[56:59], v[88:91]
    ds_read_b64_tr_b16 v[42:43], v12 offset:3072
    s_add_u32 s89, s89, 2
    s_sub_u32 s87, s89, 10
    s_min_u32 s89, s89, s87
    buffer_load_dwordx4 v6, s[16:19], s78 offen offset:1024 lds
    s_waitcnt lgkmcnt(8)
    v_mfma_f32_16x16x32_bf16 v[76:79], v[216:219], v[60:63], v[76:79]
    ds_read_b64_tr_b16 v[44:45], v13 offset:2048
    v_mfma_f32_16x16x32_bf16 v[92:95], v[220:223], v[60:63], v[92:95]
    ds_read_b64_tr_b16 v[46:47], v13 offset:3072
    ds_read_b128 v[232:235], v9 offset:0
    ds_read_b128 v[236:239], v9 offset:4096
    s_waitcnt lgkmcnt(8)
    v_mfma_f32_16x16x32_bf16 v[64:67], v[224:227], v[32:35], v[64:67]
    ds_read_b64_tr_b16 v[48:49], v10 offset:18432
    v_mfma_f32_16x16x32_bf16 v[80:83], v[228:231], v[32:35], v[80:83]
    ds_read_b64_tr_b16 v[50:51], v10 offset:19456
    s_waitcnt lgkmcnt(8)
    v_mfma_f32_16x16x32_bf16 v[68:71], v[224:227], v[36:39], v[68:71]
    ds_read_b64_tr_b16 v[52:53], v11 offset:18432
    v_mfma_f32_16x16x32_bf16 v[84:87], v[228:231], v[36:39], v[84:87]
    ds_read_b64_tr_b16 v[54:55], v11 offset:19456
    buffer_load_dwordx4 v7, s[16:19], s78 offen offset:2048 lds
    s_waitcnt lgkmcnt(8)
    v_mfma_f32_16x16x32_bf16 v[72:75], v[224:227], v[40:43], v[72:75]
    ds_read_b64_tr_b16 v[56:57], v12 offset:18432
    v_mfma_f32_16x16x32_bf16 v[88:91], v[228:231], v[40:43], v[88:91]
    ds_read_b64_tr_b16 v[58:59], v12 offset:19456
    s_waitcnt lgkmcnt(8)
    v_mfma_f32_16x16x32_bf16 v[76:79], v[224:227], v[44:47], v[76:79]
    ds_read_b64_tr_b16 v[60:61], v13 offset:18432
    v_mfma_f32_16x16x32_bf16 v[92:95], v[228:231], v[44:47], v[92:95]
    ds_read_b64_tr_b16 v[62:63], v13 offset:19456
    s_waitcnt vmcnt(3)
    s_barrier
    ds_read_b128 v[240:243], v8 offset:32768
    ds_read_b128 v[244:247], v8 offset:36864
    s_waitcnt lgkmcnt(8)
    v_mfma_f32_16x16x32_bf16 v[64:67], v[232:235], v[48:51], v[64:67]
    ds_read_b64_tr_b16 v[32:33], v10 offset:34816
    v_mfma_f32_16x16x32_bf16 v[80:83], v[236:239], v[48:51], v[80:83]
    ds_read_b64_tr_b16 v[34:35], v10 offset:35840
    s_waitcnt lgkmcnt(8)
    v_mfma_f32_16x16x32_bf16 v[68:71], v[232:235], v[52:55], v[68:71]
    ds_read_b64_tr_b16 v[36:37], v11 offset:34816
    v_mfma_f32_16x16x32_bf16 v[84:87], v[236:239], v[52:55], v[84:87]
    ds_read_b64_tr_b16 v[38:39], v11 offset:35840
    s_add_u32 m0, s79, 98304
    s_mul_i32 s78, s89, 196608
    s_add_u32 s78, s78, s80
    buffer_load_dwordx4 v5, s[16:19], s78 offen lds
    s_waitcnt lgkmcnt(8)
    v_mfma_f32_16x16x32_bf16 v[72:75], v[232:235], v[56:59], v[72:75]
    ds_read_b64_tr_b16 v[40:41], v12 offset:34816
    v_mfma_f32_16x16x32_bf16 v[88:91], v[236:239], v[56:59], v[88:91]
    ds_read_b64_tr_b16 v[42:43], v12 offset:35840
    s_add_u32 s89, s89, 2
    s_sub_u32 s87, s89, 10
    s_min_u32 s89, s89, s87
    buffer_load_dwordx4 v6, s[16:19], s78 offen offset:1024 lds
    s_waitcnt lgkmcnt(8)
    v_mfma_f32_16x16x32_bf16 v[76:79], v[232:235], v[60:63], v[76:79]
    ds_read_b64_tr_b16 v[44:45], v13 offset:34816
    v_mfma_f32_16x16x32_bf16 v[92:95], v[236:239], v[60:63], v[92:95]
    ds_read_b64_tr_b16 v[46:47], v13 offset:35840
    ds_read_b128 v[248:251], v9 offset:32768
    ds_read_b128 v[252:255], v9 offset:36864
    s_waitcnt lgkmcnt(8)
    v_mfma_f32_16x16x32_bf16 v[64:67], v[240:243], v[32:35], v[64:67]
    ds_read_b64_tr_b16 v[48:49], v10 offset:51200
    v_mfma_f32_16x16x32_bf16 v[80:83], v[244:247], v[32:35], v[80:83]
    ds_read_b64_tr_b16 v[50:51], v10 offset:52224
    s_waitcnt lgkmcnt(8)
    v_mfma_f32_16x16x32_bf16 v[68:71], v[240:243], v[36:39], v[68:71]
    ds_read_b64_tr_b16 v[52:53], v11 offset:51200
    v_mfma_f32_16x16x32_bf16 v[84:87], v[244:247], v[36:39], v[84:87]
    ds_read_b64_tr_b16 v[54:55], v11 offset:52224
    buffer_load_dwordx4 v7, s[16:19], s78 offen offset:2048 lds
    s_waitcnt lgkmcnt(8)
    v_mfma_f32_16x16x32_bf16 v[72:75], v[240:243], v[40:43], v[72:75]
    ds_read_b64_tr_b16 v[56:57], v12 offset:51200
    v_mfma_f32_16x16x32_bf16 v[88:91], v[244:247], v[40:43], v[88:91]
    ds_read_b64_tr_b16 v[58:59], v12 offset:52224
    s_waitcnt lgkmcnt(8)
    v_mfma_f32_16x16x32_bf16 v[76:79], v[240:243], v[44:47], v[76:79]
    ds_read_b64_tr_b16 v[60:61], v13 offset:51200
    v_mfma_f32_16x16x32_bf16 v[92:95], v[244:247], v[44:47], v[92:95]
    ds_read_b64_tr_b16 v[62:63], v13 offset:52224
    s_waitcnt vmcnt(3)
    s_barrier
    s_waitcnt lgkmcnt(6)
    v_mfma_f32_16x16x32_bf16 v[64:67], v[248:251], v[48:51], v[64:67]
    ds_read_b64_tr_b16 v[32:33], v14 offset:0
    v_mfma_f32_16x16x32_bf16 v[80:83], v[252:255], v[48:51], v[80:83]
    ds_read_b64_tr_b16 v[34:35], v14 offset:1536
    s_waitcnt lgkmcnt(6)
    v_mfma_f32_16x16x32_bf16 v[68:71], v[248:251], v[52:55], v[68:71]
    ds_read_b64_tr_b16 v[36:37], v15 offset:0
    v_mfma_f32_16x16x32_bf16 v[84:87], v[252:255], v[52:55], v[84:87]
    ds_read_b64_tr_b16 v[38:39], v15 offset:1536
    s_add_u32 m0, s79, 0
    s_mul_i32 s78, s89, 196608
    s_add_u32 s78, s78, s80
    buffer_load_dwordx4 v5, s[16:19], s78 offen lds
    s_waitcnt lgkmcnt(6)
    v_mfma_f32_16x16x32_bf16 v[72:75], v[248:251], v[56:59], v[72:75]
    ds_read_b64_tr_b16 v[40:41], v16 offset:0
    v_mfma_f32_16x16x32_bf16 v[88:91], v[252:255], v[56:59], v[88:91]
    ds_read_b64_tr_b16 v[42:43], v16 offset:1536
    s_add_u32 s89, s89, 2
    s_sub_u32 s87, s89, 10
    s_min_u32 s89, s89, s87
    buffer_load_dwordx4 v6, s[16:19], s78 offen offset:1024 lds
    s_waitcnt lgkmcnt(6)
    v_mfma_f32_16x16x32_bf16 v[76:79], v[248:251], v[60:63], v[76:79]
    v_mfma_f32_16x16x32_bf16 v[92:95], v[252:255], v[60:63], v[92:95]
    buffer_load_dwordx4 v7, s[16:19], s78 offen offset:2048 lds
    s_nop 5
    v_cvt_pk_bf16_f32 v44, v64, v80
    v_cvt_pk_bf16_f32 v45, v65, v81
    v_cvt_pk_bf16_f32 v46, v66, v82
    v_cvt_pk_bf16_f32 v47, v67, v83
    buffer_store_dwordx4 v[44:47], v24, s[20:23], s81 offen sc1
    v_cvt_pk_bf16_f32 v60, v68, v84
    v_cvt_pk_bf16_f32 v61, v69, v85
    v_cvt_pk_bf16_f32 v62, v70, v86
    v_cvt_pk_bf16_f32 v63, v71, v87
    buffer_store_dwordx4 v[60:63], v25, s[20:23], s81 offen sc1
    v_cvt_pk_bf16_f32 v76, v76, v92
    v_cvt_pk_bf16_f32 v77, v77, v93
    v_cvt_pk_bf16_f32 v78, v78, v94
    v_cvt_pk_bf16_f32 v79, v79, v95
    v_cvt_pk_bf16_f32 v92, v72, v88
    v_cvt_pk_bf16_f32 v93, v73, v89
    v_cvt_pk_bf16_f32 v94, v74, v90
    v_cvt_pk_bf16_f32 v95, v75, v91
    s_branch L_join_6
L_xpass_5:
    s_mov_b32 m0, 151552
    v_lshrrev_b32 v10, 4, v0
    buffer_load_dwordx4 v36, s[28:31], 0 offen lds
    buffer_load_dword v37, s[28:31], 0 offen offset:1024 lds
    s_mov_b32 m0, 152832
    v_lshrrev_b32 v10, 4, v0
    buffer_load_dwordx4 v36, s[28:31], 0 offen lds
    buffer_load_dword v37, s[28:31], 0 offen offset:1024 lds
    s_lshl_b32 s51, s90, 7
    s_add_u32 s51, s51, 151552
    v_lshlrev_b32 v10, 4, v10
    v_add_u32 v10, s51, v10
    s_add_u32 s54, s49, 256
    s_lshr_b32 s55, s54, 2
    s_and_b32 s56, s54, 3
    s_mul_i32 s82, s56, 320
    s_cmp_ge_u32 s55, 48
    s_cselect_b32 s32, s36, s40
    s_cselect_b32 s33, s37, s41
    s_mov_b32 s34, 1966080
    s_cselect_b32 s34, 819200, s34
    s_mov_b32 s35, 0x00020000
    s_lshl_b32 s51, s55, 5
    s_mul_i32 s52, s55, 40
    s_sub_u32 s52, s52, 1920
    s_cmp_ge_u32 s55, 48
    s_cselect_b32 s51, s52, s51
    s_cselect_b32 s53, 20, 16
    s_mul_i32 s52, s55, 160
    s_sub_u32 s52, s52, 10224
    s_cmp_ge_u32 s55, 64
    s_cselect_b32 s51, s52, s51
    s_cselect_b32 s53, 80, s53
    s_cselect_b32 s52, 20, 4
    s_lshl_b32 s83, s48, 6
    v_add_u32 v40, s83, v0
    v_mul_u32_u24 v41, 3277, v40
    v_lshrrev_b32 v41, 16, v41
    v_mul_u32_u24 v42, 20, v41
    v_sub_u32 v42, v40, v42
    v_and_b32 v40, 3, v41
    v_bfe_u32 v43, v41, 2, 2
    v_mad_u32_u24 v40, v43, s52, v40
    v_lshrrev_b32 v43, 4, v41
    v_mad_u32_u24 v40, v43, s53, v40
    v_add_u32 v40, s51, v40
    v_mul_u32_u24 v40, 1280, v40
    v_lshl_add_u32 v84, v42, 4, v40
    v_add_u32 v40, s83, v0
    v_add_u32 v40, 512, v40
    v_mul_u32_u24 v41, 3277, v40
    v_lshrrev_b32 v41, 16, v41
    v_mul_u32_u24 v42, 20, v41
    v_sub_u32 v42, v40, v42
    v_and_b32 v40, 3, v41
    v_bfe_u32 v43, v41, 2, 2
    v_mad_u32_u24 v40, v43, s52, v40
    v_lshrrev_b32 v43, 4, v41
    v_mad_u32_u24 v40, v43, s53, v40
    v_add_u32 v40, s51, v40
    v_mul_u32_u24 v40, 1280, v40
    v_lshl_add_u32 v85, v42, 4, v40
    s_mul_i32 s51, s55, 43
    s_lshr_b32 s51, s51, 9
    s_mul_i32 s51, s51, 5
    s_add_u32 s51, s51, s55
    s_sub_u32 s52, s55, 48
    s_mul_i32 s53, s52, 52
    s_lshr_b32 s53, s53, 8
    s_mul_i32 s53, s53, 12
    s_add_u32 s52, s52, s53
    s_add_u32 s52, s52, 12
    s_cmp_ge_u32 s55, 48
    s_cselect_b32 s55, s52, s51
    s_mul_i32 s56, s56, 136
    s_add_u32 s55, s55, s56
    v_lshrrev_b32 v41, 4, v0
    v_bfe_u32 v42, v0, 2, 2
    v_lshl_add_u32 v41, v41, 3, v42
    v_mul_u32_u24 v41, 320, v41
    v_and_b32 v40, 3, v0
    s_add_u32 s51, s48, 0
    s_cmp_ge_u32 s51, 5
    s_cselect_b32 s52, 1, 0
    s_mul_i32 s53, s52, 5
    s_sub_u32 s51, s51, s53
    s_lshr_b32 s53, s51, 1
    s_lshl_b32 s53, s53, 6
    s_and_b32 s56, s51, 1
    s_lshl_b32 s56, s56, 3
    s_add_u32 s53, s53, s56
    s_mul_i32 s56, s52, 160
    s_add_u32 s53, s53, s56
    s_add_u32 s53, s53, 131072
    s_cmp_eq_u32 s51, 4
    s_cselect_b32 s56, 3, 4
    v_lshlrev_b32 v42, s56, v40
    v_add3_u32 v86, v42, v41, s53
    s_mul_i32 s52, s52, 68
    s_add_u32 s52, s52, s55
    s_mul_i32 s52, s52, 5120
    s_lshl_b32 s51, s51, 10
    s_add_u32 s52, s52, s51
    s_add_u32 s83, s52, 16777216
    s_add_u32 s51, s48, 8
    s_cmp_ge_u32 s51, 5
    s_cselect_b32 s52, 1, 0
    s_mul_i32 s53, s52, 5
    s_sub_u32 s51, s51, s53
    s_lshr_b32 s53, s51, 1
    s_lshl_b32 s53, s53, 6
    s_and_b32 s56, s51, 1
    s_lshl_b32 s56, s56, 3
    s_add_u32 s53, s53, s56
    s_mul_i32 s56, s52, 160
    s_add_u32 s53, s53, s56
    s_add_u32 s53, s53, 131072
    s_cmp_eq_u32 s51, 4
    s_cselect_b32 s56, 3, 4
    v_lshlrev_b32 v42, s56, v40
    v_add3_u32 v87, v42, v41, s53
    s_mul_i32 s52, s52, 68
    s_add_u32 s52, s52, s55
    s_mul_i32 s52, s52, 5120
    s_lshl_b32 s51, s51, 10
    s_add_u32 s52, s52, s51
    s_add_u32 s84, s52, 16777216
    s_lshl_b32 s51, s48, 10
    s_add_u32 m0, s51, 131072
    s_nop 0
    buffer_load_dwordx4 v84, s[32:35], s82 offen lds
    s_cmp_ge_u32 s48, 2
    s_cbranch_scc1 L_lt2_38
    s_add_u32 m0, s51, 139264
    s_nop 0
    buffer_load_dwordx4 v85, s[32:35], s82 offen lds
L_lt2_38:
    s_waitcnt vmcnt(1)
    s_barrier
    ds_read_b128 v[96:99], v8 offset:0
    ds_read_b128 v[100:103], v8 offset:4096
    ds_read_b128 v[32:35], v10 offset:0
    s_add_u32 m0, s57, 65536
    s_lshl_b32 s78, s88, 7
    s_add_u32 s78, s78, s58
    buffer_load_dwordx4 v1, s[8:11], s78 offen lds
    s_add_u32 s88, s88, 1
    s_cmp_eq_u32 s88, 10
    s_cselect_b32 s88, 0, s88
    buffer_load_dwordx4 v2, s[8:11], s78 offen offset:1024 lds
    ds_read_b128 v[104:107], v9 offset:0
    ds_read_b128 v[108:111], v9 offset:4096
    s_waitcnt lgkmcnt(2)
    v_mfma_f32_16x16x32_bf16 v[64:67], v[32:35], v[96:99], 0
    ds_read_b128 v[48:51], v10 offset:64
    v_mfma_f32_16x16x32_bf16 v[80:83], v[32:35], v[100:103], 0
    s_barrier
    ds_read_b128 v[112:115], v8 offset:32768
    ds_read_b128 v[116:119], v8 offset:36864
    s_waitcnt lgkmcnt(2)
    v_mfma_f32_16x16x32_bf16 v[64:67], v[48:51], v[104:107], v[64:67]
    ds_read_b128 v[32:35], v10 offset:128
    v_mfma_f32_16x16x32_bf16 v[80:83], v[48:51], v[108:111], v[80:83]
    s_add_u32 m0, s57, 98304
    s_lshl_b32 s78, s88, 7
    s_add_u32 s78, s78, s58
    buffer_load_dwordx4 v1, s[8:11], s78 offen lds
    s_add_u32 s88, s88, 1
    s_cmp_eq_u32 s88, 10
    s_cselect_b32 s88, 0, s88
    buffer_load_dwordx4 v2, s[8:11], s78 offen offset:1024 lds
    s_cmp_lg_u32 s48, 0
    s_cbranch_scc1 L_w0_39
    s_and_b32 s51, s2, 31
    s_lshl_b32 s51, s51, 2
    s_add_u32 s51, s51, 128
    v_mov_b32 v246, s51
    v_mov_b32 v247, 1
    s_mov_b64 exec, 1
    buffer_atomic_add v247, v246, s[92:95], 0 offen sc1
    s_mov_b64 exec, -1
L_w0_39:
    ds_read_b128 v[120:123], v9 offset:32768
    ds_read_b128 v[124:127], v9 offset:36864
    v_xor_b32 v8, 0x10000, v8
    v_xor_b32 v9, 0x10000, v9
    s_waitcnt lgkmcnt(2)
    v_mfma_f32_16x16x32_bf16 v[64:67], v[32:35], v[112:115], v[64:67]
    ds_read_b128 v[48:51], v10 offset:192
    v_mfma_f32_16x16x32_bf16 v[80:83], v[32:35], v[116:119], v[80:83]
    s_cmp_eq_u32 s48, 0
    s_cbranch_scc1 L_wv_40
    s_waitcnt vmcnt(2)
L_wv_40:
    s_waitcnt vmcnt(3)
    s_barrier
    ds_read_b128 v[128:131], v8 offset:0
    ds_read_b128 v[132:135], v8 offset:4096
    s_waitcnt lgkmcnt(2)
    v_mfma_f32_16x16x32_bf16 v[64:67], v[48:51], v[120:123], v[64:67]
    ds_read_b128 v[32:35], v10 offset:256
    v_mfma_f32_16x16x32_bf16 v[80:83], v[48:51], v[124:127], v[80:83]
    s_add_u32 m0, s57, 0
    s_lshl_b32 s78, s88, 7
    s_add_u32 s78, s78, s58
    buffer_load_dwordx4 v1, s[8:11], s78 offen lds
    s_add_u32 s88, s88, 1
    s_cmp_eq_u32 s88, 10
    s_cselect_b32 s88, 0, s88
    buffer_load_dwordx4 v2, s[8:11], s78 offen offset:1024 lds
    ds_read_b128 v[136:139], v9 offset:0
    ds_read_b128 v[140:143], v9 offset:4096
    s_waitcnt lgkmcnt(2)
    v_mfma_f32_16x16x32_bf16 v[64:67], v[32:35], v[128:131], v[64:67]
    ds_read_b128 v[48:51], v10 offset:320
    v_mfma_f32_16x16x32_bf16 v[80:83], v[32:35], v[132:135], v[80:83]
    s_cmp_eq_u32 s48, 0
    s_cbranch_scc1 L_wv_42
    s_waitcnt vmcnt(2)
L_wv_42:
    s_waitcnt vmcnt(3)
    s_barrier
    ds_read_b128 v[144:147], v8 offset:32768
    ds_read_b128 v[148:151], v8 offset:36864
    s_waitcnt lgkmcnt(2)
    v_mfma_f32_16x16x32_bf16 v[64:67], v[48:51], v[136:139], v[64:67]
    ds_read_b128 v[32:35], v10 offset:384
    v_mfma_f32_16x16x32_bf16 v[80:83], v[48:51], v[140:143], v[80:83]
    s_add_u32 m0, s57, 32768
    s_lshl_b32 s78, s88, 7
    s_add_u32 s78, s78, s58
    buffer_load_dwordx4 v1, s[8:11], s78 offen lds
    s_add_u32 s88, s88, 1
    s_cmp_eq_u32 s88, 10
    s_cselect_b32 s88, 0, s88
    buffer_load_dwordx4 v2, s[8:11], s78 offen offset:1024 lds
    ds_read_b128 v[152:155], v9 offset:32768
    ds_read_b128 v[156:159], v9 offset:36864
    v_xor_b32 v8, 0x10000, v8
    v_xor_b32 v9, 0x10000, v9
    s_waitcnt lgkmcnt(2)
    v_mfma_f32_16x16x32_bf16 v[64:67], v[32:35], v[144:147], v[64:67]
    ds_read_b128 v[48:51], v10 offset:448
    v_mfma_f32_16x16x32_bf16 v[80:83], v[32:35], v[148:151], v[80:83]
    s_waitcnt vmcnt(2)
    s_barrier
    ds_read_b128 v[160:163], v8 offset:0
    ds_read_b128 v[164:167], v8 offset:4096
    s_waitcnt lgkmcnt(2)
    v_mfma_f32_16x16x32_bf16 v[64:67], v[48:51], v[152:155], v[64:67]
    ds_read_b128 v[32:35], v10 offset:512
    v_mfma_f32_16x16x32_bf16 v[80:83], v[48:51], v[156:159], v[80:83]
    s_add_u32 m0, s57, 65536
    s_lshl_b32 s78, s88, 7
    s_add_u32 s78, s78, s58
    buffer_load_dwordx4 v1, s[8:11], s78 offen lds
    s_add_u32 s88, s88, 1
    s_cmp_eq_u32 s88, 10
    s_cselect_b32 s88, 0, s88
    buffer_load_dwordx4 v2, s[8:11], s78 offen offset:1024 lds
    ds_read_b128 v[168:171], v9 offset:0
    ds_read_b128 v[172:175], v9 offset:4096
    s_waitcnt lgkmcnt(2)
    v_mfma_f32_16x16x32_bf16 v[64:67], v[32:35], v[160:163], v[64:67]
    ds_read_b128 v[48:51], v10 offset:576
    v_mfma_f32_16x16x32_bf16 v[80:83], v[32:35], v[164:167], v[80:83]
    buffer_load_dword v254, v250, s[16:19], 0 offen
    s_waitcnt vmcnt(3)
    s_barrier
    ds_read_b128 v[176:179], v8 offset:32768
    ds_read_b128 v[180:183], v8 offset:36864
    s_waitcnt lgkmcnt(2)
    v_mfma_f32_16x16x32_bf16 v[64:67], v[48:51], v[168:171], v[64:67]
    ds_read_b128 v[32:35], v10 offset:640
    v_mfma_f32_16x16x32_bf16 v[80:83], v[48:51], v[172:175], v[80:83]
    s_add_u32 m0, s57, 98304
    s_lshl_b32 s78, s88, 7
    s_add_u32 s78, s78, s58
    buffer_load_dwordx4 v1, s[8:11], s78 offen lds
    s_add_u32 s88, s88, 1
    s_cmp_eq_u32 s88, 10
    s_cselect_b32 s88, 0, s88
    buffer_load_dwordx4 v2, s[8:11], s78 offen offset:1024 lds
    ds_read_b128 v[184:187], v9 offset:32768
    ds_read_b128 v[188:191], v9 offset:36864
    v_xor_b32 v8, 0x10000, v8
    v_xor_b32 v9, 0x10000, v9
    s_waitcnt lgkmcnt(2)
    v_mfma_f32_16x16x32_bf16 v[64:67], v[32:35], v[176:179], v[64:67]
    ds_read_b128 v[48:51], v10 offset:704
    v_mfma_f32_16x16x32_bf16 v[80:83], v[32:35], v[180:183], v[80:83]
    s_cmp_lg_u32 s48, 0
    s_cbranch_scc1 L_w0_44
    v_lshlrev_b32 v244, 2, v0
    v_or_b32 v244, 128, v244
    buffer_load_dword v246, v244, s[92:95], 0 offen sc1
L_w0_44:
    s_cmp_eq_u32 s48, 0
    s_cbranch_scc1 L_wv_45
    s_waitcnt vmcnt(3)
L_wv_45:
    s_waitcnt vmcnt(4)
    s_barrier
    ds_read_b128 v[192:195], v8 offset:0
    ds_read_b128 v[196:199], v8 offset:4096
    s_waitcnt lgkmcnt(2)
    v_mfma_f32_16x16x32_bf16 v[64:67], v[48:51], v[184:187], v[64:67]
    ds_read_b128 v[32:35], v10 offset:768
    v_mfma_f32_16x16x32_bf16 v[80:83], v[48:51], v[188:191], v[80:83]
    s_add_u32 m0, s57, 0
    s_lshl_b32 s78, s88, 7
    s_add_u32 s78, s78, s58
    buffer_load_dwordx4 v1, s[8:11], s78 offen lds
    s_add_u32 s88, s88, 1
    s_cmp_eq_u32 s88, 10
    s_cselect_b32 s88, 0, s88
    buffer_load_dwordx4 v2, s[8:11], s78 offen offset:1024 lds
    ds_read_b128 v[200:203], v9 offset:0
    ds_read_b128 v[204:207], v9 offset:4096
    s_waitcnt lgkmcnt(2)
    v_mfma_f32_16x16x32_bf16 v[64:67], v[32:35], v[192:195], v[64:67]
    ds_read_b128 v[48:51], v10 offset:832
    v_mfma_f32_16x16x32_bf16 v[80:83], v[32:35], v[196:199], v[80:83]
    s_cmp_eq_u32 s48, 0
    s_cbranch_scc1 L_wv_47
    s_waitcnt vmcnt(2)
L_wv_47:
    s_waitcnt vmcnt(3)
    s_barrier
    ds_read_b128 v[208:211], v8 offset:32768
    ds_read_b128 v[212:215], v8 offset:36864
    s_waitcnt lgkmcnt(2)
    v_mfma_f32_16x16x32_bf16 v[64:67], v[48:51], v[200:203], v[64:67]
    ds_read_b128 v[32:35], v10 offset:896
    v_mfma_f32_16x16x32_bf16 v[80:83], v[48:51], v[204:207], v[80:83]
    s_add_u32 m0, s57, 32768
    s_lshl_b32 s78, s88, 7
    s_add_u32 s78, s78, s58
    buffer_load_dwordx4 v1, s[8:11], s78 offen lds
    s_add_u32 s88, s88, 1
    s_cmp_eq_u32 s88, 10
    s_cselect_b32 s88, 0, s88
    buffer_load_dwordx4 v2, s[8:11], s78 offen offset:1024 lds
    ds_read_b128 v[216:219], v9 offset:32768
    ds_read_b128 v[220:223], v9 offset:36864
    v_xor_b32 v8, 0x10000, v8
    v_xor_b32 v9, 0x10000, v9
    s_waitcnt lgkmcnt(2)
    v_mfma_f32_16x16x32_bf16 v[64:67], v[32:35], v[208:211], v[64:67]
    ds_read_b128 v[48:51], v10 offset:960
    v_mfma_f32_16x16x32_bf16 v[80:83], v[32:35], v[212:215], v[80:83]
    s_cmp_lg_u32 s48, 0
    s_cbranch_scc1 L_w0_49
    s_waitcnt vmcnt(4)
L_spin_50:
    v_cmp_le_u32 vcc, 8, v246
    s_nop 1
    s_cmp_eq_u64 vcc, -1
    s_cbranch_scc1 L_got_51
    s_add_u32 s96, s96, 1
    s_cmp_gt_u32 s96, 0x100000
    s_cbranch_scc1 L_got_51
    s_sleep 1
    buffer_load_dword v246, v244, s[92:95], 0 offen sc1
    s_waitcnt vmcnt(0)
    s_branch L_spin_50
L_got_51:
L_w0_49:
    s_waitcnt vmcnt(2)
    s_barrier
    ds_read_b128 v[224:227], v8 offset:0
    ds_read_b128 v[228:231], v8 offset:4096
    s_waitcnt lgkmcnt(2)
    v_mfma_f32_16x16x32_bf16 v[64:67], v[48:51], v[216:219], v[64:67]
    ds_read_b128 v[32:35], v10 offset:1024
    v_mfma_f32_16x16x32_bf16 v[80:83], v[48:51], v[220:223], v[80:83]
    s_add_u32 m0, s79, 65536
    s_mul_i32 s78, s89, 196608
    s_add_u32 s78, s78, s80
    buffer_load_dwordx4 v5, s[16:19], s78 offen lds
    s_add_u32 s89, s89, 2
    s_sub_u32 s87, s89, 10
    s_min_u32 s89, s89, s87
    buffer_load_dwordx4 v6, s[16:19], s78 offen offset:1024 lds
    ds_read_b128 v[232:235], v9 offset:0
    ds_read_b128 v[236:239], v9 offset:4096
    s_waitcnt lgkmcnt(2)
    v_mfma_f32_16x16x32_bf16 v[64:67], v[32:35], v[224:227], v[64:67]
    ds_read_b128 v[48:51], v10 offset:1088
    v_mfma_f32_16x16x32_bf16 v[80:83], v[32:35], v[228:231], v[80:83]
    buffer_load_dwordx4 v7, s[16:19], s78 offen offset:2048 lds
    s_waitcnt vmcnt(3)
    s_barrier
    ds_read_b128 v[240:243], v8 offset:32768
    ds_read_b128 v[244:247], v8 offset:36864
    s_waitcnt lgkmcnt(2)
    v_mfma_f32_16x16x32_bf16 v[64:67], v[48:51], v[232:235], v[64:67]
    ds_read_b128 v[32:35], v10 offset:1152
    v_mfma_f32_16x16x32_bf16 v[80:83], v[48:51], v[236:239], v[80:83]
    s_add_u32 m0, s79, 98304
    s_mul_i32 s78, s89, 196608
    s_add_u32 s78, s78, s80
    buffer_load_dwordx4 v5, s[16:19], s78 offen lds
    s_add_u32 s89, s89, 2
    s_sub_u32 s87, s89, 10
    s_min_u32 s89, s89, s87
    buffer_load_dwordx4 v6, s[16:19], s78 offen offset:1024 lds
    ds_read_b128 v[248:251], v9 offset:32768
    ds_read_b128 v[252:255], v9 offset:36864
    s_waitcnt lgkmcnt(2)
    v_mfma_f32_16x16x32_bf16 v[64:67], v[32:35], v[240:243], v[64:67]
    ds_read_b128 v[48:51], v10 offset:1216
    v_mfma_f32_16x16x32_bf16 v[80:83], v[32:35], v[244:247], v[80:83]
    buffer_load_dwordx4 v7, s[16:19], s78 offen offset:2048 lds
    s_waitcnt vmcnt(3)
    s_barrier
    s_waitcnt lgkmcnt(0)
    v_mfma_f32_16x16x32_bf16 v[64:67], v[48:51], v[248:251], v[64:67]
    ds_read_b64_tr_b16 v[32:33], v14 offset:0
    v_mfma_f32_16x16x32_bf16 v[80:83], v[48:51], v[252:255], v[80:83]
    ds_read_b64_tr_b16 v[34:35], v14 offset:1536
    ds_read_b64_tr_b16 v[36:37], v15 offset:0
    ds_read_b64_tr_b16 v[38:39], v15 offset:1536
    s_add_u32 m0, s79, 0
    s_mul_i32 s78, s89, 196608
    s_add_u32 s78, s78, s80
    buffer_load_dwordx4 v5, s[16:19], s78 offen lds
    ds_read_b64_tr_b16 v[40:41], v16 offset:0
    ds_read_b64_tr_b16 v[42:43], v16 offset:1536
    s_add_u32 s89, s89, 2
    s_sub_u32 s87, s89, 10
    s_min_u32 s89, s89, s87
    buffer_load_dwordx4 v6, s[16:19], s78 offen offset:1024 lds
    buffer_load_dwordx4 v7, s[16:19], s78 offen offset:2048 lds
    s_nop 5
    s_mov_b32 vcc_lo, 0xffff0000
    s_mov_b32 vcc_hi, 0
    s_nop 4
    v_cndmask_b32 v64, v64, v80, vcc
    v_cvt_pk_bf16_f32 v64, v64, v64
    v_and_b32 v64, 0xffff0000, v64
    v_mul_f32 v64, 0xbfb8aa3b, v64
    v_exp_f32 v64, v64
    s_nop 0
    v_add_f32 v64, 1.0, v64
    v_rcp_f32 v64, v64
    s_nop 0
    v_cvt_pk_bf16_f32 v64, v64, v64
    v_and_b32 v76, 0xffff0000, v64
    s_and_b32 s51, s48, 3
    s_lshl_b32 s52, s49, 2
    s_add_u32 s51, s51, s52
    s_lshl_b32 s51, s51, 7
    s_add_u32 s51, s51, 19562496
    v_lshlrev_b32 v77, 2, v0
    s_mov_b32 exec_hi, 0
    buffer_store_dword v76, v77, s[20:23], s51 offen sc1
    s_mov_b32 exec_hi, -1
    v_lshlrev_b32 v78, 4, v0
    ds_read_b64_tr_b16 v[92:93], v86
    ds_read_b64_tr_b16 v[94:95], v86 offset:1280
    s_waitcnt lgkmcnt(0)
    buffer_store_dwordx4 v[92:95], v78, s[20:23], s83 offen sc1
    s_cmp_ge_u32 s48, 2
    s_cbranch_scc1 L_lt2_52
    ds_read_b64_tr_b16 v[92:93], v87
    ds_read_b64_tr_b16 v[94:95], v87 offset:1280
    s_waitcnt lgkmcnt(0)
    buffer_store_dwordx4 v[92:95], v78, s[20:23], s84 offen sc1
L_lt2_52:
    s_mov_b32 s54, s2
    s_lshr_b32 s55, s54, 2
    s_and_b32 s56, s54, 3
    s_mul_i32 s82, s56, 320
    s_cmp_ge_u32 s55, 48
    s_cselect_b32 s32, s36, s40
    s_cselect_b32 s33, s37, s41
    s_mov_b32 s34, 1966080
    s_cselect_b32 s34, 819200, s34
    s_mov_b32 s35, 0x00020000
    s_lshl_b32 s51, s55, 5
    s_mul_i32 s52, s55, 40
    s_sub_u32 s52, s52, 1920
    s_cmp_ge_u32 s55, 48
    s_cselect_b32 s51, s52, s51
    s_cselect_b32 s53, 20, 16
    s_mul_i32 s52, s55, 160
    s_sub_u32 s52, s52, 10224
    s_cmp_ge_u32 s55, 64
    s_cselect_b32 s51, s52, s51
    s_cselect_b32 s53, 80, s53
    s_cselect_b32 s52, 20, 4
    s_lshl_b32 s83, s48, 6
    v_add_u32 v78, s83, v0
    v_mul_u32_u24 v79, 3277, v78
    v_lshrrev_b32 v79, 16, v79
    v_mul_u32_u24 v92, 20, v79
    v_sub_u32 v92, v78, v92
    v_and_b32 v78, 3, v79
    v_bfe_u32 v93, v79, 2, 2
    v_mad_u32_u24 v78, v93, s52, v78
    v_lshrrev_b32 v93, 4, v79
    v_mad_u32_u24 v78, v93, s53, v78
    v_add_u32 v78, s51, v78
    v_mul_u32_u24 v78, 1280, v78
    v_lshl_add_u32 v28, v92, 4, v78
    v_add_u32 v78, s83, v0
    v_add_u32 v78, 512, v78
    v_mul_u32_u24 v79, 3277, v78
    v_lshrrev_b32 v79, 16, v79
    v_mul_u32_u24 v92, 20, v79
    v_sub_u32 v92, v78, v92
    v_and_b32 v78, 3, v79
    v_bfe_u32 v93, v79, 2, 2
    v_mad_u32_u24 v78, v93, s52, v78
    v_lshrrev_b32 v93, 4, v79
    v_mad_u32_u24 v78, v93, s53, v78
    v_add_u32 v78, s51, v78
    v_mul_u32_u24 v78, 1280, v78
    v_lshl_add_u32 v29, v92, 4, v78
    s_mul_i32 s51, s55, 43
    s_lshr_b32 s51, s51, 9
    s_mul_i32 s51, s51, 5
    s_add_u32 s51, s51, s55
    s_sub_u32 s52, s55, 48
    s_mul_i32 s53, s52, 52
    s_lshr_b32 s53, s53, 8
    s_mul_i32 s53, s53, 12
    s_add_u32 s52, s52, s53
    s_add_u32 s52, s52, 12
    s_cmp_ge_u32 s55, 48
    s_cselect_b32 s55, s52, s51
    s_mul_i32 s56, s56, 136
    s_add_u32 s55, s55, s56
    v_lshrrev_b32 v79, 4, v0
    v_bfe_u32 v92, v0, 2, 2
    v_lshl_add_u32 v79, v79, 3, v92
    v_mul_u32_u24 v79, 320, v79
    v_and_b32 v78, 3, v0
    s_add_u32 s51, s48, 0
    s_cmp_ge_u32 s51, 5
    s_cselect_b32 s52, 1, 0
    s_mul_i32 s53, s52, 5
    s_sub_u32 s51, s51, s53
    s_lshr_b32 s53, s51, 1
    s_lshl_b32 s53, s53, 6
    s_and_b32 s56, s51, 1
    s_lshl_b32 s56, s56, 3
    s_add_u32 s53, s53, s56
    s_mul_i32 s56, s52, 160
    s_add_u32 s53, s53, s56
    s_add_u32 s53, s53, 92160
    s_cmp_eq_u32 s51, 4
    s_cselect_b32 s56, 3, 4
    v_lshlrev_b32 v92, s56, v78
    v_add3_u32 v30, v92, v79, s53
    s_mul_i32 s52, s52, 68
    s_add_u32 s52, s52, s55
    s_mul_i32 s52, s52, 5120
    s_lshl_b32 s51, s51, 10
    s_add_u32 s52, s52, s51
    s_add_u32 s83, s52, 16777216
    s_add_u32 s51, s48, 8
    s_cmp_ge_u32 s51, 5
    s_cselect_b32 s52, 1, 0
    s_mul_i32 s53, s52, 5
    s_sub_u32 s51, s51, s53
    s_lshr_b32 s53, s51, 1
    s_lshl_b32 s53, s53, 6
    s_and_b32 s56, s51, 1
    s_lshl_b32 s56, s56, 3
    s_add_u32 s53, s53, s56
    s_mul_i32 s56, s52, 160
    s_add_u32 s53, s53, s56
    s_add_u32 s53, s53, 92160
    s_cmp_eq_u32 s51, 4
    s_cselect_b32 s56, 3, 4
    v_lshlrev_b32 v92, s56, v78
    v_add3_u32 v31, v92, v79, s53
    s_mul_i32 s52, s52, 68
    s_add_u32 s52, s52, s55
    s_mul_i32 s52, s52, 5120
    s_lshl_b32 s51, s51, 10
    s_add_u32 s52, s52, s51
    s_add_u32 s84, s52, 16777216
L_join_6:
    s_nop 1
    v_lshlrev_b32 v64, 16, v18
    v_mov_b32 v80, v64
    v_and_b32 v65, 0xffff0000, v18
    v_mov_b32 v81, v65
    v_lshlrev_b32 v66, 16, v19
    v_mov_b32 v82, v66
    v_and_b32 v67, 0xffff0000, v19
    v_mov_b32 v83, v67
    v_lshlrev_b32 v68, 16, v20
    v_mov_b32 v84, v68
    v_and_b32 v69, 0xffff0000, v20
    v_mov_b32 v85, v69
    v_lshlrev_b32 v70, 16, v21
    v_mov_b32 v86, v70
    v_and_b32 v71, 0xffff0000, v21
    v_mov_b32 v87, v71
    v_lshlrev_b32 v72, 16, v22
    v_mov_b32 v88, v72
    v_and_b32 v73, 0xffff0000, v22
    v_mov_b32 v89, v73
    v_lshlrev_b32 v74, 16, v23
    v_mov_b32 v90, v74
    v_and_b32 v75, 0xffff0000, v23
    v_mov_b32 v91, v75
    s_waitcnt lgkmcnt(4)
    v_mfma_f32_16x16x32_bf16 v[64:67], v[32:35], v[96:99], v[64:67]
    ds_read_b64_tr_b16 v[48:49], v14 offset:6144
    v_mfma_f32_16x16x32_bf16 v[80:83], v[32:35], v[100:103], v[80:83]
    ds_read_b64_tr_b16 v[50:51], v14 offset:7680
    s_waitcnt lgkmcnt(4)
    v_mfma_f32_16x16x32_bf16 v[68:71], v[36:39], v[96:99], v[68:71]
    ds_read_b64_tr_b16 v[52:53], v15 offset:6144
    v_mfma_f32_16x16x32_bf16 v[84:87], v[36:39], v[100:103], v[84:87]
    ds_read_b64_tr_b16 v[54:55], v15 offset:7680
    s_cmp_eq_u32 s50, 15
    s_cbranch_scc1 L_ls_53
    buffer_store_dwordx4 v[76:79], v27, s[20:23], s81 offen sc1
L_ls_53:
    s_waitcnt lgkmcnt(4)
    v_mfma_f32_16x16x32_bf16 v[72:75], v[40:43], v[96:99], v[72:75]
    ds_read_b64_tr_b16 v[56:57], v16 offset:6144
    v_mfma_f32_16x16x32_bf16 v[88:91], v[40:43], v[100:103], v[88:91]
    ds_read_b64_tr_b16 v[58:59], v16 offset:7680
    s_waitcnt lgkmcnt(4)
    v_mfma_f32_16x16x32_bf16 v[64:67], v[48:51], v[104:107], v[64:67]
    ds_read_b64_tr_b16 v[32:33], v14 offset:12288
    v_mfma_f32_16x16x32_bf16 v[80:83], v[48:51], v[108:111], v[80:83]
    ds_read_b64_tr_b16 v[34:35], v14 offset:13824
    s_waitcnt lgkmcnt(4)
    v_mfma_f32_16x16x32_bf16 v[68:71], v[52:55], v[104:107], v[68:71]
    ds_read_b64_tr_b16 v[36:37], v15 offset:12288
    v_mfma_f32_16x16x32_bf16 v[84:87], v[52:55], v[108:111], v[84:87]
    ds_read_b64_tr_b16 v[38:39], v15 offset:13824
    s_cmp_eq_u32 s50, 15
    s_cbranch_scc1 L_ls_54
    buffer_store_dwordx4 v[92:95], v26, s[20:23], s81 offen sc1
L_ls_54:
    s_waitcnt lgkmcnt(4)
    v_mfma_f32_16x16x32_bf16 v[72:75], v[56:59], v[104:107], v[72:75]
    ds_read_b64_tr_b16 v[40:41], v16 offset:12288
    v_mfma_f32_16x16x32_bf16 v[88:91], v[56:59], v[108:111], v[88:91]
    ds_read_b64_tr_b16 v[42:43], v16 offset:13824
    s_waitcnt lgkmcnt(4)
    v_mfma_f32_16x16x32_bf16 v[64:67], v[32:35], v[112:115], v[64:67]
    ds_read_b64_tr_b16 v[48:49], v14 offset:18432
    v_mfma_f32_16x16x32_bf16 v[80:83], v[32:35], v[116:119], v[80:83]
    ds_read_b64_tr_b16 v[50:51], v14 offset:19968
    s_waitcnt lgkmcnt(4)
    v_mfma_f32_16x16x32_bf16 v[68:71], v[36:39], v[112:115], v[68:71]
    ds_read_b64_tr_b16 v[52:53], v15 offset:18432
    v_mfma_f32_16x16x32_bf16 v[84:87], v[36:39], v[116:119], v[84:87]
    ds_read_b64_tr_b16 v[54:55], v15 offset:19968
    s_waitcnt lgkmcnt(4)
    v_mfma_f32_16x16x32_bf16 v[72:75], v[40:43], v[112:115], v[72:75]
    ds_read_b64_tr_b16 v[56:57], v16 offset:18432
    v_mfma_f32_16x16x32_bf16 v[88:91], v[40:43], v[116:119], v[88:91]
    ds_read_b64_tr_b16 v[58:59], v16 offset:19968
    s_waitcnt vmcnt(3)
    s_barrier
    s_waitcnt lgkmcnt(4)
    v_mfma_f32_16x16x32_bf16 v[64:67], v[48:51], v[120:123], v[64:67]
    ds_read_b64_tr_b16 v[32:33], v14 offset:32768
    v_mfma_f32_16x16x32_bf16 v[80:83], v[48:51], v[124:127], v[80:83]
    ds_read_b64_tr_b16 v[34:35], v14 offset:34304
    s_waitcnt lgkmcnt(4)
    v_mfma_f32_16x16x32_bf16 v[68:71], v[52:55], v[120:123], v[68:71]
    ds_read_b64_tr_b16 v[36:37], v15 offset:32768
    v_mfma_f32_16x16x32_bf16 v[84:87], v[52:55], v[124:127], v[84:87]
    ds_read_b64_tr_b16 v[38:39], v15 offset:34304
    s_add_u32 m0, s79, 32768
    s_mul_i32 s78, s89, 196608
    s_add_u32 s78, s78, s80
    buffer_load_dwordx4 v5, s[16:19], s78 offen lds
    s_waitcnt lgkmcnt(4)
    v_mfma_f32_16x16x32_bf16 v[72:75], v[56:59], v[120:123], v[72:75]
    ds_read_b64_tr_b16 v[40:41], v16 offset:32768
    v_mfma_f32_16x16x32_bf16 v[88:91], v[56:59], v[124:127], v[88:91]
    ds_read_b64_tr_b16 v[42:43], v16 offset:34304
    s_add_u32 s89, s89, 2
    s_sub_u32 s87, s89, 10
    s_min_u32 s89, s89, s87
    buffer_load_dwordx4 v6, s[16:19], s78 offen offset:1024 lds
    s_waitcnt lgkmcnt(4)
    v_mfma_f32_16x16x32_bf16 v[64:67], v[32:35], v[128:131], v[64:67]
    ds_read_b64_tr_b16 v[48:49], v14 offset:38912
    v_mfma_f32_16x16x32_bf16 v[80:83], v[32:35], v[132:135], v[80:83]
    ds_read_b64_tr_b16 v[50:51], v14 offset:40448
    s_waitcnt lgkmcnt(4)
    v_mfma_f32_16x16x32_bf16 v[68:71], v[36:39], v[128:131], v[68:71]
    ds_read_b64_tr_b16 v[52:53], v15 offset:38912
    v_mfma_f32_16x16x32_bf16 v[84:87], v[36:39], v[132:135], v[84:87]
    ds_read_b64_tr_b16 v[54:55], v15 offset:40448
    s_waitcnt vmcnt(2)
    v_mov_b32 v92, 163832
    v_mov_b32 v93, 1
    s_mov_b64 exec, 1
    ds_add_rtn_u32 v94, v92, v93
    s_mov_b64 exec, -1
    s_waitcnt lgkmcnt(0)
    v_readfirstlane_b32 s51, v94
    v_mov_b32 v92, 0
    s_nop 2
    s_cmp_lg_u32 s51, 7
    s_cbranch_scc1 L_pub_55
    s_lshl_b32 s51, s2, 7
    s_add_u32 s51, s51, 19570688
    s_mov_b64 exec, 1
    buffer_store_dword v93, v92, s[20:23], s51 offen sc1
    s_mov_b64 exec, -1
L_pub_55:
    v_mfma_f32_16x16x32_bf16 v[72:75], v[40:43], v[128:131], v[72:75]
    ds_read_b64_tr_b16 v[56:57], v16 offset:38912
    v_mfma_f32_16x16x32_bf16 v[88:91], v[40:43], v[132:135], v[88:91]
    ds_read_b64_tr_b16 v[58:59], v16 offset:40448
    buffer_load_dwordx4 v7, s[16:19], s78 offen offset:2048 lds
    v_mfma_f32_16x16x32_bf16 v[64:67], v[48:51], v[136:139], v[64:67]
    ds_read_b64_tr_b16 v[32:33], v14 offset:45056
    v_mfma_f32_16x16x32_bf16 v[80:83], v[48:51], v[140:143], v[80:83]
    ds_read_b64_tr_b16 v[34:35], v14 offset:46592
    v_mfma_f32_16x16x32_bf16 v[68:71], v[52:55], v[136:139], v[68:71]
    ds_read_b64_tr_b16 v[36:37], v15 offset:45056
    v_mfma_f32_16x16x32_bf16 v[84:87], v[52:55], v[140:143], v[84:87]
    ds_read_b64_tr_b16 v[38:39], v15 offset:46592
    s_waitcnt lgkmcnt(4)
    v_mfma_f32_16x16x32_bf16 v[72:75], v[56:59], v[136:139], v[72:75]
    ds_read_b64_tr_b16 v[40:41], v16 offset:45056
    v_mfma_f32_16x16x32_bf16 v[88:91], v[56:59], v[140:143], v[88:91]
    ds_read_b64_tr_b16 v[42:43], v16 offset:46592
    s_waitcnt lgkmcnt(4)
    v_mfma_f32_16x16x32_bf16 v[64:67], v[32:35], v[144:147], v[64:67]
    ds_read_b64_tr_b16 v[48:49], v14 offset:51200
    v_mfma_f32_16x16x32_bf16 v[80:83], v[32:35], v[148:151], v[80:83]
    ds_read_b64_tr_b16 v[50:51], v14 offset:52736
    v_xor_b32 v14, 0x10000, v14
    s_waitcnt lgkmcnt(4)
    v_mfma_f32_16x16x32_bf16 v[68:71], v[36:39], v[144:147], v[68:71]
    ds_read_b64_tr_b16 v[52:53], v15 offset:51200
    v_mfma_f32_16x16x32_bf16 v[84:87], v[36:39], v[148:151], v[84:87]
    ds_read_b64_tr_b16 v[54:55], v15 offset:52736
    v_xor_b32 v15, 0x10000, v15
    s_waitcnt lgkmcnt(4)
    v_mfma_f32_16x16x32_bf16 v[72:75], v[40:43], v[144:147], v[72:75]
    ds_read_b64_tr_b16 v[56:57], v16 offset:51200
    v_mfma_f32_16x16x32_bf16 v[88:91], v[40:43], v[148:151], v[88:91]
    ds_read_b64_tr_b16 v[58:59], v16 offset:52736
    v_xor_b32 v16, 0x10000, v16
    s_barrier
    s_waitcnt lgkmcnt(4)
    v_mfma_f32_16x16x32_bf16 v[64:67], v[48:51], v[152:155], v[64:67]
    ds_read_b64_tr_b16 v[32:33], v14 offset:0
    v_mfma_f32_16x16x32_bf16 v[80:83], v[48:51], v[156:159], v[80:83]
    ds_read_b64_tr_b16 v[34:35], v14 offset:1536
    s_waitcnt lgkmcnt(4)
    v_mfma_f32_16x16x32_bf16 v[68:71], v[52:55], v[152:155], v[68:71]
    ds_read_b64_tr_b16 v[36:37], v15 offset:0
    v_mfma_f32_16x16x32_bf16 v[84:87], v[52:55], v[156:159], v[84:87]
    ds_read_b64_tr_b16 v[38:39], v15 offset:1536
    s_add_u32 m0, s79, 65536
    s_mul_i32 s78, s89, 196608
    s_add_u32 s78, s78, s80
    buffer_load_dwordx4 v5, s[16:19], s78 offen lds
    s_waitcnt lgkmcnt(4)
    v_mfma_f32_16x16x32_bf16 v[72:75], v[56:59], v[152:155], v[72:75]
    ds_read_b64_tr_b16 v[40:41], v16 offset:0
    v_mfma_f32_16x16x32_bf16 v[88:91], v[56:59], v[156:159], v[88:91]
    ds_read_b64_tr_b16 v[42:43], v16 offset:1536
    s_add_u32 s89, s89, 2
    s_sub_u32 s87, s89, 10
    s_min_u32 s89, s89, s87
    buffer_load_dwordx4 v6, s[16:19], s78 offen offset:1024 lds
    s_waitcnt lgkmcnt(4)
    v_mfma_f32_16x16x32_bf16 v[64:67], v[32:35], v[160:163], v[64:67]
    ds_read_b64_tr_b16 v[48:49], v14 offset:6144
    v_mfma_f32_16x16x32_bf16 v[80:83], v[32:35], v[164:167], v[80:83]
    ds_read_b64_tr_b16 v[50:51], v14 offset:7680
    s_waitcnt lgkmcnt(4)
    v_mfma_f32_16x16x32_bf16 v[68:71], v[36:39], v[160:163], v[68:71]
    ds_read_b64_tr_b16 v[52:53], v15 offset:6144
    v_mfma_f32_16x16x32_bf16 v[84:87], v[36:39], v[164:167], v[84:87]
    ds_read_b64_tr_b16 v[54:55], v15 offset:7680
    buffer_load_dwordx4 v7, s[16:19], s78 offen offset:2048 lds
    s_waitcnt lgkmcnt(4)
    v_mfma_f32_16x16x32_bf16 v[72:75], v[40:43], v[160:163], v[72:75]
    ds_read_b64_tr_b16 v[56:57], v16 offset:6144
    v_mfma_f32_16x16x32_bf16 v[88:91], v[40:43], v[164:167], v[88:91]
    ds_read_b64_tr_b16 v[58:59], v16 offset:7680
    s_waitcnt lgkmcnt(4)
    v_mfma_f32_16x16x32_bf16 v[64:67], v[48:51], v[168:171], v[64:67]
    ds_read_b64_tr_b16 v[32:33], v14 offset:12288
    v_mfma_f32_16x16x32_bf16 v[80:83], v[48:51], v[172:175], v[80:83]
    ds_read_b64_tr_b16 v[34:35], v14 offset:13824
    s_waitcnt lgkmcnt(4)
    v_mfma_f32_16x16x32_bf16 v[68:71], v[52:55], v[168:171], v[68:71]
    ds_read_b64_tr_b16 v[36:37], v15 offset:12288
    v_mfma_f32_16x16x32_bf16 v[84:87], v[52:55], v[172:175], v[84:87]
    ds_read_b64_tr_b16 v[38:39], v15 offset:13824
    s_waitcnt lgkmcnt(4)
    v_mfma_f32_16x16x32_bf16 v[72:75], v[56:59], v[168:171], v[72:75]
    ds_read_b64_tr_b16 v[40:41], v16 offset:12288
    v_mfma_f32_16x16x32_bf16 v[88:91], v[56:59], v[172:175], v[88:91]
    ds_read_b64_tr_b16 v[42:43], v16 offset:13824
    s_waitcnt lgkmcnt(4)
    v_mfma_f32_16x16x32_bf16 v[64:67], v[32:35], v[176:179], v[64:67]
    ds_read_b64_tr_b16 v[48:49], v14 offset:18432
    v_mfma_f32_16x16x32_bf16 v[80:83], v[32:35], v[180:183], v[80:83]
    ds_read_b64_tr_b16 v[50:51], v14 offset:19968
    s_waitcnt lgkmcnt(4)
    v_mfma_f32_16x16x32_bf16 v[68:71], v[36:39], v[176:179], v[68:71]
    ds_read_b64_tr_b16 v[52:53], v15 offset:18432
    v_mfma_f32_16x16x32_bf16 v[84:87], v[36:39], v[180:183], v[84:87]
    ds_read_b64_tr_b16 v[54:55], v15 offset:19968
    s_waitcnt lgkmcnt(4)
    v_mfma_f32_16x16x32_bf16 v[72:75], v[40:43], v[176:179], v[72:75]
    ds_read_b64_tr_b16 v[56:57], v16 offset:18432
    v_mfma_f32_16x16x32_bf16 v[88:91], v[40:43], v[180:183], v[88:91]
    ds_read_b64_tr_b16 v[58:59], v16 offset:19968
    s_waitcnt vmcnt(3)
    s_barrier
    s_waitcnt lgkmcnt(4)
    v_mfma_f32_16x16x32_bf16 v[64:67], v[48:51], v[184:187], v[64:67]
    ds_read_b64_tr_b16 v[32:33], v14 offset:32768
    v_mfma_f32_16x16x32_bf16 v[80:83], v[48:51], v[188:191], v[80:83]
    ds_read_b64_tr_b16 v[34:35], v14 offset:34304
    s_waitcnt lgkmcnt(4)
    v_mfma_f32_16x16x32_bf16 v[68:71], v[52:55], v[184:187], v[68:71]
    ds_read_b64_tr_b16 v[36:37], v15 offset:32768
    v_mfma_f32_16x16x32_bf16 v[84:87], v[52:55], v[188:191], v[84:87]
    ds_read_b64_tr_b16 v[38:39], v15 offset:34304
    s_waitcnt lgkmcnt(4)
    v_mfma_f32_16x16x32_bf16 v[72:75], v[56:59], v[184:187], v[72:75]
    ds_read_b64_tr_b16 v[40:41], v16 offset:32768
    v_mfma_f32_16x16x32_bf16 v[88:91], v[56:59], v[188:191], v[88:91]
    ds_read_b64_tr_b16 v[42:43], v16 offset:34304
    s_waitcnt lgkmcnt(4)
    v_mfma_f32_16x16x32_bf16 v[64:67], v[32:35], v[192:195], v[64:67]
    ds_read_b64_tr_b16 v[48:49], v14 offset:38912
    v_mfma_f32_16x16x32_bf16 v[80:83], v[32:35], v[196:199], v[80:83]
    ds_read_b64_tr_b16 v[50:51], v14 offset:40448
    s_waitcnt lgkmcnt(4)
    v_mfma_f32_16x16x32_bf16 v[68:71], v[36:39], v[192:195], v[68:71]
    ds_read_b64_tr_b16 v[52:53], v15 offset:38912
    v_mfma_f32_16x16x32_bf16 v[84:87], v[36:39], v[196:199], v[84:87]
    ds_read_b64_tr_b16 v[54:55], v15 offset:40448
    s_waitcnt lgkmcnt(4)
    v_mfma_f32_16x16x32_bf16 v[72:75], v[40:43], v[192:195], v[72:75]
    ds_read_b64_tr_b16 v[56:57], v16 offset:38912
    v_mfma_f32_16x16x32_bf16 v[88:91], v[40:43], v[196:199], v[88:91]
    ds_read_b64_tr_b16 v[58:59], v16 offset:40448
    s_waitcnt lgkmcnt(4)
    v_mfma_f32_16x16x32_bf16 v[64:67], v[48:51], v[200:203], v[64:67]
    ds_read_b64_tr_b16 v[32:33], v14 offset:45056
    v_mfma_f32_16x16x32_bf16 v[80:83], v[48:51], v[204:207], v[80:83]
    ds_read_b64_tr_b16 v[34:35], v14 offset:46592
    s_waitcnt lgkmcnt(4)
    v_mfma_f32_16x16x32_bf16 v[68:71], v[52:55], v[200:203], v[68:71]
    ds_read_b64_tr_b16 v[36:37], v15 offset:45056
    v_mfma_f32_16x16x32_bf16 v[84:87], v[52:55], v[204:207], v[84:87]
    ds_read_b64_tr_b16 v[38:39], v15 offset:46592
    s_waitcnt lgkmcnt(4)
    v_mfma_f32_16x16x32_bf16 v[72:75], v[56:59], v[200:203], v[72:75]
    ds_read_b64_tr_b16 v[40:41], v16 offset:45056
    v_mfma_f32_16x16x32_bf16 v[88:91], v[56:59], v[204:207], v[88:91]
    ds_read_b64_tr_b16 v[42:43], v16 offset:46592
    s_waitcnt lgkmcnt(4)
    v_mfma_f32_16x16x32_bf16 v[64:67], v[32:35], v[208:211], v[64:67]
    ds_read_b64_tr_b16 v[48:49], v14 offset:51200
    v_mfma_f32_16x16x32_bf16 v[80:83], v[32:35], v[212:215], v[80:83]
    ds_read_b64_tr_b16 v[50:51], v14 offset:52736
    v_xor_b32 v14, 0x10000, v14
    s_waitcnt lgkmcnt(4)
    v_mfma_f32_16x16x32_bf16 v[68:71], v[36:39], v[208:211], v[68:71]
    ds_read_b64_tr_b16 v[52:53], v15 offset:51200
    v_mfma_f32_16x16x32_bf16 v[84:87], v[36:39], v[212:215], v[84:87]
    ds_read_b64_tr_b16 v[54:55], v15 offset:52736
    v_xor_b32 v15, 0x10000, v15
    s_waitcnt lgkmcnt(4)
    v_mfma_f32_16x16x32_bf16 v[72:75], v[40:43], v[208:211], v[72:75]
    ds_read_b64_tr_b16 v[56:57], v16 offset:51200
    v_mfma_f32_16x16x32_bf16 v[88:91], v[40:43], v[212:215], v[88:91]
    ds_read_b64_tr_b16 v[58:59], v16 offset:52736
    v_xor_b32 v16, 0x10000, v16
    s_waitcnt vmcnt(0)
    s_barrier
    s_waitcnt lgkmcnt(4)
    v_mfma_f32_16x16x32_bf16 v[64:67], v[48:51], v[216:219], v[64:67]
    ds_read_b64_tr_b16 v[32:33], v14 offset:0
    v_mfma_f32_16x16x32_bf16 v[80:83], v[48:51], v[220:223], v[80:83]
    ds_read_b64_tr_b16 v[34:35], v14 offset:1536
    s_waitcnt lgkmcnt(4)
    v_mfma_f32_16x16x32_bf16 v[68:71], v[52:55], v[216:219], v[68:71]
    ds_read_b64_tr_b16 v[36:37], v15 offset:0
    v_mfma_f32_16x16x32_bf16 v[84:87], v[52:55], v[220:223], v[84:87]
    ds_read_b64_tr_b16 v[38:39], v15 offset:1536
    s_waitcnt lgkmcnt(4)
    v_mfma_f32_16x16x32_bf16 v[72:75], v[56:59], v[216:219], v[72:75]
    ds_read_b64_tr_b16 v[40:41], v16 offset:0
    v_mfma_f32_16x16x32_bf16 v[88:91], v[56:59], v[220:223], v[88:91]
    ds_read_b64_tr_b16 v[42:43], v16 offset:1536
    s_waitcnt lgkmcnt(4)
    v_mfma_f32_16x16x32_bf16 v[64:67], v[32:35], v[224:227], v[64:67]
    ds_read_b64_tr_b16 v[48:49], v14 offset:6144
    v_mfma_f32_16x16x32_bf16 v[80:83], v[32:35], v[228:231], v[80:83]
    ds_read_b64_tr_b16 v[50:51], v14 offset:7680
    s_waitcnt lgkmcnt(4)
    v_mfma_f32_16x16x32_bf16 v[68:71], v[36:39], v[224:227], v[68:71]
    ds_read_b64_tr_b16 v[52:53], v15 offset:6144
    v_mfma_f32_16x16x32_bf16 v[84:87], v[36:39], v[228:231], v[84:87]
    ds_read_b64_tr_b16 v[54:55], v15 offset:7680
    s_cmp_lg_u32 s48, 0
    s_cbranch_scc1 L_w0_56
    s_lshl_b32 s54, s61, 2
    s_add_u32 s54, s54, s63
    s_mul_i32 s54, s54, 20
    s_add_u32 s55, s54, 19
    s_lshr_b32 s54, s54, 7
    s_lshr_b32 s55, s55, 7
    s_sub_u32 s55, s55, s54
    v_bfe_u32 v218, v0, 4, 1
    v_mul_u32_u24 v218, s55, v218
    v_lshrrev_b32 v219, 5, v0
    v_mad_u32_u24 v218, v219, 5, v218
    v_add3_u32 v218, v218, s54, 5
    v_and_b32 v219, 15, v0
    v_lshrrev_b32 v220, 3, v219
    v_lshrrev_b32 v221, 2, v218
    v_lshl_add_u32 v220, v221, 1, v220
    v_and_b32 v219, 7, v219
    v_lshl_add_u32 v220, v219, 3, v220
    v_and_b32 v218, 3, v218
    v_lshl_add_u32 v220, v218, 6, v220
    v_lshlrev_b32 v216, 7, v220
    v_and_b32 v218, 1, v0
    v_mul_u32_u24 v218, s55, v218
    v_add_u32 v218, s54, v218
    v_bfe_u32 v219, v0, 1, 1
    s_lshl_b32 s56, s62, 1
    v_add_u32 v219, s56, v219
    v_lshrrev_b32 v220, 3, v219
    v_lshrrev_b32 v221, 2, v218
    v_lshl_add_u32 v220, v221, 1, v220
    v_and_b32 v219, 7, v219
    v_lshl_add_u32 v220, v219, 3, v220
    v_and_b32 v218, 3, v218
    v_lshl_add_u32 v220, v218, 6, v220
    v_lshlrev_b32 v217, 7, v220
    s_mov_b32 s56, 19570688
    buffer_load_dword v218, v216, s[20:23], s56 offen sc1
    s_mov_b32 s56, 19570688
    buffer_load_dword v219, v217, s[20:23], s56 offen sc1
L_w0_56:
    s_waitcnt lgkmcnt(4)
    v_mfma_f32_16x16x32_bf16 v[72:75], v[40:43], v[224:227], v[72:75]
    ds_read_b64_tr_b16 v[56:57], v16 offset:6144
    v_mfma_f32_16x16x32_bf16 v[88:91], v[40:43], v[228:231], v[88:91]
    ds_read_b64_tr_b16 v[58:59], v16 offset:7680
    s_waitcnt lgkmcnt(4)
    v_mfma_f32_16x16x32_bf16 v[64:67], v[48:51], v[232:235], v[64:67]
    ds_read_b64_tr_b16 v[32:33], v14 offset:12288
    v_mfma_f32_16x16x32_bf16 v[80:83], v[48:51], v[236:239], v[80:83]
    ds_read_b64_tr_b16 v[34:35], v14 offset:13824
    s_waitcnt lgkmcnt(4)
    v_mfma_f32_16x16x32_bf16 v[68:71], v[52:55], v[232:235], v[68:71]
    ds_read_b64_tr_b16 v[36:37], v15 offset:12288
    v_mfma_f32_16x16x32_bf16 v[84:87], v[52:55], v[236:239], v[84:87]
    ds_read_b64_tr_b16 v[38:39], v15 offset:13824
    s_waitcnt lgkmcnt(4)
    v_mfma_f32_16x16x32_bf16 v[72:75], v[56:59], v[232:235], v[72:75]
    ds_read_b64_tr_b16 v[40:41], v16 offset:12288
    v_mfma_f32_16x16x32_bf16 v[88:91], v[56:59], v[236:239], v[88:91]
    ds_read_b64_tr_b16 v[42:43], v16 offset:13824
    s_waitcnt lgkmcnt(4)
    v_mfma_f32_16x16x32_bf16 v[64:67], v[32:35], v[240:243], v[64:67]
    ds_read_b64_tr_b16 v[48:49], v14 offset:18432
    v_mfma_f32_16x16x32_bf16 v[80:83], v[32:35], v[244:247], v[80:83]
    ds_read_b64_tr_b16 v[50:51], v14 offset:19968
    s_waitcnt lgkmcnt(4)
    v_mfma_f32_16x16x32_bf16 v[68:71], v[36:39], v[240:243], v[68:71]
    ds_read_b64_tr_b16 v[52:53], v15 offset:18432
    v_mfma_f32_16x16x32_bf16 v[84:87], v[36:39], v[244:247], v[84:87]
    ds_read_b64_tr_b16 v[54:55], v15 offset:19968
    s_waitcnt lgkmcnt(4)
    v_mfma_f32_16x16x32_bf16 v[72:75], v[40:43], v[240:243], v[72:75]
    ds_read_b64_tr_b16 v[56:57], v16 offset:18432
    v_mfma_f32_16x16x32_bf16 v[88:91], v[40:43], v[244:247], v[88:91]
    ds_read_b64_tr_b16 v[58:59], v16 offset:19968
    v_lshlrev_b32 v4, 4, v0
    v_lshlrev_b32 v5, 2, v0
    s_cmp_lg_u32 s48, 0
    s_cbranch_scc1 L_w0_57
    s_waitcnt vmcnt(0)
L_spin_58:
    v_cmp_eq_u32 s[46:47], 1, v218
    v_cmp_eq_u32 vcc, 1, v219
    s_nop 1
    s_lshl_b32 s54, 7, s91
    s_lshr_b32 s55, s54, 16
    s_or_b32 s54, s54, s55
    s_and_b32 s54, s54, 0xffff
    s_mul_i32 s54, s54, 0x10001
    s_cmp_eq_u64 vcc, -1
    s_cselect_b32 s46, s46, 0
L_test_60:
    s_and_b32 s55, s46, s47
    s_and_b32 s55, s55, s54
    s_cmp_eq_u32 s55, s54
    s_cbranch_scc1 L_got_59
    s_add_u32 s96, s96, 1
    s_cmp_gt_u32 s96, 0x100000
    s_cbranch_scc1 L_got_59
    s_sleep 1
    s_mov_b32 s56, 19570688
    buffer_load_dword v218, v216, s[20:23], s56 offen sc1
    s_mov_b32 s56, 19570688
    buffer_load_dword v219, v217, s[20:23], s56 offen sc1
    s_waitcnt vmcnt(0)
    s_branch L_spin_58
L_got_59:
L_w0_57:
    s_barrier
    s_add_u32 m0, s72, 122880
    s_mul_i32 s51, s91, 10240
    s_add_u32 s51, s51, s70
    buffer_load_dwordx4 v4, s[20:23], s51 offen sc1 lds
    s_add_u32 s91, s91, 1
    s_and_b32 s91, s91, 15
    buffer_load_dword v5, s[20:23], s51 offen offset:1024 sc1 lds
    s_mul_i32 s51, s48, 1280
    s_add_u32 m0, s51, 104448
    s_nop 0
    buffer_load_dwordx4 v4, s[20:23], s97 offen sc1 lds
    buffer_load_dword v5, s[20:23], s97 offen offset:1024 sc1 lds
    s_add_u32 m0, s72, 135168
    s_mul_i32 s51, s91, 10240
    s_add_u32 s51, s51, s70
    buffer_load_dwordx4 v4, s[20:23], s51 offen sc1 lds
    s_add_u32 s91, s91, 1
    s_and_b32 s91, s91, 15
    buffer_load_dword v5, s[20:23], s51 offen offset:1024 sc1 lds
    s_add_u32 m0, s72, 147456
    s_mul_i32 s51, s91, 10240
    s_add_u32 s51, s51, s70
    buffer_load_dwordx4 v4, s[20:23], s51 offen sc1 lds
    s_add_u32 s91, s91, 1
    s_and_b32 s91, s91, 15
    buffer_load_dword v5, s[20:23], s51 offen offset:1024 sc1 lds
    s_waitcnt lgkmcnt(4)
    v_mfma_f32_16x16x32_bf16 v[64:67], v[48:51], v[248:251], v[64:67]
    v_mfma_f32_16x16x32_bf16 v[80:83], v[48:51], v[252:255], v[80:83]
    s_waitcnt lgkmcnt(2)
    v_mfma_f32_16x16x32_bf16 v[68:71], v[52:55], v[248:251], v[68:71]
    v_mfma_f32_16x16x32_bf16 v[84:87], v[52:55], v[252:255], v[84:87]
    s_waitcnt lgkmcnt(0)
    v_mfma_f32_16x16x32_bf16 v[72:75], v[56:59], v[248:251], v[72:75]
    v_mfma_f32_16x16x32_bf16 v[88:91], v[56:59], v[252:255], v[88:91]
    s_nop 7
    s_and_b32 s51, s48, 3
    s_lshl_b32 s51, s51, 1
    s_lshl_b32 s52, s49, 3
    s_add_u32 s51, s51, s52
    s_mul_i32 s51, s51, 69632
    s_lshr_b32 s52, s48, 2
    s_mul_i32 s52, s52, 1536
    s_mul_i32 s53, s50, 3072
    s_add_u32 s51, s51, s52
    s_add_u32 s51, s51, s53
    s_lshr_b32 s52, s50, 2
    s_mul_i32 s52, s52, 5120
    s_add_u32 s51, s51, s52
    s_add_u32 s81, s51, 7864320
    v_bfe_u32 v212, v0, 4, 1
    v_mul_u32_u24 v212, 69632, v212
    v_lshrrev_b32 v213, 5, v0
    v_lshl_add_u32 v212, v213, 8, v212
    v_and_b32 v213, 15, v0
    v_lshl_add_u32 v212, v213, 4, v212
    v_max_f32 v64, 0, v64
    v_max_f32 v65, 0, v65
    v_max_f32 v66, 0, v66
    v_max_f32 v67, 0, v67
    v_max_f32 v80, 0, v80
    v_max_f32 v81, 0, v81
    v_max_f32 v82, 0, v82
    v_max_f32 v83, 0, v83
    v_mul_f32 v64, v64, v64
    v_mul_f32 v65, v65, v65
    v_mul_f32 v66, v66, v66
    v_mul_f32 v67, v67, v67
    v_mul_f32 v80, v80, v80
    v_mul_f32 v81, v81, v81
    v_mul_f32 v82, v82, v82
    v_mul_f32 v83, v83, v83
    v_cvt_pk_bf16_f32 v200, v64, v65
    v_cvt_pk_bf16_f32 v201, v66, v67
    v_cvt_pk_bf16_f32 v202, v80, v81
    v_cvt_pk_bf16_f32 v203, v82, v83
    s_nop 1
    v_permlane16_swap_b32 v200, v202
    v_permlane16_swap_b32 v201, v203
    buffer_store_dwordx4 v[200:203], v212, s[20:23], s81 offen offset:0 sc1
    v_max_f32 v68, 0, v68
    v_max_f32 v69, 0, v69
    v_max_f32 v70, 0, v70
    v_max_f32 v71, 0, v71
    v_max_f32 v84, 0, v84
    v_max_f32 v85, 0, v85
    v_max_f32 v86, 0, v86
    v_max_f32 v87, 0, v87
    v_mul_f32 v68, v68, v68
    v_mul_f32 v69, v69, v69
    v_mul_f32 v70, v70, v70
    v_mul_f32 v71, v71, v71
    v_mul_f32 v84, v84, v84
    v_mul_f32 v85, v85, v85
    v_mul_f32 v86, v86, v86
    v_mul_f32 v87, v87, v87
    v_cvt_pk_bf16_f32 v204, v68, v69
    v_cvt_pk_bf16_f32 v205, v70, v71
    v_cvt_pk_bf16_f32 v206, v84, v85
    v_cvt_pk_bf16_f32 v207, v86, v87
    s_nop 1
    v_permlane16_swap_b32 v204, v206
    v_permlane16_swap_b32 v205, v207
    buffer_store_dwordx4 v[204:207], v212, s[20:23], s81 offen offset:512 sc1
    v_max_f32 v72, 0, v72
    v_max_f32 v73, 0, v73
    v_max_f32 v74, 0, v74
    v_max_f32 v75, 0, v75
    v_max_f32 v88, 0, v88
    v_max_f32 v89, 0, v89
    v_max_f32 v90, 0, v90
    v_max_f32 v91, 0, v91
    v_mul_f32 v72, v72, v72
    v_mul_f32 v73, v73, v73
    v_mul_f32 v74, v74, v74
    v_mul_f32 v75, v75, v75
    v_mul_f32 v88, v88, v88
    v_mul_f32 v89, v89, v89
    v_mul_f32 v90, v90, v90
    v_mul_f32 v91, v91, v91
    v_cvt_pk_bf16_f32 v208, v72, v73
    v_cvt_pk_bf16_f32 v209, v74, v75
    v_cvt_pk_bf16_f32 v210, v88, v89
    v_cvt_pk_bf16_f32 v211, v90, v91
    s_nop 1
    v_permlane16_swap_b32 v208, v210
    v_permlane16_swap_b32 v209, v211
    buffer_store_dwordx4 v[208:211], v212, s[20:23], s81 offen offset:1024 sc1
    v_mov_b32 v240, v28
    v_mov_b32 v241, v29
    v_mov_b32 v242, v30
    v_mov_b32 v243, v31
    s_mul_i32 s51, s71, 6144
    s_add_u32 s51, s51, 122880
    v_and_b32 v2, 31, v0
    v_lshrrev_b32 v1, 5, v0
    v_mul_u32_u24 v72, 320, v1
    v_lshl_add_u32 v3, v2, 4, v72
    v_add_u32 v7, 640, v3
    v_cmp_gt_u32 vcc, 20, v2
    v_mov_b32 v72, 1280
    v_and_b32 v73, 27, v2
    v_cmp_eq_u32 s[66:67], 24, v73
    v_mov_b32 v73, 1296
    s_nop 0
    v_cndmask_b32 v72, v73, v72, s[66:67]
    v_lshlrev_b32 v2, 3, v2
    v_cndmask_b32 v3, v72, v3, vcc
    v_cndmask_b32 v7, v72, v7, vcc
    v_add_u32 v3, s51, v3
    v_add_u32 v7, s51, v7
    v_add_u32 v2, s51, v2
    v_lshl_add_u32 v1, v1, 8, v2
    v_mov_b32 v76, 0x3f803f80
    v_mov_b32 v77, 0x3f803f80
    v_mov_b32 v78, 0x3f803f80
    v_mov_b32 v79, 0x3f803f80
    v_min_u32 v72, 11, v0
    v_mul_u32_u24 v72, 3072, v72
    v_add_u32 v72, 122880, v72
    ds_write_b128 v72, v[76:79] offset:2560
    v_mov_b32 v40, 0
    v_mov_b32 v41, 0
    v_mov_b32 v42, 0
    v_mov_b32 v43, 0
    ds_write_b128 v72, v[40:43] offset:2576
    v_mov_b32 v72, 1552
    v_add_u32 v72, s51, v72
    s_mov_b32 exec_lo, 0
    v_mov_b32 v2, v72
    s_mov_b32 exec_lo, -1
    s_mul_i32 s51, s48, 3328
    s_add_u32 s51, s51, 135168
    v_add_u32 v224, s51, v4
    v_add_u32 v225, s51, v5
    s_xor_b32 s52, s48, 4
    s_mul_i32 s52, s52, 3328
    s_add_u32 s52, s52, 135168
    v_add_u32 v226, s52, v4
    v_add_u32 v227, s52, v5
    v_bfe_u32 v221, v0, 4, 1
    v_mul_u32_u24 v221, 69632, v221
    v_and_b32 v228, 15, v0
    v_lshl_add_u32 v221, v228, 4, v221
    v_lshrrev_b32 v228, 5, v0
    v_lshl_add_u32 v220, v228, 8, v221
    v_and_b32 v222, 31, v0
    v_lshlrev_b32 v222, 2, v222
    v_mov_b32 v228, -1
    v_mov_b32 v229, -1
    v_mov_b32 v230, -1
    v_mov_b32 v231, -1
    v_and_b32 v8, 9, v0
    v_bfe_u32 v9, v0, 1, 1
    v_lshl_add_u32 v8, v9, 2, v8
    v_bfe_u32 v9, v0, 2, 1
    v_lshl_add_u32 v8, v9, 1, v8
    v_lshlrev_b32 v8, 4, v8
    v_bfe_u32 v9, v0, 4, 1
    v_lshl_add_u32 v8, v9, 3, v8
    v_lshrrev_b32 v9, 5, v0
    v_lshl_add_u32 v9, v9, 8, v8
    s_and_b32 s51, s48, 3
    s_lshl_b32 s51, s51, 1
    s_add_u32 s52, s51, s71
    s_xor_b32 s53, s52, 1
    s_mul_i32 s52, s52, 1280
    s_mul_i32 s53, s53, 1280
    s_add_u32 s52, s52, 104448
    s_add_u32 s53, s53, 104448
    v_add_u32 v10, s52, v8
    v_add_u32 v11, s52, v9
    v_add_u32 v12, s53, v8
    v_add_u32 v13, s53, v9
    s_waitcnt vmcnt(7) lgkmcnt(0)
    s_barrier
    ds_read2st64_b64 v[108:111], v11 offset0:0 offset1:1
    ds_read_b64 v[112:113], v10 offset:1024
    ds_read2st64_b64 v[114:117], v13 offset0:0 offset1:1
    ds_read_b64 v[118:119], v12 offset:1024
    ds_read2st64_b64 v[96:99], v1 offset0:0 offset1:1
    ds_read_b64 v[100:101], v2 offset:1024
    ds_read_b128 v[80:83], v3 offset:1280
    ds_read_b128 v[84:87], v7 offset:1280
    ds_read2st64_b64 v[102:105], v1 offset0:6 offset1:7
    ds_read_b64 v[106:107], v2 offset:4096
    s_lshl_b32 s51, s48, 10
    s_add_u32 m0, s51, 92160
    s_nop 0
    buffer_load_dwordx4 v240, s[32:35], s82 offen lds
    s_cmp_ge_u32 s48, 2
    s_cbranch_scc1 L_lt2_61
    s_add_u32 m0, s51, 100352
    s_nop 0
    buffer_load_dwordx4 v241, s[32:35], s82 offen lds
L_lt2_61:
    s_waitcnt lgkmcnt(6)
    s_mov_b32 exec_lo, 0
    v_mov_b32 v112, 0
    v_mov_b32 v113, 0
    v_mov_b32 v118, 0
    v_mov_b32 v119, 0
    s_mov_b32 exec_lo, -1
    s_waitcnt lgkmcnt(4)
    s_nop 0
    v_mfma_f32_32x32x8_bf16 v[8:23], v[100:101], v[112:113], 0
    s_nop 9
    v_mfma_f32_32x32x16_bf16 v[8:23], v[96:99], v[108:111], v[8:23]
    s_nop 11
    v_mfma_f32_32x32x8_bf16 v[24:39], v[100:101], v[118:119], 0
    s_setprio 1
    v_exp_f32 v8, v8
    v_exp_f32 v9, v9
    v_exp_f32 v10, v10
    v_exp_f32 v11, v11
    v_cvt_pk_bf16_f32 v72, v8, v9
    v_cvt_pk_bf16_f32 v73, v10, v11
    ds_read_b128 v[88:91], v3 offset:4352
    v_exp_f32 v12, v12
    v_exp_f32 v13, v13
    v_exp_f32 v14, v14
    v_exp_f32 v15, v15
    v_cvt_pk_bf16_f32 v74, v12, v13
    v_cvt_pk_bf16_f32 v75, v14, v15
    v_mfma_f32_32x32x16_bf16 v[24:39], v[96:99], v[114:117], v[24:39]
    s_waitcnt lgkmcnt(1)
    v_exp_f32 v16, v16
    v_exp_f32 v17, v17
    v_exp_f32 v18, v18
    v_exp_f32 v19, v19
    v_cvt_pk_bf16_f32 v76, v16, v17
    v_cvt_pk_bf16_f32 v77, v18, v19
    v_mfma_f32_32x32x16_bf16 v[40:55], v[80:83], v[72:75], 0
    ds_read_b128 v[92:95], v7 offset:4352
    v_exp_f32 v20, v20
    v_exp_f32 v21, v21
    v_exp_f32 v22, v22
    v_exp_f32 v23, v23
    v_cvt_pk_bf16_f32 v78, v20, v21
    v_cvt_pk_bf16_f32 v79, v22, v23
    v_mfma_f32_32x32x8_bf16 v[8:23], v[106:107], v[112:113], 0
    s_setprio 0
    v_exp_f32 v24, v24
    v_exp_f32 v25, v25
    v_exp_f32 v26, v26
    v_exp_f32 v27, v27
    v_cvt_pk_bf16_f32 v72, v24, v25
    v_cvt_pk_bf16_f32 v73, v26, v27
    v_mfma_f32_32x32x16_bf16 v[40:55], v[84:87], v[76:79], v[40:55]
    s_cmp_eq_u64 s[46:47], -1
    s_cbranch_scc1 L_rdy_62
    s_lshl_b32 s54, 0x00010001, s91
    s_branch L_test_65
L_spin_63:
    v_cmp_eq_u32 s[46:47], 1, v218
    s_nop 1
L_test_65:
    s_and_b32 s55, s46, s47
    s_and_b32 s55, s55, s54
    s_cmp_eq_u32 s55, s54
    s_cbranch_scc1 L_got_64
    s_add_u32 s96, s96, 1
    s_cmp_gt_u32 s96, 0x100000
    s_cbranch_scc1 L_got_64
    s_sleep 1
    s_mov_b32 s56, 19570688
    buffer_load_dword v218, v216, s[20:23], s56 offen sc1
    s_waitcnt vmcnt(0)
    s_branch L_spin_63
L_got_64:
L_rdy_62:
    v_exp_f32 v28, v28
    v_exp_f32 v29, v29
    v_exp_f32 v30, v30
    v_exp_f32 v31, v31
    v_cvt_pk_bf16_f32 v74, v28, v29
    v_cvt_pk_bf16_f32 v75, v30, v31
    v_mfma_f32_32x32x16_bf16 v[8:23], v[102:105], v[108:111], v[8:23]
    s_waitcnt vmcnt(6) lgkmcnt(0)
    s_barrier
    ds_read2st64_b64 v[96:99], v1 offset0:24 offset1:25
    v_exp_f32 v32, v32
    v_exp_f32 v33, v33
    v_exp_f32 v34, v34
    v_exp_f32 v35, v35
    v_cvt_pk_bf16_f32 v76, v32, v33
    v_cvt_pk_bf16_f32 v77, v34, v35
    v_mfma_f32_32x32x16_bf16 v[56:71], v[80:83], v[72:75], 0
    ds_read_b64 v[100:101], v2 offset:13312
    s_add_u32 m0, s72, 122880
    s_mul_i32 s51, s91, 10240
    s_add_u32 s51, s51, s70
    buffer_load_dwordx4 v4, s[20:23], s51 offen sc1 lds
    v_exp_f32 v36, v36
    v_exp_f32 v37, v37
    v_exp_f32 v38, v38
    v_exp_f32 v39, v39
    v_cvt_pk_bf16_f32 v78, v36, v37
    v_cvt_pk_bf16_f32 v79, v38, v39
    v_mfma_f32_32x32x8_bf16 v[24:39], v[106:107], v[118:119], 0
    s_setprio 3
    s_add_u32 s91, s91, 1
    s_and_b32 s91, s91, 15
    buffer_load_dword v5, s[20:23], s51 offen offset:1024 sc1 lds
    v_exp_f32 v8, v8
    v_exp_f32 v9, v9
    v_exp_f32 v10, v10
    v_exp_f32 v11, v11
    v_cvt_pk_bf16_f32 v72, v8, v9
    v_cvt_pk_bf16_f32 v73, v10, v11
    v_mfma_f32_32x32x16_bf16 v[56:71], v[84:87], v[76:79], v[56:71]
    ds_read_b128 v[80:83], v3 offset:13568
    buffer_store_dwordx4 v[228:231], v220, s[20:23], s4 offen sc1
    s_mov_b32 exec_hi, 0
    buffer_store_dwordx2 v[228:229], v221, s[20:23], s5 offen sc1
    s_mov_b32 exec_hi, -1
    v_exp_f32 v12, v12
    v_exp_f32 v13, v13
    v_exp_f32 v14, v14
    v_exp_f32 v15, v15
    v_cvt_pk_bf16_f32 v74, v12, v13
    v_cvt_pk_bf16_f32 v75, v14, v15
    v_mfma_f32_32x32x16_bf16 v[24:39], v[102:105], v[114:117], v[24:39]
    s_waitcnt lgkmcnt(1)
    v_exp_f32 v16, v16
    v_exp_f32 v17, v17
    v_exp_f32 v18, v18
    v_exp_f32 v19, v19
    v_cvt_pk_bf16_f32 v76, v16, v17
    v_cvt_pk_bf16_f32 v77, v18, v19
    v_mfma_f32_32x32x16_bf16 v[40:55], v[88:91], v[72:75], v[40:55]
    ds_read_b128 v[84:87], v7 offset:13568
    v_exp_f32 v20, v20
    v_exp_f32 v21, v21
    v_exp_f32 v22, v22
    v_exp_f32 v23, v23
    v_cvt_pk_bf16_f32 v78, v20, v21
    v_cvt_pk_bf16_f32 v79, v22, v23
    v_mfma_f32_32x32x8_bf16 v[8:23], v[100:101], v[112:113], 0
    s_setprio 2
    v_exp_f32 v24, v24
    v_exp_f32 v25, v25
    v_exp_f32 v26, v26
    v_exp_f32 v27, v27
    v_cvt_pk_bf16_f32 v72, v24, v25
    v_cvt_pk_bf16_f32 v73, v26, v27
    v_mfma_f32_32x32x16_bf16 v[40:55], v[92:95], v[76:79], v[40:55]
    v_exp_f32 v28, v28
    v_exp_f32 v29, v29
    v_exp_f32 v30, v30
    v_exp_f32 v31, v31
    v_cvt_pk_bf16_f32 v74, v28, v29
    v_cvt_pk_bf16_f32 v75, v30, v31
    v_mfma_f32_32x32x16_bf16 v[8:23], v[96:99], v[108:111], v[8:23]
    ds_read2st64_b64 v[102:105], v1 offset0:30 offset1:31
    v_exp_f32 v32, v32
    v_exp_f32 v33, v33
    v_exp_f32 v34, v34
    v_exp_f32 v35, v35
    v_cvt_pk_bf16_f32 v76, v32, v33
    v_cvt_pk_bf16_f32 v77, v34, v35
    v_mfma_f32_32x32x16_bf16 v[56:71], v[88:91], v[72:75], v[56:71]
    ds_read_b64 v[106:107], v2 offset:16384
    v_exp_f32 v36, v36
    v_exp_f32 v37, v37
    v_exp_f32 v38, v38
    v_exp_f32 v39, v39
    v_cvt_pk_bf16_f32 v78, v36, v37
    v_cvt_pk_bf16_f32 v79, v38, v39
    v_mfma_f32_32x32x8_bf16 v[24:39], v[100:101], v[118:119], 0
    s_setprio 1
    v_exp_f32 v8, v8
    v_exp_f32 v9, v9
    v_exp_f32 v10, v10
    v_exp_f32 v11, v11
    v_cvt_pk_bf16_f32 v72, v8, v9
    v_cvt_pk_bf16_f32 v73, v10, v11
    v_mfma_f32_32x32x16_bf16 v[56:71], v[92:95], v[76:79], v[56:71]
    ds_read_b128 v[88:91], v3 offset:16640
    v_exp_f32 v12, v12
    v_exp_f32 v13, v13
    v_exp_f32 v14, v14
    v_exp_f32 v15, v15
    v_cvt_pk_bf16_f32 v74, v12, v13
    v_cvt_pk_bf16_f32 v75, v14, v15
    v_mfma_f32_32x32x16_bf16 v[24:39], v[96:99], v[114:117], v[24:39]
    s_waitcnt lgkmcnt(1)
    v_exp_f32 v16, v16
    v_exp_f32 v17, v17
    v_exp_f32 v18, v18
    v_exp_f32 v19, v19
    v_cvt_pk_bf16_f32 v76, v16, v17
    v_cvt_pk_bf16_f32 v77, v18, v19
    v_mfma_f32_32x32x16_bf16 v[40:55], v[80:83], v[72:75], v[40:55]
    ds_read_b128 v[92:95], v7 offset:16640
    v_exp_f32 v20, v20
    v_exp_f32 v21, v21
    v_exp_f32 v22, v22
    v_exp_f32 v23, v23
    v_cvt_pk_bf16_f32 v78, v20, v21
    v_cvt_pk_bf16_f32 v79, v22, v23
    v_mfma_f32_32x32x8_bf16 v[8:23], v[106:107], v[112:113], 0
    s_setprio 0
    v_exp_f32 v24, v24
    v_exp_f32 v25, v25
    v_exp_f32 v26, v26
    v_exp_f32 v27, v27
    v_cvt_pk_bf16_f32 v72, v24, v25
    v_cvt_pk_bf16_f32 v73, v26, v27
    v_mfma_f32_32x32x16_bf16 v[40:55], v[84:87], v[76:79], v[40:55]
    s_cmp_eq_u64 s[46:47], -1
    s_cbranch_scc1 L_rdy_66
    s_lshl_b32 s54, 0x00010001, s91
    s_branch L_test_69
L_spin_67:
    v_cmp_eq_u32 s[46:47], 1, v218
    s_nop 1
L_test_69:
    s_and_b32 s55, s46, s47
    s_and_b32 s55, s55, s54
    s_cmp_eq_u32 s55, s54
    s_cbranch_scc1 L_got_68
    s_add_u32 s96, s96, 1
    s_cmp_gt_u32 s96, 0x100000
    s_cbranch_scc1 L_got_68
    s_sleep 1
    s_mov_b32 s56, 19570688
    buffer_load_dword v218, v216, s[20:23], s56 offen sc1
    s_waitcnt vmcnt(0)
    s_branch L_spin_67
L_got_68:
L_rdy_66:
    v_exp_f32 v28, v28
    v_exp_f32 v29, v29
    v_exp_f32 v30, v30
    v_exp_f32 v31, v31
    v_cvt_pk_bf16_f32 v74, v28, v29
    v_cvt_pk_bf16_f32 v75, v30, v31
    v_mfma_f32_32x32x16_bf16 v[8:23], v[102:105], v[108:111], v[8:23]
    s_waitcnt vmcnt(8) lgkmcnt(0)
    s_barrier
    ds_read2st64_b64 v[96:99], v1 offset0:48 offset1:49
    v_exp_f32 v32, v32
    v_exp_f32 v33, v33
    v_exp_f32 v34, v34
    v_exp_f32 v35, v35
    v_cvt_pk_bf16_f32 v76, v32, v33
    v_cvt_pk_bf16_f32 v77, v34, v35
    v_mfma_f32_32x32x16_bf16 v[56:71], v[80:83], v[72:75], v[56:71]
    ds_read_b64 v[100:101], v2 offset:25600
    s_add_u32 m0, s72, 135168
    s_mul_i32 s51, s91, 10240
    s_add_u32 s51, s51, s70
    buffer_load_dwordx4 v4, s[20:23], s51 offen sc1 lds
    v_exp_f32 v36, v36
    v_exp_f32 v37, v37
    v_exp_f32 v38, v38
    v_exp_f32 v39, v39
    v_cvt_pk_bf16_f32 v78, v36, v37
    v_cvt_pk_bf16_f32 v79, v38, v39
    v_mfma_f32_32x32x8_bf16 v[24:39], v[106:107], v[118:119], 0
    s_setprio 3
    s_add_u32 s91, s91, 1
    s_and_b32 s91, s91, 15
    buffer_load_dword v5, s[20:23], s51 offen offset:1024 sc1 lds
    v_exp_f32 v8, v8
    v_exp_f32 v9, v9
    v_exp_f32 v10, v10
    v_exp_f32 v11, v11
    v_cvt_pk_bf16_f32 v72, v8, v9
    v_cvt_pk_bf16_f32 v73, v10, v11
    v_mfma_f32_32x32x16_bf16 v[56:71], v[84:87], v[76:79], v[56:71]
    ds_read_b128 v[80:83], v3 offset:25856
    v_exp_f32 v12, v12
    v_exp_f32 v13, v13
    v_exp_f32 v14, v14
    v_exp_f32 v15, v15
    v_cvt_pk_bf16_f32 v74, v12, v13
    v_cvt_pk_bf16_f32 v75, v14, v15
    v_mfma_f32_32x32x16_bf16 v[24:39], v[102:105], v[114:117], v[24:39]
    s_waitcnt lgkmcnt(1)
    v_exp_f32 v16, v16
    v_exp_f32 v17, v17
    v_exp_f32 v18, v18
    v_exp_f32 v19, v19
    v_cvt_pk_bf16_f32 v76, v16, v17
    v_cvt_pk_bf16_f32 v77, v18, v19
    v_mfma_f32_32x32x16_bf16 v[40:55], v[88:91], v[72:75], v[40:55]
    ds_read_b128 v[84:87], v7 offset:25856
    v_exp_f32 v20, v20
    v_exp_f32 v21, v21
    v_exp_f32 v22, v22
    v_exp_f32 v23, v23
    v_cvt_pk_bf16_f32 v78, v20, v21
    v_cvt_pk_bf16_f32 v79, v22, v23
    v_mfma_f32_32x32x8_bf16 v[8:23], v[100:101], v[112:113], 0
    s_setprio 2
    v_exp_f32 v24, v24
    v_exp_f32 v25, v25
    v_exp_f32 v26, v26
    v_exp_f32 v27, v27
    v_cvt_pk_bf16_f32 v72, v24, v25
    v_cvt_pk_bf16_f32 v73, v26, v27
    v_mfma_f32_32x32x16_bf16 v[40:55], v[92:95], v[76:79], v[40:55]
    v_exp_f32 v28, v28
    v_exp_f32 v29, v29
    v_exp_f32 v30, v30
    v_exp_f32 v31, v31
    v_cvt_pk_bf16_f32 v74, v28, v29
    v_cvt_pk_bf16_f32 v75, v30, v31
    v_mfma_f32_32x32x16_bf16 v[8:23], v[96:99], v[108:111], v[8:23]
    ds_read2st64_b64 v[102:105], v1 offset0:54 offset1:55
    v_exp_f32 v32, v32
    v_exp_f32 v33, v33
    v_exp_f32 v34, v34
    v_exp_f32 v35, v35
    v_cvt_pk_bf16_f32 v76, v32, v33
    v_cvt_pk_bf16_f32 v77, v34, v35
    v_mfma_f32_32x32x16_bf16 v[56:71], v[88:91], v[72:75], v[56:71]
    ds_read_b64 v[106:107], v2 offset:28672
    v_exp_f32 v36, v36
    v_exp_f32 v37, v37
    v_exp_f32 v38, v38
    v_exp_f32 v39, v39
    v_cvt_pk_bf16_f32 v78, v36, v37
    v_cvt_pk_bf16_f32 v79, v38, v39
    v_mfma_f32_32x32x8_bf16 v[24:39], v[100:101], v[118:119], 0
    s_setprio 1
    v_exp_f32 v8, v8
    v_exp_f32 v9, v9
    v_exp_f32 v10, v10
    v_exp_f32 v11, v11
    v_cvt_pk_bf16_f32 v72, v8, v9
    v_cvt_pk_bf16_f32 v73, v10, v11
    v_mfma_f32_32x32x16_bf16 v[56:71], v[92:95], v[76:79], v[56:71]
    ds_read_b128 v[88:91], v3 offset:28928
    v_exp_f32 v12, v12
    v_exp_f32 v13, v13
    v_exp_f32 v14, v14
    v_exp_f32 v15, v15
    v_cvt_pk_bf16_f32 v74, v12, v13
    v_cvt_pk_bf16_f32 v75, v14, v15
    v_mfma_f32_32x32x16_bf16 v[24:39], v[96:99], v[114:117], v[24:39]
    s_waitcnt lgkmcnt(1)
    v_exp_f32 v16, v16
    v_exp_f32 v17, v17
    v_exp_f32 v18, v18
    v_exp_f32 v19, v19
    v_cvt_pk_bf16_f32 v76, v16, v17
    v_cvt_pk_bf16_f32 v77, v18, v19
    v_mfma_f32_32x32x16_bf16 v[40:55], v[80:83], v[72:75], v[40:55]
    ds_read_b128 v[92:95], v7 offset:28928
    v_exp_f32 v20, v20
    v_exp_f32 v21, v21
    v_exp_f32 v22, v22
    v_exp_f32 v23, v23
    v_cvt_pk_bf16_f32 v78, v20, v21
    v_cvt_pk_bf16_f32 v79, v22, v23
    v_mfma_f32_32x32x8_bf16 v[8:23], v[106:107], v[112:113], 0
    s_setprio 0
    v_exp_f32 v24, v24
    v_exp_f32 v25, v25
    v_exp_f32 v26, v26
    v_exp_f32 v27, v27
    v_cvt_pk_bf16_f32 v72, v24, v25
    v_cvt_pk_bf16_f32 v73, v26, v27
    v_mfma_f32_32x32x16_bf16 v[40:55], v[84:87], v[76:79], v[40:55]
    s_cmp_eq_u64 s[46:47], -1
    s_cbranch_scc1 L_rdy_70
    s_lshl_b32 s54, 0x00010001, s91
    s_branch L_test_73
L_spin_71:
    v_cmp_eq_u32 s[46:47], 1, v218
    s_nop 1
L_test_73:
    s_and_b32 s55, s46, s47
    s_and_b32 s55, s55, s54
    s_cmp_eq_u32 s55, s54
    s_cbranch_scc1 L_got_72
    s_add_u32 s96, s96, 1
    s_cmp_gt_u32 s96, 0x100000
    s_cbranch_scc1 L_got_72
    s_sleep 1
    s_mov_b32 s56, 19570688
    buffer_load_dword v218, v216, s[20:23], s56 offen sc1
    s_waitcnt vmcnt(0)
    s_branch L_spin_71
L_got_72:
L_rdy_70:
    v_exp_f32 v28, v28
    v_exp_f32 v29, v29
    v_exp_f32 v30, v30
    v_exp_f32 v31, v31
    v_cvt_pk_bf16_f32 v74, v28, v29
    v_cvt_pk_bf16_f32 v75, v30, v31
    v_mfma_f32_32x32x16_bf16 v[8:23], v[102:105], v[108:111], v[8:23]
    s_waitcnt vmcnt(4) lgkmcnt(0)
    s_barrier
    ds_read2st64_b64 v[96:99], v1 offset0:0 offset1:1
    v_exp_f32 v32, v32
    v_exp_f32 v33, v33
    v_exp_f32 v34, v34
    v_exp_f32 v35, v35
    v_cvt_pk_bf16_f32 v76, v32, v33
    v_cvt_pk_bf16_f32 v77, v34, v35
    v_mfma_f32_32x32x16_bf16 v[56:71], v[80:83], v[72:75], v[56:71]
    ds_read_b64 v[100:101], v2 offset:1024
    s_add_u32 m0, s72, 147456
    s_mul_i32 s51, s91, 10240
    s_add_u32 s51, s51, s70
    buffer_load_dwordx4 v4, s[20:23], s51 offen sc1 lds
    v_exp_f32 v36, v36
    v_exp_f32 v37, v37
    v_exp_f32 v38, v38
    v_exp_f32 v39, v39
    v_cvt_pk_bf16_f32 v78, v36, v37
    v_cvt_pk_bf16_f32 v79, v38, v39
    v_mfma_f32_32x32x8_bf16 v[24:39], v[106:107], v[118:119], 0
    s_setprio 3
    s_add_u32 s91, s91, 1
    s_and_b32 s91, s91, 15
    buffer_load_dword v5, s[20:23], s51 offen offset:1024 sc1 lds
    v_exp_f32 v8, v8
    v_exp_f32 v9, v9
    v_exp_f32 v10, v10
    v_exp_f32 v11, v11
    v_cvt_pk_bf16_f32 v72, v8, v9
    v_cvt_pk_bf16_f32 v73, v10, v11
    v_mfma_f32_32x32x16_bf16 v[56:71], v[84:87], v[76:79], v[56:71]
    ds_read_b128 v[80:83], v3 offset:1280
    v_lshlrev_b32 v248, 4, v0
    ds_read_b64_tr_b16 v[244:245], v242
    ds_read_b64_tr_b16 v[246:247], v242 offset:1280
    s_waitcnt lgkmcnt(0)
    buffer_store_dwordx4 v[244:247], v248, s[20:23], s83 offen sc1
    s_cmp_ge_u32 s48, 2
    s_cbranch_scc1 L_lt2_74
    ds_read_b64_tr_b16 v[244:245], v243
    ds_read_b64_tr_b16 v[246:247], v243 offset:1280
    s_waitcnt lgkmcnt(0)
    buffer_store_dwordx4 v[244:247], v248, s[20:23], s84 offen sc1
L_lt2_74:
    v_exp_f32 v12, v12
    v_exp_f32 v13, v13
    v_exp_f32 v14, v14
    v_exp_f32 v15, v15
    v_cvt_pk_bf16_f32 v74, v12, v13
    v_cvt_pk_bf16_f32 v75, v14, v15
    v_mfma_f32_32x32x16_bf16 v[24:39], v[102:105], v[114:117], v[24:39]
    v_exp_f32 v16, v16
    v_exp_f32 v17, v17
    v_exp_f32 v18, v18
    v_exp_f32 v19, v19
    v_cvt_pk_bf16_f32 v76, v16, v17
    v_cvt_pk_bf16_f32 v77, v18, v19
    v_mfma_f32_32x32x16_bf16 v[40:55], v[88:91], v[72:75], v[40:55]
    ds_read_b128 v[84:87], v7 offset:1280
    v_exp_f32 v20, v20
    v_exp_f32 v21, v21
    v_exp_f32 v22, v22
    v_exp_f32 v23, v23
    v_cvt_pk_bf16_f32 v78, v20, v21
    v_cvt_pk_bf16_f32 v79, v22, v23
    v_mfma_f32_32x32x8_bf16 v[8:23], v[100:101], v[112:113], 0
    s_setprio 2
    v_exp_f32 v24, v24
    v_exp_f32 v25, v25
    v_exp_f32 v26, v26
    v_exp_f32 v27, v27
    v_cvt_pk_bf16_f32 v72, v24, v25
    v_cvt_pk_bf16_f32 v73, v26, v27
    v_mfma_f32_32x32x16_bf16 v[40:55], v[92:95], v[76:79], v[40:55]
    v_exp_f32 v28, v28
    v_exp_f32 v29, v29
    v_exp_f32 v30, v30
    v_exp_f32 v31, v31
    v_cvt_pk_bf16_f32 v74, v28, v29
    v_cvt_pk_bf16_f32 v75, v30, v31
    v_mfma_f32_32x32x16_bf16 v[8:23], v[96:99], v[108:111], v[8:23]
    ds_read2st64_b64 v[102:105], v1 offset0:6 offset1:7
    v_exp_f32 v32, v32
    v_exp_f32 v33, v33
    v_exp_f32 v34, v34
    v_exp_f32 v35, v35
    v_cvt_pk_bf16_f32 v76, v32, v33
    v_cvt_pk_bf16_f32 v77, v34, v35
    v_mfma_f32_32x32x16_bf16 v[56:71], v[88:91], v[72:75], v[56:71]
    ds_read_b64 v[106:107], v2 offset:4096
    v_exp_f32 v36, v36
    v_exp_f32 v37, v37
    v_exp_f32 v38, v38
    v_exp_f32 v39, v39
    v_cvt_pk_bf16_f32 v78, v36, v37
    v_cvt_pk_bf16_f32 v79, v38, v39
    v_mfma_f32_32x32x8_bf16 v[24:39], v[100:101], v[118:119], 0
    s_setprio 1
    v_exp_f32 v8, v8
    v_exp_f32 v9, v9
    v_exp_f32 v10, v10
    v_exp_f32 v11, v11
    v_cvt_pk_bf16_f32 v72, v8, v9
    v_cvt_pk_bf16_f32 v73, v10, v11
    v_mfma_f32_32x32x16_bf16 v[56:71], v[92:95], v[76:79], v[56:71]
    ds_read_b128 v[88:91], v3 offset:4352
    v_exp_f32 v12, v12
    v_exp_f32 v13, v13
    v_exp_f32 v14, v14
    v_exp_f32 v15, v15
    v_cvt_pk_bf16_f32 v74, v12, v13
    v_cvt_pk_bf16_f32 v75, v14, v15
    v_mfma_f32_32x32x16_bf16 v[24:39], v[96:99], v[114:117], v[24:39]
    s_waitcnt lgkmcnt(1)
    v_exp_f32 v16, v16
    v_exp_f32 v17, v17
    v_exp_f32 v18, v18
    v_exp_f32 v19, v19
    v_cvt_pk_bf16_f32 v76, v16, v17
    v_cvt_pk_bf16_f32 v77, v18, v19
    v_mfma_f32_32x32x16_bf16 v[40:55], v[80:83], v[72:75], v[40:55]
    ds_read_b128 v[92:95], v7 offset:4352
    v_exp_f32 v20, v20
    v_exp_f32 v21, v21
    v_exp_f32 v22, v22
    v_exp_f32 v23, v23
    v_cvt_pk_bf16_f32 v78, v20, v21
    v_cvt_pk_bf16_f32 v79, v22, v23
    v_mfma_f32_32x32x8_bf16 v[8:23], v[106:107], v[112:113], 0
    s_setprio 0
    v_exp_f32 v24, v24
    v_exp_f32 v25, v25
    v_exp_f32 v26, v26
    v_exp_f32 v27, v27
    v_cvt_pk_bf16_f32 v72, v24, v25
    v_cvt_pk_bf16_f32 v73, v26, v27
    v_mfma_f32_32x32x16_bf16 v[40:55], v[84:87], v[76:79], v[40:55]
    s_cmp_eq_u64 s[46:47], -1
    s_cbranch_scc1 L_rdy_75
    s_lshl_b32 s54, 0x00010001, s91
    s_branch L_test_78
L_spin_76:
    v_cmp_eq_u32 s[46:47], 1, v218
    s_nop 1
L_test_78:
    s_and_b32 s55, s46, s47
    s_and_b32 s55, s55, s54
    s_cmp_eq_u32 s55, s54
    s_cbranch_scc1 L_got_77
    s_add_u32 s96, s96, 1
    s_cmp_gt_u32 s96, 0x100000
    s_cbranch_scc1 L_got_77
    s_sleep 1
    s_mov_b32 s56, 19570688
    buffer_load_dword v218, v216, s[20:23], s56 offen sc1
    s_waitcnt vmcnt(0)
    s_branch L_spin_76
L_got_77:
L_rdy_75:
    v_exp_f32 v28, v28
    v_exp_f32 v29, v29
    v_exp_f32 v30, v30
    v_exp_f32 v31, v31
    v_cvt_pk_bf16_f32 v74, v28, v29
    v_cvt_pk_bf16_f32 v75, v30, v31
    v_mfma_f32_32x32x16_bf16 v[8:23], v[102:105], v[108:111], v[8:23]
    s_waitcnt vmcnt(3) lgkmcnt(0)
    s_barrier
    ds_read2st64_b64 v[96:99], v1 offset0:24 offset1:25
    v_exp_f32 v32, v32
    v_exp_f32 v33, v33
    v_exp_f32 v34, v34
    v_exp_f32 v35, v35
    v_cvt_pk_bf16_f32 v76, v32, v33
    v_cvt_pk_bf16_f32 v77, v34, v35
    v_mfma_f32_32x32x16_bf16 v[56:71], v[80:83], v[72:75], v[56:71]
    ds_read_b64 v[100:101], v2 offset:13312
    s_add_u32 m0, s72, 122880
    s_mul_i32 s51, s91, 10240
    s_add_u32 s51, s51, s70
    buffer_load_dwordx4 v4, s[20:23], s51 offen sc1 lds
    v_exp_f32 v36, v36
    v_exp_f32 v37, v37
    v_exp_f32 v38, v38
    v_exp_f32 v39, v39
    v_cvt_pk_bf16_f32 v78, v36, v37
    v_cvt_pk_bf16_f32 v79, v38, v39
    v_mfma_f32_32x32x8_bf16 v[24:39], v[106:107], v[118:119], 0
    s_setprio 3
    s_add_u32 s91, s91, 1
    s_and_b32 s91, s91, 15
    buffer_load_dword v5, s[20:23], s51 offen offset:1024 sc1 lds
    v_exp_f32 v8, v8
    v_exp_f32 v9, v9
    v_exp_f32 v10, v10
    v_exp_f32 v11, v11
    v_cvt_pk_bf16_f32 v72, v8, v9
    v_cvt_pk_bf16_f32 v73, v10, v11
    v_mfma_f32_32x32x16_bf16 v[56:71], v[84:87], v[76:79], v[56:71]
    ds_read_b128 v[80:83], v3 offset:13568
    v_exp_f32 v12, v12
    v_exp_f32 v13, v13
    v_exp_f32 v14, v14
    v_exp_f32 v15, v15
    v_cvt_pk_bf16_f32 v74, v12, v13
    v_cvt_pk_bf16_f32 v75, v14, v15
    v_mfma_f32_32x32x16_bf16 v[24:39], v[102:105], v[114:117], v[24:39]
    s_waitcnt lgkmcnt(1)
    v_exp_f32 v16, v16
    v_exp_f32 v17, v17
    v_exp_f32 v18, v18
    v_exp_f32 v19, v19
    v_cvt_pk_bf16_f32 v76, v16, v17
    v_cvt_pk_bf16_f32 v77, v18, v19
    v_mfma_f32_32x32x16_bf16 v[40:55], v[88:91], v[72:75], v[40:55]
    ds_read_b128 v[84:87], v7 offset:13568
    v_exp_f32 v20, v20
    v_exp_f32 v21, v21
    v_exp_f32 v22, v22
    v_exp_f32 v23, v23
    v_cvt_pk_bf16_f32 v78, v20, v21
    v_cvt_pk_bf16_f32 v79, v22, v23
    v_mfma_f32_32x32x8_bf16 v[8:23], v[100:101], v[112:113], 0
    s_setprio 2
    v_exp_f32 v24, v24
    v_exp_f32 v25, v25
    v_exp_f32 v26, v26
    v_exp_f32 v27, v27
    v_cvt_pk_bf16_f32 v72, v24, v25
    v_cvt_pk_bf16_f32 v73, v26, v27
    v_mfma_f32_32x32x16_bf16 v[40:55], v[92:95], v[76:79], v[40:55]
    v_exp_f32 v28, v28
    v_exp_f32 v29, v29
    v_exp_f32 v30, v30
    v_exp_f32 v31, v31
    v_cvt_pk_bf16_f32 v74, v28, v29
    v_cvt_pk_bf16_f32 v75, v30, v31
    v_mfma_f32_32x32x16_bf16 v[8:23], v[96:99], v[108:111], v[8:23]
    ds_read2st64_b64 v[102:105], v1 offset0:30 offset1:31
    v_exp_f32 v32, v32
    v_exp_f32 v33, v33
    v_exp_f32 v34, v34
    v_exp_f32 v35, v35
    v_cvt_pk_bf16_f32 v76, v32, v33
    v_cvt_pk_bf16_f32 v77, v34, v35
    v_mfma_f32_32x32x16_bf16 v[56:71], v[88:91], v[72:75], v[56:71]
    ds_read_b64 v[106:107], v2 offset:16384
    v_exp_f32 v36, v36
    v_exp_f32 v37, v37
    v_exp_f32 v38, v38
    v_exp_f32 v39, v39
    v_cvt_pk_bf16_f32 v78, v36, v37
    v_cvt_pk_bf16_f32 v79, v38, v39
    v_mfma_f32_32x32x8_bf16 v[24:39], v[100:101], v[118:119], 0
    s_setprio 1
    v_exp_f32 v8, v8
    v_exp_f32 v9, v9
    v_exp_f32 v10, v10
    v_exp_f32 v11, v11
    v_cvt_pk_bf16_f32 v72, v8, v9
    v_cvt_pk_bf16_f32 v73, v10, v11
    v_mfma_f32_32x32x16_bf16 v[56:71], v[92:95], v[76:79], v[56:71]
    ds_read_b128 v[88:91], v3 offset:16640
    v_exp_f32 v12, v12
    v_exp_f32 v13, v13
    v_exp_f32 v14, v14
    v_exp_f32 v15, v15
    v_cvt_pk_bf16_f32 v74, v12, v13
    v_cvt_pk_bf16_f32 v75, v14, v15
    v_mfma_f32_32x32x16_bf16 v[24:39], v[96:99], v[114:117], v[24:39]
    s_waitcnt lgkmcnt(1)
    v_exp_f32 v16, v16
    v_exp_f32 v17, v17
    v_exp_f32 v18, v18
    v_exp_f32 v19, v19
    v_cvt_pk_bf16_f32 v76, v16, v17
    v_cvt_pk_bf16_f32 v77, v18, v19
    v_mfma_f32_32x32x16_bf16 v[40:55], v[80:83], v[72:75], v[40:55]
    ds_read_b128 v[92:95], v7 offset:16640
    v_exp_f32 v20, v20
    v_exp_f32 v21, v21
    v_exp_f32 v22, v22
    v_exp_f32 v23, v23
    v_cvt_pk_bf16_f32 v78, v20, v21
    v_cvt_pk_bf16_f32 v79, v22, v23
    v_mfma_f32_32x32x8_bf16 v[8:23], v[106:107], v[112:113], 0
    s_setprio 0
    v_exp_f32 v24, v24
    v_exp_f32 v25, v25
    v_exp_f32 v26, v26
    v_exp_f32 v27, v27
    v_cvt_pk_bf16_f32 v72, v24, v25
    v_cvt_pk_bf16_f32 v73, v26, v27
    v_mfma_f32_32x32x16_bf16 v[40:55], v[84:87], v[76:79], v[40:55]
    s_cmp_eq_u64 s[46:47], -1
    s_cbranch_scc1 L_rdy_79
    s_lshl_b32 s54, 0x00010001, s91
    s_branch L_test_82
L_spin_80:
    v_cmp_eq_u32 s[46:47], 1, v218
    s_nop 1
L_test_82:
    s_and_b32 s55, s46, s47
    s_and_b32 s55, s55, s54
    s_cmp_eq_u32 s55, s54
    s_cbranch_scc1 L_got_81
    s_add_u32 s96, s96, 1
    s_cmp_gt_u32 s96, 0x100000
    s_cbranch_scc1 L_got_81
    s_sleep 1
    s_mov_b32 s56, 19570688
    buffer_load_dword v218, v216, s[20:23], s56 offen sc1
    s_waitcnt vmcnt(0)
    s_branch L_spin_80
L_got_81:
L_rdy_79:
    v_exp_f32 v28, v28
    v_exp_f32 v29, v29
    v_exp_f32 v30, v30
    v_exp_f32 v31, v31
    v_cvt_pk_bf16_f32 v74, v28, v29
    v_cvt_pk_bf16_f32 v75, v30, v31
    v_mfma_f32_32x32x16_bf16 v[8:23], v[102:105], v[108:111], v[8:23]
    s_waitcnt vmcnt(2)
    s_waitcnt lgkmcnt(0)
    s_barrier
    ds_read2st64_b64 v[96:99], v1 offset0:48 offset1:49
    v_exp_f32 v32, v32
    v_exp_f32 v33, v33
    v_exp_f32 v34, v34
    v_exp_f32 v35, v35
    v_cvt_pk_bf16_f32 v76, v32, v33
    v_cvt_pk_bf16_f32 v77, v34, v35
    v_mfma_f32_32x32x16_bf16 v[56:71], v[80:83], v[72:75], v[56:71]
    ds_read_b64 v[100:101], v2 offset:25600
    s_add_u32 m0, s72, 135168
    s_mul_i32 s51, s91, 10240
    s_add_u32 s51, s51, s70
    buffer_load_dwordx4 v4, s[20:23], s51 offen sc1 lds
    v_exp_f32 v36, v36
    v_exp_f32 v37, v37
    v_exp_f32 v38, v38
    v_exp_f32 v39, v39
    v_cvt_pk_bf16_f32 v78, v36, v37
    v_cvt_pk_bf16_f32 v79, v38, v39
    v_mfma_f32_32x32x8_bf16 v[24:39], v[106:107], v[118:119], 0
    s_setprio 3
    s_add_u32 s91, s91, 1
    s_and_b32 s91, s91, 15
    buffer_load_dword v5, s[20:23], s51 offen offset:1024 sc1 lds
    v_exp_f32 v8, v8
    v_exp_f32 v9, v9
    v_exp_f32 v10, v10
    v_exp_f32 v11, v11
    v_cvt_pk_bf16_f32 v72, v8, v9
    v_cvt_pk_bf16_f32 v73, v10, v11
    v_mfma_f32_32x32x16_bf16 v[56:71], v[84:87], v[76:79], v[56:71]
    ds_read_b128 v[80:83], v3 offset:25856
    s_cmp_lg_u32 s48, 0
    s_cbranch_scc1 L_w0_83
    v_mov_b32 v120, 0
    v_mov_b32 v121, 1
    s_lshl_b32 s51, s2, 7
    s_add_u32 s51, s51, 19603456
    s_mov_b64 exec, 1
    buffer_store_dword v121, v120, s[20:23], s51 offen sc1
    s_mov_b64 exec, -1
L_w0_83:
    v_exp_f32 v12, v12
    v_exp_f32 v13, v13
    v_exp_f32 v14, v14
    v_exp_f32 v15, v15
    v_cvt_pk_bf16_f32 v74, v12, v13
    v_cvt_pk_bf16_f32 v75, v14, v15
    v_mfma_f32_32x32x16_bf16 v[24:39], v[102:105], v[114:117], v[24:39]
    s_waitcnt lgkmcnt(1)
    v_exp_f32 v16, v16
    v_exp_f32 v17, v17
    v_exp_f32 v18, v18
    v_exp_f32 v19, v19
    v_cvt_pk_bf16_f32 v76, v16, v17
    v_cvt_pk_bf16_f32 v77, v18, v19
    v_mfma_f32_32x32x16_bf16 v[40:55], v[88:91], v[72:75], v[40:55]
    ds_read_b128 v[84:87], v7 offset:25856
    v_exp_f32 v20, v20
    v_exp_f32 v21, v21
    v_exp_f32 v22, v22
    v_exp_f32 v23, v23
    v_cvt_pk_bf16_f32 v78, v20, v21
    v_cvt_pk_bf16_f32 v79, v22, v23
    v_mfma_f32_32x32x8_bf16 v[8:23], v[100:101], v[112:113], 0
    s_setprio 2
    v_exp_f32 v24, v24
    v_exp_f32 v25, v25
    v_exp_f32 v26, v26
    v_exp_f32 v27, v27
    v_cvt_pk_bf16_f32 v72, v24, v25
    v_cvt_pk_bf16_f32 v73, v26, v27
    v_mfma_f32_32x32x16_bf16 v[40:55], v[92:95], v[76:79], v[40:55]
    v_exp_f32 v28, v28
    v_exp_f32 v29, v29
    v_exp_f32 v30, v30
    v_exp_f32 v31, v31
    v_cvt_pk_bf16_f32 v74, v28, v29
    v_cvt_pk_bf16_f32 v75, v30, v31
    v_mfma_f32_32x32x16_bf16 v[8:23], v[96:99], v[108:111], v[8:23]
    ds_read2st64_b64 v[102:105], v1 offset0:54 offset1:55
    v_exp_f32 v32, v32
    v_exp_f32 v33, v33
    v_exp_f32 v34, v34
    v_exp_f32 v35, v35
    v_cvt_pk_bf16_f32 v76, v32, v33
    v_cvt_pk_bf16_f32 v77, v34, v35
    v_mfma_f32_32x32x16_bf16 v[56:71], v[88:91], v[72:75], v[56:71]
    ds_read_b64 v[106:107], v2 offset:28672
    v_exp_f32 v36, v36
    v_exp_f32 v37, v37
    v_exp_f32 v38, v38
    v_exp_f32 v39, v39
    v_cvt_pk_bf16_f32 v78, v36, v37
    v_cvt_pk_bf16_f32 v79, v38, v39
    v_mfma_f32_32x32x8_bf16 v[24:39], v[100:101], v[118:119], 0
    s_setprio 1
    v_exp_f32 v8, v8
    v_exp_f32 v9, v9
    v_exp_f32 v10, v10
    v_exp_f32 v11, v11
    v_cvt_pk_bf16_f32 v72, v8, v9
    v_cvt_pk_bf16_f32 v73, v10, v11
    v_mfma_f32_32x32x16_bf16 v[56:71], v[92:95], v[76:79], v[56:71]
    ds_read_b128 v[88:91], v3 offset:28928
    v_exp_f32 v12, v12
    v_exp_f32 v13, v13
    v_exp_f32 v14, v14
    v_exp_f32 v15, v15
    v_cvt_pk_bf16_f32 v74, v12, v13
    v_cvt_pk_bf16_f32 v75, v14, v15
    v_mfma_f32_32x32x16_bf16 v[24:39], v[96:99], v[114:117], v[24:39]
    s_waitcnt lgkmcnt(1)
    v_exp_f32 v16, v16
    v_exp_f32 v17, v17
    v_exp_f32 v18, v18
    v_exp_f32 v19, v19
    v_cvt_pk_bf16_f32 v76, v16, v17
    v_cvt_pk_bf16_f32 v77, v18, v19
    v_mfma_f32_32x32x16_bf16 v[40:55], v[80:83], v[72:75], v[40:55]
    ds_read_b128 v[92:95], v7 offset:28928
    v_exp_f32 v20, v20
    v_exp_f32 v21, v21
    v_exp_f32 v22, v22
    v_exp_f32 v23, v23
    v_cvt_pk_bf16_f32 v78, v20, v21
    v_cvt_pk_bf16_f32 v79, v22, v23
    v_mfma_f32_32x32x8_bf16 v[8:23], v[106:107], v[112:113], 0
    s_setprio 0
    v_exp_f32 v24, v24
    v_exp_f32 v25, v25
    v_exp_f32 v26, v26
    v_exp_f32 v27, v27
    v_cvt_pk_bf16_f32 v72, v24, v25
    v_cvt_pk_bf16_f32 v73, v26, v27
    v_mfma_f32_32x32x16_bf16 v[40:55], v[84:87], v[76:79], v[40:55]
    s_cmp_eq_u64 s[46:47], -1
    s_cbranch_scc1 L_rdy_84
    s_lshl_b32 s54, 0x00010001, s91
    s_branch L_test_87
L_spin_85:
    v_cmp_eq_u32 s[46:47], 1, v218
    s_nop 1
L_test_87:
    s_and_b32 s55, s46, s47
    s_and_b32 s55, s55, s54
    s_cmp_eq_u32 s55, s54
    s_cbranch_scc1 L_got_86
    s_add_u32 s96, s96, 1
    s_cmp_gt_u32 s96, 0x100000
    s_cbranch_scc1 L_got_86
    s_sleep 1
    s_mov_b32 s56, 19570688
    buffer_load_dword v218, v216, s[20:23], s56 offen sc1
    s_waitcnt vmcnt(0)
    s_branch L_spin_85
L_got_86:
L_rdy_84:
    v_exp_f32 v28, v28
    v_exp_f32 v29, v29
    v_exp_f32 v30, v30
    v_exp_f32 v31, v31
    v_cvt_pk_bf16_f32 v74, v28, v29
    v_cvt_pk_bf16_f32 v75, v30, v31
    v_mfma_f32_32x32x16_bf16 v[8:23], v[102:105], v[108:111], v[8:23]
    s_waitcnt vmcnt(2) lgkmcnt(0)
    s_barrier
    ds_read2st64_b64 v[96:99], v1 offset0:0 offset1:1
    v_exp_f32 v32, v32
    v_exp_f32 v33, v33
    v_exp_f32 v34, v34
    v_exp_f32 v35, v35
    v_cvt_pk_bf16_f32 v76, v32, v33
    v_cvt_pk_bf16_f32 v77, v34, v35
    v_mfma_f32_32x32x16_bf16 v[56:71], v[80:83], v[72:75], v[56:71]
    ds_read_b64 v[100:101], v2 offset:1024
    s_add_u32 m0, s72, 147456
    s_mul_i32 s51, s91, 10240
    s_add_u32 s51, s51, s70
    buffer_load_dwordx4 v4, s[20:23], s51 offen sc1 lds
    v_exp_f32 v36, v36
    v_exp_f32 v37, v37
    v_exp_f32 v38, v38
    v_exp_f32 v39, v39
    v_cvt_pk_bf16_f32 v78, v36, v37
    v_cvt_pk_bf16_f32 v79, v38, v39
    v_mfma_f32_32x32x8_bf16 v[24:39], v[106:107], v[118:119], 0
    s_setprio 3
    s_add_u32 s91, s91, 1
    s_and_b32 s91, s91, 15
    buffer_load_dword v5, s[20:23], s51 offen offset:1024 sc1 lds
    v_exp_f32 v8, v8
    v_exp_f32 v9, v9
    v_exp_f32 v10, v10
    v_exp_f32 v11, v11
    v_cvt_pk_bf16_f32 v72, v8, v9
    v_cvt_pk_bf16_f32 v73, v10, v11
    v_mfma_f32_32x32x16_bf16 v[56:71], v[84:87], v[76:79], v[56:71]
    ds_read_b128 v[80:83], v3 offset:1280
    v_exp_f32 v12, v12
    v_exp_f32 v13, v13
    v_exp_f32 v14, v14
    v_exp_f32 v15, v15
    v_cvt_pk_bf16_f32 v74, v12, v13
    v_cvt_pk_bf16_f32 v75, v14, v15
    v_mfma_f32_32x32x16_bf16 v[24:39], v[102:105], v[114:117], v[24:39]
    s_waitcnt lgkmcnt(1)
    v_exp_f32 v16, v16
    v_exp_f32 v17, v17
    v_exp_f32 v18, v18
    v_exp_f32 v19, v19
    v_cvt_pk_bf16_f32 v76, v16, v17
    v_cvt_pk_bf16_f32 v77, v18, v19
    v_mfma_f32_32x32x16_bf16 v[40:55], v[88:91], v[72:75], v[40:55]
    ds_read_b128 v[84:87], v7 offset:1280
    v_exp_f32 v20, v20
    v_exp_f32 v21, v21
    v_exp_f32 v22, v22
    v_exp_f32 v23, v23
    v_cvt_pk_bf16_f32 v78, v20, v21
    v_cvt_pk_bf16_f32 v79, v22, v23
    v_mfma_f32_32x32x8_bf16 v[8:23], v[100:101], v[112:113], 0
    s_setprio 2
    v_exp_f32 v24, v24
    v_exp_f32 v25, v25
    v_exp_f32 v26, v26
    v_exp_f32 v27, v27
    v_cvt_pk_bf16_f32 v72, v24, v25
    v_cvt_pk_bf16_f32 v73, v26, v27
    v_mfma_f32_32x32x16_bf16 v[40:55], v[92:95], v[76:79], v[40:55]
    v_exp_f32 v28, v28
    v_exp_f32 v29, v29
    v_exp_f32 v30, v30
    v_exp_f32 v31, v31
    v_cvt_pk_bf16_f32 v74, v28, v29
    v_cvt_pk_bf16_f32 v75, v30, v31
    v_mfma_f32_32x32x16_bf16 v[8:23], v[96:99], v[108:111], v[8:23]
    ds_read2st64_b64 v[102:105], v1 offset0:6 offset1:7
    v_exp_f32 v32, v32
    v_exp_f32 v33, v33
    v_exp_f32 v34, v34
    v_exp_f32 v35, v35
    v_cvt_pk_bf16_f32 v76, v32, v33
    v_cvt_pk_bf16_f32 v77, v34, v35
    v_mfma_f32_32x32x16_bf16 v[56:71], v[88:91], v[72:75], v[56:71]
    ds_read_b64 v[106:107], v2 offset:4096
    v_exp_f32 v36, v36
    v_exp_f32 v37, v37
    v_exp_f32 v38, v38
    v_exp_f32 v39, v39
    v_cvt_pk_bf16_f32 v78, v36, v37
    v_cvt_pk_bf16_f32 v79, v38, v39
    v_mfma_f32_32x32x8_bf16 v[24:39], v[100:101], v[118:119], 0
    s_setprio 1
    v_exp_f32 v8, v8
    v_exp_f32 v9, v9
    v_exp_f32 v10, v10
    v_exp_f32 v11, v11
    v_cvt_pk_bf16_f32 v72, v8, v9
    v_cvt_pk_bf16_f32 v73, v10, v11
    v_mfma_f32_32x32x16_bf16 v[56:71], v[92:95], v[76:79], v[56:71]
    ds_read_b128 v[88:91], v3 offset:4352
    v_exp_f32 v12, v12
    v_exp_f32 v13, v13
    v_exp_f32 v14, v14
    v_exp_f32 v15, v15
    v_cvt_pk_bf16_f32 v74, v12, v13
    v_cvt_pk_bf16_f32 v75, v14, v15
    v_mfma_f32_32x32x16_bf16 v[24:39], v[96:99], v[114:117], v[24:39]
    s_waitcnt lgkmcnt(1)
    v_exp_f32 v16, v16
    v_exp_f32 v17, v17
    v_exp_f32 v18, v18
    v_exp_f32 v19, v19
    v_cvt_pk_bf16_f32 v76, v16, v17
    v_cvt_pk_bf16_f32 v77, v18, v19
    v_mfma_f32_32x32x16_bf16 v[40:55], v[80:83], v[72:75], v[40:55]
    ds_read_b128 v[92:95], v7 offset:4352
    v_exp_f32 v20, v20
    v_exp_f32 v21, v21
    v_exp_f32 v22, v22
    v_exp_f32 v23, v23
    v_cvt_pk_bf16_f32 v78, v20, v21
    v_cvt_pk_bf16_f32 v79, v22, v23
    v_mfma_f32_32x32x8_bf16 v[8:23], v[106:107], v[112:113], 0
    s_setprio 0
    v_exp_f32 v24, v24
    v_exp_f32 v25, v25
    v_exp_f32 v26, v26
    v_exp_f32 v27, v27
    v_cvt_pk_bf16_f32 v72, v24, v25
    v_cvt_pk_bf16_f32 v73, v26, v27
    v_mfma_f32_32x32x16_bf16 v[40:55], v[84:87], v[76:79], v[40:55]
    s_cmp_eq_u64 s[46:47], -1
    s_cbranch_scc1 L_rdy_88
    s_lshl_b32 s54, 0x00010001, s91
    s_branch L_test_91
L_spin_89:
    v_cmp_eq_u32 s[46:47], 1, v218
    s_nop 1
L_test_91:
    s_and_b32 s55, s46, s47
    s_and_b32 s55, s55, s54
    s_cmp_eq_u32 s55, s54
    s_cbranch_scc1 L_got_90
    s_add_u32 s96, s96, 1
    s_cmp_gt_u32 s96, 0x100000
    s_cbranch_scc1 L_got_90
    s_sleep 1
    s_mov_b32 s56, 19570688
    buffer_load_dword v218, v216, s[20:23], s56 offen sc1
    s_waitcnt vmcnt(0)
    s_branch L_spin_89
L_got_90:
L_rdy_88:
    v_exp_f32 v28, v28
    v_exp_f32 v29, v29
    v_exp_f32 v30, v30
    v_exp_f32 v31, v31
    v_cvt_pk_bf16_f32 v74, v28, v29
    v_cvt_pk_bf16_f32 v75, v30, v31
    v_mfma_f32_32x32x16_bf16 v[8:23], v[102:105], v[108:111], v[8:23]
    s_waitcnt vmcnt(2) lgkmcnt(0)
    s_barrier
    ds_read2st64_b64 v[96:99], v1 offset0:24 offset1:25
    v_exp_f32 v32, v32
    v_exp_f32 v33, v33
    v_exp_f32 v34, v34
    v_exp_f32 v35, v35
    v_cvt_pk_bf16_f32 v76, v32, v33
    v_cvt_pk_bf16_f32 v77, v34, v35
    v_mfma_f32_32x32x16_bf16 v[56:71], v[80:83], v[72:75], v[56:71]
    ds_read_b64 v[100:101], v2 offset:13312
    s_add_u32 m0, s72, 122880
    s_mul_i32 s51, s91, 10240
    s_add_u32 s51, s51, s70
    buffer_load_dwordx4 v4, s[20:23], s51 offen sc1 lds
    v_exp_f32 v36, v36
    v_exp_f32 v37, v37
    v_exp_f32 v38, v38
    v_exp_f32 v39, v39
    v_cvt_pk_bf16_f32 v78, v36, v37
    v_cvt_pk_bf16_f32 v79, v38, v39
    v_mfma_f32_32x32x8_bf16 v[24:39], v[106:107], v[118:119], 0
    s_setprio 3
    s_add_u32 s91, s91, 1
    s_and_b32 s91, s91, 15
    buffer_load_dword v5, s[20:23], s51 offen offset:1024 sc1 lds
    v_exp_f32 v8, v8
    v_exp_f32 v9, v9
    v_exp_f32 v10, v10
    v_exp_f32 v11, v11
    v_cvt_pk_bf16_f32 v72, v8, v9
    v_cvt_pk_bf16_f32 v73, v10, v11
    v_mfma_f32_32x32x16_bf16 v[56:71], v[84:87], v[76:79], v[56:71]
    ds_read_b128 v[80:83], v3 offset:13568
    s_cmp_lg_u32 s48, 0
    s_cbranch_scc1 L_w0_92
    v_lshlrev_b32 v120, 7, v0
    s_mov_b32 s56, 19603456
    buffer_load_dword v122, v120, s[20:23], s56 offen sc1
    s_mov_b32 s56, 19611648
    buffer_load_dword v123, v120, s[20:23], s56 offen sc1
    s_mov_b32 s56, 19619840
    buffer_load_dword v124, v120, s[20:23], s56 offen sc1
    s_mov_b32 s56, 19628032
    buffer_load_dword v125, v120, s[20:23], s56 offen sc1
L_w0_92:
    v_exp_f32 v12, v12
    v_exp_f32 v13, v13
    v_exp_f32 v14, v14
    v_exp_f32 v15, v15
    v_cvt_pk_bf16_f32 v74, v12, v13
    v_cvt_pk_bf16_f32 v75, v14, v15
    v_mfma_f32_32x32x16_bf16 v[24:39], v[102:105], v[114:117], v[24:39]
    s_waitcnt lgkmcnt(1)
    v_exp_f32 v16, v16
    v_exp_f32 v17, v17
    v_exp_f32 v18, v18
    v_exp_f32 v19, v19
    v_cvt_pk_bf16_f32 v76, v16, v17
    v_cvt_pk_bf16_f32 v77, v18, v19
    v_mfma_f32_32x32x16_bf16 v[40:55], v[88:91], v[72:75], v[40:55]
    ds_read_b128 v[84:87], v7 offset:13568
    v_exp_f32 v20, v20
    v_exp_f32 v21, v21
    v_exp_f32 v22, v22
    v_exp_f32 v23, v23
    v_cvt_pk_bf16_f32 v78, v20, v21
    v_cvt_pk_bf16_f32 v79, v22, v23
    v_mfma_f32_32x32x8_bf16 v[8:23], v[100:101], v[112:113], 0
    s_setprio 2
    v_exp_f32 v24, v24
    v_exp_f32 v25, v25
    v_exp_f32 v26, v26
    v_exp_f32 v27, v27
    v_cvt_pk_bf16_f32 v72, v24, v25
    v_cvt_pk_bf16_f32 v73, v26, v27
    v_mfma_f32_32x32x16_bf16 v[40:55], v[92:95], v[76:79], v[40:55]
    v_exp_f32 v28, v28
    v_exp_f32 v29, v29
    v_exp_f32 v30, v30
    v_exp_f32 v31, v31
    v_cvt_pk_bf16_f32 v74, v28, v29
    v_cvt_pk_bf16_f32 v75, v30, v31
    v_mfma_f32_32x32x16_bf16 v[8:23], v[96:99], v[108:111], v[8:23]
    ds_read2st64_b64 v[102:105], v1 offset0:30 offset1:31
    v_exp_f32 v32, v32
    v_exp_f32 v33, v33
    v_exp_f32 v34, v34
    v_exp_f32 v35, v35
    v_cvt_pk_bf16_f32 v76, v32, v33
    v_cvt_pk_bf16_f32 v77, v34, v35
    v_mfma_f32_32x32x16_bf16 v[56:71], v[88:91], v[72:75], v[56:71]
    ds_read_b64 v[106:107], v2 offset:16384
    v_exp_f32 v36, v36
    v_exp_f32 v37, v37
    v_exp_f32 v38, v38
    v_exp_f32 v39, v39
    v_cvt_pk_bf16_f32 v78, v36, v37
    v_cvt_pk_bf16_f32 v79, v38, v39
    v_mfma_f32_32x32x8_bf16 v[24:39], v[100:101], v[118:119], 0
    s_setprio 1
    v_exp_f32 v8, v8
    v_exp_f32 v9, v9
    v_exp_f32 v10, v10
    v_exp_f32 v11, v11
    v_cvt_pk_bf16_f32 v72, v8, v9
    v_cvt_pk_bf16_f32 v73, v10, v11
    v_mfma_f32_32x32x16_bf16 v[56:71], v[92:95], v[76:79], v[56:71]
    ds_read_b128 v[88:91], v3 offset:16640
    v_exp_f32 v12, v12
    v_exp_f32 v13, v13
    v_exp_f32 v14, v14
    v_exp_f32 v15, v15
    v_cvt_pk_bf16_f32 v74, v12, v13
    v_cvt_pk_bf16_f32 v75, v14, v15
    v_mfma_f32_32x32x16_bf16 v[24:39], v[96:99], v[114:117], v[24:39]
    s_waitcnt lgkmcnt(1)
    v_exp_f32 v16, v16
    v_exp_f32 v17, v17
    v_exp_f32 v18, v18
    v_exp_f32 v19, v19
    v_cvt_pk_bf16_f32 v76, v16, v17
    v_cvt_pk_bf16_f32 v77, v18, v19
    v_mfma_f32_32x32x16_bf16 v[40:55], v[80:83], v[72:75], v[40:55]
    ds_read_b128 v[92:95], v7 offset:16640
    v_exp_f32 v20, v20
    v_exp_f32 v21, v21
    v_exp_f32 v22, v22
    v_exp_f32 v23, v23
    v_cvt_pk_bf16_f32 v78, v20, v21
    v_cvt_pk_bf16_f32 v79, v22, v23
    v_mfma_f32_32x32x8_bf16 v[8:23], v[106:107], v[112:113], 0
    s_setprio 0
    v_exp_f32 v24, v24
    v_exp_f32 v25, v25
    v_exp_f32 v26, v26
    v_exp_f32 v27, v27
    v_cvt_pk_bf16_f32 v72, v24, v25
    v_cvt_pk_bf16_f32 v73, v26, v27
    v_mfma_f32_32x32x16_bf16 v[40:55], v[84:87], v[76:79], v[40:55]
    s_cmp_eq_u64 s[46:47], -1
    s_cbranch_scc1 L_rdy_93
    s_lshl_b32 s54, 0x00010001, s91
    s_branch L_test_96
L_spin_94:
    v_cmp_eq_u32 s[46:47], 1, v218
    s_nop 1
L_test_96:
    s_and_b32 s55, s46, s47
    s_and_b32 s55, s55, s54
    s_cmp_eq_u32 s55, s54
    s_cbranch_scc1 L_got_95
    s_add_u32 s96, s96, 1
    s_cmp_gt_u32 s96, 0x100000
    s_cbranch_scc1 L_got_95
    s_sleep 1
    s_mov_b32 s56, 19570688
    buffer_load_dword v218, v216, s[20:23], s56 offen sc1
    s_waitcnt vmcnt(0)
    s_branch L_spin_94
L_got_95:
L_rdy_93:
    v_exp_f32 v28, v28
    v_exp_f32 v29, v29
    v_exp_f32 v30, v30
    v_exp_f32 v31, v31
    v_cvt_pk_bf16_f32 v74, v28, v29
    v_cvt_pk_bf16_f32 v75, v30, v31
    v_mfma_f32_32x32x16_bf16 v[8:23], v[102:105], v[108:111], v[8:23]
    s_waitcnt vmcnt(2) lgkmcnt(0)
    s_barrier
    ds_read2st64_b64 v[96:99], v1 offset0:48 offset1:49
    v_exp_f32 v32, v32
    v_exp_f32 v33, v33
    v_exp_f32 v34, v34
    v_exp_f32 v35, v35
    v_cvt_pk_bf16_f32 v76, v32, v33
    v_cvt_pk_bf16_f32 v77, v34, v35
    v_mfma_f32_32x32x16_bf16 v[56:71], v[80:83], v[72:75], v[56:71]
    ds_read_b64 v[100:101], v2 offset:25600
    s_add_u32 m0, s72, 135168
    s_mul_i32 s51, s91, 10240
    s_add_u32 s51, s51, s70
    buffer_load_dwordx4 v4, s[20:23], s51 offen sc1 lds
    v_exp_f32 v36, v36
    v_exp_f32 v37, v37
    v_exp_f32 v38, v38
    v_exp_f32 v39, v39
    v_cvt_pk_bf16_f32 v78, v36, v37
    v_cvt_pk_bf16_f32 v79, v38, v39
    v_mfma_f32_32x32x8_bf16 v[24:39], v[106:107], v[118:119], 0
    s_setprio 3
    s_add_u32 s91, s91, 1
    s_and_b32 s91, s91, 15
    buffer_load_dword v5, s[20:23], s51 offen offset:1024 sc1 lds
    v_exp_f32 v8, v8
    v_exp_f32 v9, v9
    v_exp_f32 v10, v10
    v_exp_f32 v11, v11
    v_cvt_pk_bf16_f32 v72, v8, v9
    v_cvt_pk_bf16_f32 v73, v10, v11
    v_mfma_f32_32x32x16_bf16 v[56:71], v[84:87], v[76:79], v[56:71]
    ds_read_b128 v[80:83], v3 offset:25856
    v_exp_f32 v12, v12
    v_exp_f32 v13, v13
    v_exp_f32 v14, v14
    v_exp_f32 v15, v15
    v_cvt_pk_bf16_f32 v74, v12, v13
    v_cvt_pk_bf16_f32 v75, v14, v15
    v_mfma_f32_32x32x16_bf16 v[24:39], v[102:105], v[114:117], v[24:39]
    s_waitcnt lgkmcnt(1)
    v_exp_f32 v16, v16
    v_exp_f32 v17, v17
    v_exp_f32 v18, v18
    v_exp_f32 v19, v19
    v_cvt_pk_bf16_f32 v76, v16, v17
    v_cvt_pk_bf16_f32 v77, v18, v19
    v_mfma_f32_32x32x16_bf16 v[40:55], v[88:91], v[72:75], v[40:55]
    ds_read_b128 v[84:87], v7 offset:25856
    v_exp_f32 v20, v20
    v_exp_f32 v21, v21
    v_exp_f32 v22, v22
    v_exp_f32 v23, v23
    v_cvt_pk_bf16_f32 v78, v20, v21
    v_cvt_pk_bf16_f32 v79, v22, v23
    v_mfma_f32_32x32x8_bf16 v[8:23], v[100:101], v[112:113], 0
    s_setprio 2
    v_exp_f32 v24, v24
    v_exp_f32 v25, v25
    v_exp_f32 v26, v26
    v_exp_f32 v27, v27
    v_cvt_pk_bf16_f32 v72, v24, v25
    v_cvt_pk_bf16_f32 v73, v26, v27
    v_mfma_f32_32x32x16_bf16 v[40:55], v[92:95], v[76:79], v[40:55]
    v_exp_f32 v28, v28
    v_exp_f32 v29, v29
    v_exp_f32 v30, v30
    v_exp_f32 v31, v31
    v_cvt_pk_bf16_f32 v74, v28, v29
    v_cvt_pk_bf16_f32 v75, v30, v31
    v_mfma_f32_32x32x16_bf16 v[8:23], v[96:99], v[108:111], v[8:23]
    ds_read2st64_b64 v[102:105], v1 offset0:54 offset1:55
    v_exp_f32 v32, v32
    v_exp_f32 v33, v33
    v_exp_f32 v34, v34
    v_exp_f32 v35, v35
    v_cvt_pk_bf16_f32 v76, v32, v33
    v_cvt_pk_bf16_f32 v77, v34, v35
    v_mfma_f32_32x32x16_bf16 v[56:71], v[88:91], v[72:75], v[56:71]
    ds_read_b64 v[106:107], v2 offset:28672
    v_exp_f32 v36, v36
    v_exp_f32 v37, v37
    v_exp_f32 v38, v38
    v_exp_f32 v39, v39
    v_cvt_pk_bf16_f32 v78, v36, v37
    v_cvt_pk_bf16_f32 v79, v38, v39
    v_mfma_f32_32x32x8_bf16 v[24:39], v[100:101], v[118:119], 0
    s_setprio 1
    v_exp_f32 v8, v8
    v_exp_f32 v9, v9
    v_exp_f32 v10, v10
    v_exp_f32 v11, v11
    v_cvt_pk_bf16_f32 v72, v8, v9
    v_cvt_pk_bf16_f32 v73, v10, v11
    v_mfma_f32_32x32x16_bf16 v[56:71], v[92:95], v[76:79], v[56:71]
    ds_read_b128 v[88:91], v3 offset:28928
    v_exp_f32 v12, v12
    v_exp_f32 v13, v13
    v_exp_f32 v14, v14
    v_exp_f32 v15, v15
    v_cvt_pk_bf16_f32 v74, v12, v13
    v_cvt_pk_bf16_f32 v75, v14, v15
    v_mfma_f32_32x32x16_bf16 v[24:39], v[96:99], v[114:117], v[24:39]
    s_waitcnt lgkmcnt(1)
    v_exp_f32 v16, v16
    v_exp_f32 v17, v17
    v_exp_f32 v18, v18
    v_exp_f32 v19, v19
    v_cvt_pk_bf16_f32 v76, v16, v17
    v_cvt_pk_bf16_f32 v77, v18, v19
    v_mfma_f32_32x32x16_bf16 v[40:55], v[80:83], v[72:75], v[40:55]
    ds_read_b128 v[92:95], v7 offset:28928
    v_exp_f32 v20, v20
    v_exp_f32 v21, v21
    v_exp_f32 v22, v22
    v_exp_f32 v23, v23
    v_cvt_pk_bf16_f32 v78, v20, v21
    v_cvt_pk_bf16_f32 v79, v22, v23
    v_mfma_f32_32x32x8_bf16 v[8:23], v[106:107], v[112:113], 0
    s_setprio 0
    v_exp_f32 v24, v24
    v_exp_f32 v25, v25
    v_exp_f32 v26, v26
    v_exp_f32 v27, v27
    v_cvt_pk_bf16_f32 v72, v24, v25
    v_cvt_pk_bf16_f32 v73, v26, v27
    v_mfma_f32_32x32x16_bf16 v[40:55], v[84:87], v[76:79], v[40:55]
    s_cmp_eq_u64 s[46:47], -1
    s_cbranch_scc1 L_rdy_97
    s_lshl_b32 s54, 0x00010001, s91
    s_branch L_test_100
L_spin_98:
    v_cmp_eq_u32 s[46:47], 1, v218
    s_nop 1
L_test_100:
    s_and_b32 s55, s46, s47
    s_and_b32 s55, s55, s54
    s_cmp_eq_u32 s55, s54
    s_cbranch_scc1 L_got_99
    s_add_u32 s96, s96, 1
    s_cmp_gt_u32 s96, 0x100000
    s_cbranch_scc1 L_got_99
    s_sleep 1
    s_mov_b32 s56, 19570688
    buffer_load_dword v218, v216, s[20:23], s56 offen sc1
    s_waitcnt vmcnt(0)
    s_branch L_spin_98
L_got_99:
L_rdy_97:
    v_exp_f32 v28, v28
    v_exp_f32 v29, v29
    v_exp_f32 v30, v30
    v_exp_f32 v31, v31
    v_cvt_pk_bf16_f32 v74, v28, v29
    v_cvt_pk_bf16_f32 v75, v30, v31
    v_mfma_f32_32x32x16_bf16 v[8:23], v[102:105], v[108:111], v[8:23]
    s_cmp_lg_u32 s48, 0
    s_cbranch_scc1 L_w0_101
    s_waitcnt vmcnt(2)
L_spin_102:
    v_and_b32 v122, v122, v123
    v_and_b32 v124, v124, v125
    v_and_b32 v122, v122, v124
    v_cmp_eq_u32 vcc, 1, v122
    s_nop 1
    s_cmp_eq_u64 vcc, -1
    s_cbranch_scc1 L_got_103
    s_add_u32 s96, s96, 1
    s_cmp_gt_u32 s96, 0x100000
    s_cbranch_scc1 L_got_103
    s_sleep 1
    s_mov_b32 s56, 19603456
    buffer_load_dword v122, v120, s[20:23], s56 offen sc1
    s_mov_b32 s56, 19611648
    buffer_load_dword v123, v120, s[20:23], s56 offen sc1
    s_mov_b32 s56, 19619840
    buffer_load_dword v124, v120, s[20:23], s56 offen sc1
    s_mov_b32 s56, 19628032
    buffer_load_dword v125, v120, s[20:23], s56 offen sc1
    s_waitcnt vmcnt(0)
    s_branch L_spin_102
L_got_103:
L_w0_101:
    s_waitcnt vmcnt(2) lgkmcnt(0)
    s_barrier
    ds_read2st64_b64 v[96:99], v1 offset0:0 offset1:1
    v_exp_f32 v32, v32
    v_exp_f32 v33, v33
    v_exp_f32 v34, v34
    v_exp_f32 v35, v35
    v_cvt_pk_bf16_f32 v76, v32, v33
    v_cvt_pk_bf16_f32 v77, v34, v35
    v_mfma_f32_32x32x16_bf16 v[56:71], v[80:83], v[72:75], v[56:71]
    ds_read_b64 v[100:101], v2 offset:1024
    s_add_u32 m0, s72, 147456
    s_mul_i32 s51, s91, 10240
    s_add_u32 s51, s51, s70
    buffer_load_dwordx4 v4, s[20:23], s51 offen sc1 lds
    v_exp_f32 v36, v36
    v_exp_f32 v37, v37
    v_exp_f32 v38, v38
    v_exp_f32 v39, v39
    v_cvt_pk_bf16_f32 v78, v36, v37
    v_cvt_pk_bf16_f32 v79, v38, v39
    v_mfma_f32_32x32x8_bf16 v[24:39], v[106:107], v[118:119], 0
    s_setprio 3
    s_add_u32 s91, s91, 1
    s_and_b32 s91, s91, 15
    buffer_load_dword v5, s[20:23], s51 offen offset:1024 sc1 lds
    v_exp_f32 v8, v8
    v_exp_f32 v9, v9
    v_exp_f32 v10, v10
    v_exp_f32 v11, v11
    v_cvt_pk_bf16_f32 v72, v8, v9
    v_cvt_pk_bf16_f32 v73, v10, v11
    v_mfma_f32_32x32x16_bf16 v[56:71], v[84:87], v[76:79], v[56:71]
    ds_read_b128 v[80:83], v3 offset:1280
    s_add_u32 s78, s76, 0
    buffer_load_dwordx4 v[120:123], v4, s[20:23], s78 offen sc1
    v_exp_f32 v12, v12
    v_exp_f32 v13, v13
    v_exp_f32 v14, v14
    v_exp_f32 v15, v15
    v_cvt_pk_bf16_f32 v74, v12, v13
    v_cvt_pk_bf16_f32 v75, v14, v15
    v_mfma_f32_32x32x16_bf16 v[24:39], v[102:105], v[114:117], v[24:39]
    s_waitcnt lgkmcnt(1)
    buffer_load_dwordx4 v[128:131], v4, s[20:23], s78 offen offset:1024 sc1
    v_exp_f32 v16, v16
    v_exp_f32 v17, v17
    v_exp_f32 v18, v18
    v_exp_f32 v19, v19
    v_cvt_pk_bf16_f32 v76, v16, v17
    v_cvt_pk_bf16_f32 v77, v18, v19
    v_mfma_f32_32x32x16_bf16 v[40:55], v[88:91], v[72:75], v[40:55]
    ds_read_b128 v[84:87], v7 offset:1280
    buffer_load_dwordx4 v[136:139], v4, s[20:23], s78 offen offset:2048 sc1
    v_exp_f32 v20, v20
    v_exp_f32 v21, v21
    v_exp_f32 v22, v22
    v_exp_f32 v23, v23
    v_cvt_pk_bf16_f32 v78, v20, v21
    v_cvt_pk_bf16_f32 v79, v22, v23
    v_mfma_f32_32x32x8_bf16 v[8:23], v[100:101], v[112:113], 0
    s_setprio 2
    s_add_u32 m0, s77, 0
    s_add_u32 s87, s75, 0
    buffer_load_dwordx4 v4, s[20:23], s87 offen sc1 lds
    v_exp_f32 v24, v24
    v_exp_f32 v25, v25
    v_exp_f32 v26, v26
    v_exp_f32 v27, v27
    v_cvt_pk_bf16_f32 v72, v24, v25
    v_cvt_pk_bf16_f32 v73, v26, v27
    v_mfma_f32_32x32x16_bf16 v[40:55], v[92:95], v[76:79], v[40:55]
    s_add_u32 m0, s77, 1024
    s_add_u32 s87, s75, 1024
    buffer_load_dwordx4 v4, s[20:23], s87 offen sc1 lds
    v_exp_f32 v28, v28
    v_exp_f32 v29, v29
    v_exp_f32 v30, v30
    v_exp_f32 v31, v31
    v_cvt_pk_bf16_f32 v74, v28, v29
    v_cvt_pk_bf16_f32 v75, v30, v31
    v_mfma_f32_32x32x16_bf16 v[8:23], v[96:99], v[108:111], v[8:23]
    ds_read2st64_b64 v[102:105], v1 offset0:6 offset1:7
    buffer_load_dword v222, v222, s[20:23], s6 offen sc1
    v_exp_f32 v32, v32
    v_exp_f32 v33, v33
    v_exp_f32 v34, v34
    v_exp_f32 v35, v35
    v_cvt_pk_bf16_f32 v76, v32, v33
    v_cvt_pk_bf16_f32 v77, v34, v35
    v_mfma_f32_32x32x16_bf16 v[56:71], v[88:91], v[72:75], v[56:71]
    ds_read_b64 v[106:107], v2 offset:4096
    v_exp_f32 v36, v36
    v_exp_f32 v37, v37
    v_exp_f32 v38, v38
    v_exp_f32 v39, v39
    v_cvt_pk_bf16_f32 v78, v36, v37
    v_cvt_pk_bf16_f32 v79, v38, v39
    v_mfma_f32_32x32x8_bf16 v[24:39], v[100:101], v[118:119], 0
    s_setprio 1
    v_exp_f32 v8, v8
    v_exp_f32 v9, v9
    v_exp_f32 v10, v10
    v_exp_f32 v11, v11
    v_cvt_pk_bf16_f32 v72, v8, v9
    v_cvt_pk_bf16_f32 v73, v10, v11
    v_mfma_f32_32x32x16_bf16 v[56:71], v[92:95], v[76:79], v[56:71]
    ds_read_b128 v[88:91], v3 offset:4352
    v_exp_f32 v12, v12
    v_exp_f32 v13, v13
    v_exp_f32 v14, v14
    v_exp_f32 v15, v15
    v_cvt_pk_bf16_f32 v74, v12, v13
    v_cvt_pk_bf16_f32 v75, v14, v15
    v_mfma_f32_32x32x16_bf16 v[24:39], v[96:99], v[114:117], v[24:39]
    s_waitcnt lgkmcnt(1)
    v_exp_f32 v16, v16
    v_exp_f32 v17, v17
    v_exp_f32 v18, v18
    v_exp_f32 v19, v19
    v_cvt_pk_bf16_f32 v76, v16, v17
    v_cvt_pk_bf16_f32 v77, v18, v19
    v_mfma_f32_32x32x16_bf16 v[40:55], v[80:83], v[72:75], v[40:55]
    ds_read_b128 v[92:95], v7 offset:4352
    v_exp_f32 v20, v20
    v_exp_f32 v21, v21
    v_exp_f32 v22, v22
    v_exp_f32 v23, v23
    v_cvt_pk_bf16_f32 v78, v20, v21
    v_cvt_pk_bf16_f32 v79, v22, v23
    v_mfma_f32_32x32x8_bf16 v[8:23], v[106:107], v[112:113], 0
    s_setprio 0
    v_exp_f32 v24, v24
    v_exp_f32 v25, v25
    v_exp_f32 v26, v26
    v_exp_f32 v27, v27
    v_cvt_pk_bf16_f32 v72, v24, v25
    v_cvt_pk_bf16_f32 v73, v26, v27
    v_mfma_f32_32x32x16_bf16 v[40:55], v[84:87], v[76:79], v[40:55]
    s_cmp_eq_u64 s[46:47], -1
    s_cbranch_scc1 L_rdy_104
    s_lshl_b32 s54, 0x00010001, s91
    s_branch L_test_107
L_spin_105:
    v_cmp_eq_u32 s[46:47], 1, v218
    s_nop 1
L_test_107:
    s_and_b32 s55, s46, s47
    s_and_b32 s55, s55, s54
    s_cmp_eq_u32 s55, s54
    s_cbranch_scc1 L_got_106
    s_add_u32 s96, s96, 1
    s_cmp_gt_u32 s96, 0x100000
    s_cbranch_scc1 L_got_106
    s_sleep 1
    s_mov_b32 s56, 19570688
    buffer_load_dword v218, v216, s[20:23], s56 offen sc1
    s_waitcnt vmcnt(0)
    s_branch L_spin_105
L_got_106:
L_rdy_104:
    v_exp_f32 v28, v28
    v_exp_f32 v29, v29
    v_exp_f32 v30, v30
    v_exp_f32 v31, v31
    v_cvt_pk_bf16_f32 v74, v28, v29
    v_cvt_pk_bf16_f32 v75, v30, v31
    v_mfma_f32_32x32x16_bf16 v[8:23], v[102:105], v[108:111], v[8:23]
    s_waitcnt vmcnt(8) lgkmcnt(0)
    s_barrier
    ds_read2st64_b64 v[96:99], v1 offset0:24 offset1:25
    v_exp_f32 v32, v32
    v_exp_f32 v33, v33
    v_exp_f32 v34, v34
    v_exp_f32 v35, v35
    v_cvt_pk_bf16_f32 v76, v32, v33
    v_cvt_pk_bf16_f32 v77, v34, v35
    v_mfma_f32_32x32x16_bf16 v[56:71], v[80:83], v[72:75], v[56:71]
    ds_read_b64 v[100:101], v2 offset:13312
    s_add_u32 m0, s72, 122880
    s_mul_i32 s51, s91, 10240
    s_add_u32 s51, s51, s70
    buffer_load_dwordx4 v4, s[20:23], s51 offen sc1 lds
    v_exp_f32 v36, v36
    v_exp_f32 v37, v37
    v_exp_f32 v38, v38
    v_exp_f32 v39, v39
    v_cvt_pk_bf16_f32 v78, v36, v37
    v_cvt_pk_bf16_f32 v79, v38, v39
    v_mfma_f32_32x32x8_bf16 v[24:39], v[106:107], v[118:119], 0
    s_setprio 3
    s_add_u32 s91, s91, 1
    s_and_b32 s91, s91, 15
    buffer_load_dword v5, s[20:23], s51 offen offset:1024 sc1 lds
    v_exp_f32 v8, v8
    v_exp_f32 v9, v9
    v_exp_f32 v10, v10
    v_exp_f32 v11, v11
    v_cvt_pk_bf16_f32 v72, v8, v9
    v_cvt_pk_bf16_f32 v73, v10, v11
    v_mfma_f32_32x32x16_bf16 v[56:71], v[84:87], v[76:79], v[56:71]
    ds_read_b128 v[80:83], v3 offset:13568
    s_add_u32 s78, s76, 0
    buffer_load_dwordx4 v[144:147], v4, s[20:23], s78 offen offset:3072 sc1
    v_exp_f32 v12, v12
    v_exp_f32 v13, v13
    v_exp_f32 v14, v14
    v_exp_f32 v15, v15
    v_cvt_pk_bf16_f32 v74, v12, v13
    v_cvt_pk_bf16_f32 v75, v14, v15
    v_mfma_f32_32x32x16_bf16 v[24:39], v[102:105], v[114:117], v[24:39]
    s_waitcnt lgkmcnt(1)
    s_add_u32 s78, s76, 69632
    buffer_load_dwordx4 v[124:127], v4, s[20:23], s78 offen sc1
    v_exp_f32 v16, v16
    v_exp_f32 v17, v17
    v_exp_f32 v18, v18
    v_exp_f32 v19, v19
    v_cvt_pk_bf16_f32 v76, v16, v17
    v_cvt_pk_bf16_f32 v77, v18, v19
    v_mfma_f32_32x32x16_bf16 v[40:55], v[88:91], v[72:75], v[40:55]
    ds_read_b128 v[84:87], v7 offset:13568
    buffer_load_dwordx4 v[132:135], v4, s[20:23], s78 offen offset:1024 sc1
    v_exp_f32 v20, v20
    v_exp_f32 v21, v21
    v_exp_f32 v22, v22
    v_exp_f32 v23, v23
    v_cvt_pk_bf16_f32 v78, v20, v21
    v_cvt_pk_bf16_f32 v79, v22, v23
    v_mfma_f32_32x32x8_bf16 v[8:23], v[100:101], v[112:113], 0
    s_setprio 2
    s_add_u32 m0, s77, 2048
    s_add_u32 s87, s75, 2048
    buffer_load_dwordx4 v4, s[20:23], s87 offen sc1 lds
    v_exp_f32 v24, v24
    v_exp_f32 v25, v25
    v_exp_f32 v26, v26
    v_exp_f32 v27, v27
    v_cvt_pk_bf16_f32 v72, v24, v25
    v_cvt_pk_bf16_f32 v73, v26, v27
    v_mfma_f32_32x32x16_bf16 v[40:55], v[92:95], v[76:79], v[40:55]
    s_add_u32 m0, s77, 3072
    s_add_u32 s87, s75, 3072
    buffer_load_dwordx4 v4, s[20:23], s87 offen sc1 lds
    v_exp_f32 v28, v28
    v_exp_f32 v29, v29
    v_exp_f32 v30, v30
    v_exp_f32 v31, v31
    v_cvt_pk_bf16_f32 v74, v28, v29
    v_cvt_pk_bf16_f32 v75, v30, v31
    v_mfma_f32_32x32x16_bf16 v[8:23], v[96:99], v[108:111], v[8:23]
    ds_read2st64_b64 v[102:105], v1 offset0:30 offset1:31
    v_exp_f32 v32, v32
    v_exp_f32 v33, v33
    v_exp_f32 v34, v34
    v_exp_f32 v35, v35
    v_cvt_pk_bf16_f32 v76, v32, v33
    v_cvt_pk_bf16_f32 v77, v34, v35
    v_mfma_f32_32x32x16_bf16 v[56:71], v[88:91], v[72:75], v[56:71]
    ds_read_b64 v[106:107], v2 offset:16384
    v_exp_f32 v36, v36
    v_exp_f32 v37, v37
    v_exp_f32 v38, v38
    v_exp_f32 v39, v39
    v_cvt_pk_bf16_f32 v78, v36, v37
    v_cvt_pk_bf16_f32 v79, v38, v39
    v_mfma_f32_32x32x8_bf16 v[24:39], v[100:101], v[118:119], 0
    s_setprio 1
    v_exp_f32 v8, v8
    v_exp_f32 v9, v9
    v_exp_f32 v10, v10
    v_exp_f32 v11, v11
    v_cvt_pk_bf16_f32 v72, v8, v9
    v_cvt_pk_bf16_f32 v73, v10, v11
    v_mfma_f32_32x32x16_bf16 v[56:71], v[92:95], v[76:79], v[56:71]
    ds_read_b128 v[88:91], v3 offset:16640
    v_exp_f32 v12, v12
    v_exp_f32 v13, v13
    v_exp_f32 v14, v14
    v_exp_f32 v15, v15
    v_cvt_pk_bf16_f32 v74, v12, v13
    v_cvt_pk_bf16_f32 v75, v14, v15
    v_mfma_f32_32x32x16_bf16 v[24:39], v[96:99], v[114:117], v[24:39]
    s_waitcnt lgkmcnt(1)
    v_exp_f32 v16, v16
    v_exp_f32 v17, v17
    v_exp_f32 v18, v18
    v_exp_f32 v19, v19
    v_cvt_pk_bf16_f32 v76, v16, v17
    v_cvt_pk_bf16_f32 v77, v18, v19
    v_mfma_f32_32x32x16_bf16 v[40:55], v[80:83], v[72:75], v[40:55]
    ds_read_b128 v[92:95], v7 offset:16640
    v_exp_f32 v20, v20
    v_exp_f32 v21, v21
    v_exp_f32 v22, v22
    v_exp_f32 v23, v23
    v_cvt_pk_bf16_f32 v78, v20, v21
    v_cvt_pk_bf16_f32 v79, v22, v23
    v_mfma_f32_32x32x8_bf16 v[8:23], v[106:107], v[112:113], 0
    s_setprio 0
    v_exp_f32 v24, v24
    v_exp_f32 v25, v25
    v_exp_f32 v26, v26
    v_exp_f32 v27, v27
    v_cvt_pk_bf16_f32 v72, v24, v25
    v_cvt_pk_bf16_f32 v73, v26, v27
    v_mfma_f32_32x32x16_bf16 v[40:55], v[84:87], v[76:79], v[40:55]
    s_cmp_eq_u64 s[46:47], -1
    s_cbranch_scc1 L_rdy_108
    s_lshl_b32 s54, 0x00010001, s91
    s_branch L_test_111
L_spin_109:
    v_cmp_eq_u32 s[46:47], 1, v218
    s_nop 1
L_test_111:
    s_and_b32 s55, s46, s47
    s_and_b32 s55, s55, s54
    s_cmp_eq_u32 s55, s54
    s_cbranch_scc1 L_got_110
    s_add_u32 s96, s96, 1
    s_cmp_gt_u32 s96, 0x100000
    s_cbranch_scc1 L_got_110
    s_sleep 1
    s_mov_b32 s56, 19570688
    buffer_load_dword v218, v216, s[20:23], s56 offen sc1
    s_waitcnt vmcnt(0)
    s_branch L_spin_109
L_got_110:
L_rdy_108:
    v_exp_f32 v28, v28
    v_exp_f32 v29, v29
    v_exp_f32 v30, v30
    v_exp_f32 v31, v31
    v_cvt_pk_bf16_f32 v74, v28, v29
    v_cvt_pk_bf16_f32 v75, v30, v31
    v_mfma_f32_32x32x16_bf16 v[8:23], v[102:105], v[108:111], v[8:23]
    s_waitcnt vmcnt(13) lgkmcnt(0)
    s_barrier
    ds_read2st64_b64 v[96:99], v1 offset0:48 offset1:49
    v_exp_f32 v32, v32
    v_exp_f32 v33, v33
    v_exp_f32 v34, v34
    v_exp_f32 v35, v35
    v_cvt_pk_bf16_f32 v76, v32, v33
    v_cvt_pk_bf16_f32 v77, v34, v35
    v_mfma_f32_32x32x16_bf16 v[56:71], v[80:83], v[72:75], v[56:71]
    ds_read_b64 v[100:101], v2 offset:25600
    s_add_u32 m0, s72, 135168
    s_mul_i32 s51, s91, 10240
    s_add_u32 s51, s51, s70
    buffer_load_dwordx4 v4, s[20:23], s51 offen sc1 lds
    v_exp_f32 v36, v36
    v_exp_f32 v37, v37
    v_exp_f32 v38, v38
    v_exp_f32 v39, v39
    v_cvt_pk_bf16_f32 v78, v36, v37
    v_cvt_pk_bf16_f32 v79, v38, v39
    v_mfma_f32_32x32x8_bf16 v[24:39], v[106:107], v[118:119], 0
    s_setprio 3
    s_add_u32 s91, s91, 1
    s_and_b32 s91, s91, 15
    buffer_load_dword v5, s[20:23], s51 offen offset:1024 sc1 lds
    v_exp_f32 v8, v8
    v_exp_f32 v9, v9
    v_exp_f32 v10, v10
    v_exp_f32 v11, v11
    v_cvt_pk_bf16_f32 v72, v8, v9
    v_cvt_pk_bf16_f32 v73, v10, v11
    v_mfma_f32_32x32x16_bf16 v[56:71], v[84:87], v[76:79], v[56:71]
    ds_read_b128 v[80:83], v3 offset:25856
    s_add_u32 s78, s76, 69632
    buffer_load_dwordx4 v[140:143], v4, s[20:23], s78 offen offset:2048 sc1
    v_exp_f32 v12, v12
    v_exp_f32 v13, v13
    v_exp_f32 v14, v14
    v_exp_f32 v15, v15
    v_cvt_pk_bf16_f32 v74, v12, v13
    v_cvt_pk_bf16_f32 v75, v14, v15
    v_mfma_f32_32x32x16_bf16 v[24:39], v[102:105], v[114:117], v[24:39]
    s_waitcnt lgkmcnt(1)
    buffer_load_dwordx4 v[148:151], v4, s[20:23], s78 offen offset:3072 sc1
    v_exp_f32 v16, v16
    v_exp_f32 v17, v17
    v_exp_f32 v18, v18
    v_exp_f32 v19, v19
    v_cvt_pk_bf16_f32 v76, v16, v17
    v_cvt_pk_bf16_f32 v77, v18, v19
    v_mfma_f32_32x32x16_bf16 v[40:55], v[88:91], v[72:75], v[40:55]
    ds_read_b128 v[84:87], v7 offset:25856
    s_add_u32 s78, s76, 4096
    buffer_load_dwordx4 v[152:155], v4, s[20:23], s78 offen sc1
    v_exp_f32 v20, v20
    v_exp_f32 v21, v21
    v_exp_f32 v22, v22
    v_exp_f32 v23, v23
    v_cvt_pk_bf16_f32 v78, v20, v21
    v_cvt_pk_bf16_f32 v79, v22, v23
    v_mfma_f32_32x32x8_bf16 v[8:23], v[100:101], v[112:113], 0
    s_setprio 2
    buffer_load_dwordx4 v[160:163], v4, s[20:23], s78 offen offset:1024 sc1
    v_exp_f32 v24, v24
    v_exp_f32 v25, v25
    v_exp_f32 v26, v26
    v_exp_f32 v27, v27
    v_cvt_pk_bf16_f32 v72, v24, v25
    v_cvt_pk_bf16_f32 v73, v26, v27
    v_mfma_f32_32x32x16_bf16 v[40:55], v[92:95], v[76:79], v[40:55]
    s_add_u32 m0, s77, 4096
    s_add_u32 s87, s75, 4096
    buffer_load_dwordx4 v4, s[20:23], s87 offen sc1 lds
    v_exp_f32 v28, v28
    v_exp_f32 v29, v29
    v_exp_f32 v30, v30
    v_exp_f32 v31, v31
    v_cvt_pk_bf16_f32 v74, v28, v29
    v_cvt_pk_bf16_f32 v75, v30, v31
    v_mfma_f32_32x32x16_bf16 v[8:23], v[96:99], v[108:111], v[8:23]
    ds_read2st64_b64 v[102:105], v1 offset0:54 offset1:55
    s_add_u32 m0, s77, 40960
    s_add_u32 s87, s75, 10240
    buffer_load_dwordx4 v4, s[20:23], s87 offen sc1 lds
    v_exp_f32 v32, v32
    v_exp_f32 v33, v33
    v_exp_f32 v34, v34
    v_exp_f32 v35, v35
    v_cvt_pk_bf16_f32 v76, v32, v33
    v_cvt_pk_bf16_f32 v77, v34, v35
    v_mfma_f32_32x32x16_bf16 v[56:71], v[88:91], v[72:75], v[56:71]
    ds_read_b64 v[106:107], v2 offset:28672
    v_exp_f32 v36, v36
    v_exp_f32 v37, v37
    v_exp_f32 v38, v38
    v_exp_f32 v39, v39
    v_cvt_pk_bf16_f32 v78, v36, v37
    v_cvt_pk_bf16_f32 v79, v38, v39
    v_mfma_f32_32x32x8_bf16 v[24:39], v[100:101], v[118:119], 0
    s_setprio 1
    v_exp_f32 v8, v8
    v_exp_f32 v9, v9
    v_exp_f32 v10, v10
    v_exp_f32 v11, v11
    v_cvt_pk_bf16_f32 v72, v8, v9
    v_cvt_pk_bf16_f32 v73, v10, v11
    v_mfma_f32_32x32x16_bf16 v[56:71], v[92:95], v[76:79], v[56:71]
    ds_read_b128 v[88:91], v3 offset:28928
    v_exp_f32 v12, v12
    v_exp_f32 v13, v13
    v_exp_f32 v14, v14
    v_exp_f32 v15, v15
    v_cvt_pk_bf16_f32 v74, v12, v13
    v_cvt_pk_bf16_f32 v75, v14, v15
    v_mfma_f32_32x32x16_bf16 v[24:39], v[96:99], v[114:117], v[24:39]
    s_waitcnt lgkmcnt(1)
    v_exp_f32 v16, v16
    v_exp_f32 v17, v17
    v_exp_f32 v18, v18
    v_exp_f32 v19, v19
    v_cvt_pk_bf16_f32 v76, v16, v17
    v_cvt_pk_bf16_f32 v77, v18, v19
    v_mfma_f32_32x32x16_bf16 v[40:55], v[80:83], v[72:75], v[40:55]
    ds_read_b128 v[92:95], v7 offset:28928
    v_exp_f32 v20, v20
    v_exp_f32 v21, v21
    v_exp_f32 v22, v22
    v_exp_f32 v23, v23
    v_cvt_pk_bf16_f32 v78, v20, v21
    v_cvt_pk_bf16_f32 v79, v22, v23
    v_mfma_f32_32x32x8_bf16 v[8:23], v[106:107], v[112:113], 0
    s_setprio 0
    v_exp_f32 v24, v24
    v_exp_f32 v25, v25
    v_exp_f32 v26, v26
    v_exp_f32 v27, v27
    v_cvt_pk_bf16_f32 v72, v24, v25
    v_cvt_pk_bf16_f32 v73, v26, v27
    v_mfma_f32_32x32x16_bf16 v[40:55], v[84:87], v[76:79], v[40:55]
    s_cmp_eq_u64 s[46:47], -1
    s_cbranch_scc1 L_rdy_112
    s_lshl_b32 s54, 0x00010001, s91
    s_branch L_test_115
L_spin_113:
    v_cmp_eq_u32 s[46:47], 1, v218
    s_nop 1
L_test_115:
    s_and_b32 s55, s46, s47
    s_and_b32 s55, s55, s54
    s_cmp_eq_u32 s55, s54
    s_cbranch_scc1 L_got_114
    s_add_u32 s96, s96, 1
    s_cmp_gt_u32 s96, 0x100000
    s_cbranch_scc1 L_got_114
    s_sleep 1
    s_mov_b32 s56, 19570688
    buffer_load_dword v218, v216, s[20:23], s56 offen sc1
    s_waitcnt vmcnt(0)
    s_branch L_spin_113
L_got_114:
L_rdy_112:
    v_exp_f32 v28, v28
    v_exp_f32 v29, v29
    v_exp_f32 v30, v30
    v_exp_f32 v31, v31
    v_cvt_pk_bf16_f32 v74, v28, v29
    v_cvt_pk_bf16_f32 v75, v30, v31
    v_mfma_f32_32x32x16_bf16 v[8:23], v[102:105], v[108:111], v[8:23]
    s_waitcnt vmcnt(13) lgkmcnt(0)
    s_barrier
    ds_read2st64_b64 v[96:99], v1 offset0:0 offset1:1
    v_exp_f32 v32, v32
    v_exp_f32 v33, v33
    v_exp_f32 v34, v34
    v_exp_f32 v35, v35
    v_cvt_pk_bf16_f32 v76, v32, v33
    v_cvt_pk_bf16_f32 v77, v34, v35
    v_mfma_f32_32x32x16_bf16 v[56:71], v[80:83], v[72:75], v[56:71]
    ds_read_b64 v[100:101], v2 offset:1024
    s_add_u32 m0, s72, 147456
    s_mul_i32 s51, s91, 10240
    s_add_u32 s51, s51, s70
    buffer_load_dwordx4 v4, s[20:23], s51 offen sc1 lds
    v_exp_f32 v36, v36
    v_exp_f32 v37, v37
    v_exp_f32 v38, v38
    v_exp_f32 v39, v39
    v_cvt_pk_bf16_f32 v78, v36, v37
    v_cvt_pk_bf16_f32 v79, v38, v39
    v_mfma_f32_32x32x8_bf16 v[24:39], v[106:107], v[118:119], 0
    s_setprio 3
    s_add_u32 s91, s91, 1
    s_and_b32 s91, s91, 15
    buffer_load_dword v5, s[20:23], s51 offen offset:1024 sc1 lds
    v_exp_f32 v8, v8
    v_exp_f32 v9, v9
    v_exp_f32 v10, v10
    v_exp_f32 v11, v11
    v_cvt_pk_bf16_f32 v72, v8, v9
    v_cvt_pk_bf16_f32 v73, v10, v11
    v_mfma_f32_32x32x16_bf16 v[56:71], v[84:87], v[76:79], v[56:71]
    ds_read_b128 v[80:83], v3 offset:1280
    s_add_u32 s78, s76, 4096
    buffer_load_dwordx4 v[168:171], v4, s[20:23], s78 offen offset:2048 sc1
    v_exp_f32 v12, v12
    v_exp_f32 v13, v13
    v_exp_f32 v14, v14
    v_exp_f32 v15, v15
    v_cvt_pk_bf16_f32 v74, v12, v13
    v_cvt_pk_bf16_f32 v75, v14, v15
    v_mfma_f32_32x32x16_bf16 v[24:39], v[102:105], v[114:117], v[24:39]
    s_waitcnt lgkmcnt(1)
    buffer_load_dwordx4 v[176:179], v4, s[20:23], s78 offen offset:3072 sc1
    v_exp_f32 v16, v16
    v_exp_f32 v17, v17
    v_exp_f32 v18, v18
    v_exp_f32 v19, v19
    v_cvt_pk_bf16_f32 v76, v16, v17
    v_cvt_pk_bf16_f32 v77, v18, v19
    v_mfma_f32_32x32x16_bf16 v[40:55], v[88:91], v[72:75], v[40:55]
    ds_read_b128 v[84:87], v7 offset:1280
    s_add_u32 s78, s76, 73728
    buffer_load_dwordx4 v[156:159], v4, s[20:23], s78 offen sc1
    v_exp_f32 v20, v20
    v_exp_f32 v21, v21
    v_exp_f32 v22, v22
    v_exp_f32 v23, v23
    v_cvt_pk_bf16_f32 v78, v20, v21
    v_cvt_pk_bf16_f32 v79, v22, v23
    v_mfma_f32_32x32x8_bf16 v[8:23], v[100:101], v[112:113], 0
    s_setprio 2
    s_add_u32 m0, s77, 41984
    s_add_u32 s87, s75, 11264
    buffer_load_dwordx4 v4, s[20:23], s87 offen sc1 lds
    v_exp_f32 v24, v24
    v_exp_f32 v25, v25
    v_exp_f32 v26, v26
    v_exp_f32 v27, v27
    v_cvt_pk_bf16_f32 v72, v24, v25
    v_cvt_pk_bf16_f32 v73, v26, v27
    v_mfma_f32_32x32x16_bf16 v[40:55], v[92:95], v[76:79], v[40:55]
    s_add_u32 m0, s77, 43008
    s_add_u32 s87, s75, 12288
    buffer_load_dwordx4 v4, s[20:23], s87 offen sc1 lds
    v_exp_f32 v28, v28
    v_exp_f32 v29, v29
    v_exp_f32 v30, v30
    v_exp_f32 v31, v31
    v_cvt_pk_bf16_f32 v74, v28, v29
    v_cvt_pk_bf16_f32 v75, v30, v31
    v_mfma_f32_32x32x16_bf16 v[8:23], v[96:99], v[108:111], v[8:23]
    ds_read2st64_b64 v[102:105], v1 offset0:6 offset1:7
    v_exp_f32 v32, v32
    v_exp_f32 v33, v33
    v_exp_f32 v34, v34
    v_exp_f32 v35, v35
    v_cvt_pk_bf16_f32 v76, v32, v33
    v_cvt_pk_bf16_f32 v77, v34, v35
    v_mfma_f32_32x32x16_bf16 v[56:71], v[88:91], v[72:75], v[56:71]
    ds_read_b64 v[106:107], v2 offset:4096
    v_exp_f32 v36, v36
    v_exp_f32 v37, v37
    v_exp_f32 v38, v38
    v_exp_f32 v39, v39
    v_cvt_pk_bf16_f32 v78, v36, v37
    v_cvt_pk_bf16_f32 v79, v38, v39
    v_mfma_f32_32x32x8_bf16 v[24:39], v[100:101], v[118:119], 0
    s_setprio 1
    v_exp_f32 v8, v8
    v_exp_f32 v9, v9
    v_exp_f32 v10, v10
    v_exp_f32 v11, v11
    v_cvt_pk_bf16_f32 v72, v8, v9
    v_cvt_pk_bf16_f32 v73, v10, v11
    v_mfma_f32_32x32x16_bf16 v[56:71], v[92:95], v[76:79], v[56:71]
    ds_read_b128 v[88:91], v3 offset:4352
    v_exp_f32 v12, v12
    v_exp_f32 v13, v13
    v_exp_f32 v14, v14
    v_exp_f32 v15, v15
    v_cvt_pk_bf16_f32 v74, v12, v13
    v_cvt_pk_bf16_f32 v75, v14, v15
    v_mfma_f32_32x32x16_bf16 v[24:39], v[96:99], v[114:117], v[24:39]
    s_waitcnt lgkmcnt(1)
    v_exp_f32 v16, v16
    v_exp_f32 v17, v17
    v_exp_f32 v18, v18
    v_exp_f32 v19, v19
    v_cvt_pk_bf16_f32 v76, v16, v17
    v_cvt_pk_bf16_f32 v77, v18, v19
    v_mfma_f32_32x32x16_bf16 v[40:55], v[80:83], v[72:75], v[40:55]
    ds_read_b128 v[92:95], v7 offset:4352
    v_exp_f32 v20, v20
    v_exp_f32 v21, v21
    v_exp_f32 v22, v22
    v_exp_f32 v23, v23
    v_cvt_pk_bf16_f32 v78, v20, v21
    v_cvt_pk_bf16_f32 v79, v22, v23
    v_mfma_f32_32x32x8_bf16 v[8:23], v[106:107], v[112:113], 0
    s_setprio 0
    v_exp_f32 v24, v24
    v_exp_f32 v25, v25
    v_exp_f32 v26, v26
    v_exp_f32 v27, v27
    v_cvt_pk_bf16_f32 v72, v24, v25
    v_cvt_pk_bf16_f32 v73, v26, v27
    v_mfma_f32_32x32x16_bf16 v[40:55], v[84:87], v[76:79], v[40:55]
    s_cmp_eq_u64 s[46:47], -1
    s_cbranch_scc1 L_rdy_116
    s_lshl_b32 s54, 0x00010001, s91
    s_branch L_test_119
L_spin_117:
    v_cmp_eq_u32 s[46:47], 1, v218
    s_nop 1
L_test_119:
    s_and_b32 s55, s46, s47
    s_and_b32 s55, s55, s54
    s_cmp_eq_u32 s55, s54
    s_cbranch_scc1 L_got_118
    s_add_u32 s96, s96, 1
    s_cmp_gt_u32 s96, 0x100000
    s_cbranch_scc1 L_got_118
    s_sleep 1
    s_mov_b32 s56, 19570688
    buffer_load_dword v218, v216, s[20:23], s56 offen sc1
    s_waitcnt vmcnt(0)
    s_branch L_spin_117
L_got_118:
L_rdy_116:
    v_exp_f32 v28, v28
    v_exp_f32 v29, v29
    v_exp_f32 v30, v30
    v_exp_f32 v31, v31
    v_cvt_pk_bf16_f32 v74, v28, v29
    v_cvt_pk_bf16_f32 v75, v30, v31
    v_mfma_f32_32x32x16_bf16 v[8:23], v[102:105], v[108:111], v[8:23]
    s_waitcnt vmcnt(13) lgkmcnt(0)
    s_barrier
    ds_read2st64_b64 v[96:99], v1 offset0:24 offset1:25
    v_exp_f32 v32, v32
    v_exp_f32 v33, v33
    v_exp_f32 v34, v34
    v_exp_f32 v35, v35
    v_cvt_pk_bf16_f32 v76, v32, v33
    v_cvt_pk_bf16_f32 v77, v34, v35
    v_mfma_f32_32x32x16_bf16 v[56:71], v[80:83], v[72:75], v[56:71]
    ds_read_b64 v[100:101], v2 offset:13312
    s_add_u32 m0, s72, 122880
    s_mul_i32 s51, s91, 10240
    s_add_u32 s51, s51, s70
    buffer_load_dwordx4 v4, s[20:23], s51 offen sc1 lds
    v_exp_f32 v36, v36
    v_exp_f32 v37, v37
    v_exp_f32 v38, v38
    v_exp_f32 v39, v39
    v_cvt_pk_bf16_f32 v78, v36, v37
    v_cvt_pk_bf16_f32 v79, v38, v39
    v_mfma_f32_32x32x8_bf16 v[24:39], v[106:107], v[118:119], 0
    s_setprio 3
    s_add_u32 s91, s91, 1
    s_and_b32 s91, s91, 15
    buffer_load_dword v5, s[20:23], s51 offen offset:1024 sc1 lds
    v_exp_f32 v8, v8
    v_exp_f32 v9, v9
    v_exp_f32 v10, v10
    v_exp_f32 v11, v11
    v_cvt_pk_bf16_f32 v72, v8, v9
    v_cvt_pk_bf16_f32 v73, v10, v11
    v_mfma_f32_32x32x16_bf16 v[56:71], v[84:87], v[76:79], v[56:71]
    ds_read_b128 v[80:83], v3 offset:13568
    s_add_u32 s78, s76, 73728
    buffer_load_dwordx4 v[164:167], v4, s[20:23], s78 offen offset:1024 sc1
    v_exp_f32 v12, v12
    v_exp_f32 v13, v13
    v_exp_f32 v14, v14
    v_exp_f32 v15, v15
    v_cvt_pk_bf16_f32 v74, v12, v13
    v_cvt_pk_bf16_f32 v75, v14, v15
    v_mfma_f32_32x32x16_bf16 v[24:39], v[102:105], v[114:117], v[24:39]
    s_waitcnt lgkmcnt(1)
    buffer_load_dwordx4 v[172:175], v4, s[20:23], s78 offen offset:2048 sc1
    v_exp_f32 v16, v16
    v_exp_f32 v17, v17
    v_exp_f32 v18, v18
    v_exp_f32 v19, v19
    v_cvt_pk_bf16_f32 v76, v16, v17
    v_cvt_pk_bf16_f32 v77, v18, v19
    v_mfma_f32_32x32x16_bf16 v[40:55], v[88:91], v[72:75], v[40:55]
    ds_read_b128 v[84:87], v7 offset:13568
    buffer_load_dwordx4 v[180:183], v4, s[20:23], s78 offen offset:3072 sc1
    v_exp_f32 v20, v20
    v_exp_f32 v21, v21
    v_exp_f32 v22, v22
    v_exp_f32 v23, v23
    v_cvt_pk_bf16_f32 v78, v20, v21
    v_cvt_pk_bf16_f32 v79, v22, v23
    v_mfma_f32_32x32x8_bf16 v[8:23], v[100:101], v[112:113], 0
    s_setprio 2
    s_add_u32 s78, s76, 8192
    buffer_load_dwordx4 v[184:187], v4, s[20:23], s78 offen sc1
    v_exp_f32 v24, v24
    v_exp_f32 v25, v25
    v_exp_f32 v26, v26
    v_exp_f32 v27, v27
    v_cvt_pk_bf16_f32 v72, v24, v25
    v_cvt_pk_bf16_f32 v73, v26, v27
    v_mfma_f32_32x32x16_bf16 v[40:55], v[92:95], v[76:79], v[40:55]
    s_add_u32 m0, s77, 44032
    s_add_u32 s87, s75, 13312
    buffer_load_dwordx4 v4, s[20:23], s87 offen sc1 lds
    v_exp_f32 v28, v28
    v_exp_f32 v29, v29
    v_exp_f32 v30, v30
    v_exp_f32 v31, v31
    v_cvt_pk_bf16_f32 v74, v28, v29
    v_cvt_pk_bf16_f32 v75, v30, v31
    v_mfma_f32_32x32x16_bf16 v[8:23], v[96:99], v[108:111], v[8:23]
    ds_read2st64_b64 v[102:105], v1 offset0:30 offset1:31
    s_add_u32 m0, s77, 45056
    s_add_u32 s87, s75, 14336
    buffer_load_dwordx4 v4, s[20:23], s87 offen sc1 lds
    v_exp_f32 v32, v32
    v_exp_f32 v33, v33
    v_exp_f32 v34, v34
    v_exp_f32 v35, v35
    v_cvt_pk_bf16_f32 v76, v32, v33
    v_cvt_pk_bf16_f32 v77, v34, v35
    v_mfma_f32_32x32x16_bf16 v[56:71], v[88:91], v[72:75], v[56:71]
    ds_read_b64 v[106:107], v2 offset:16384
    v_exp_f32 v36, v36
    v_exp_f32 v37, v37
    v_exp_f32 v38, v38
    v_exp_f32 v39, v39
    v_cvt_pk_bf16_f32 v78, v36, v37
    v_cvt_pk_bf16_f32 v79, v38, v39
    v_mfma_f32_32x32x8_bf16 v[24:39], v[100:101], v[118:119], 0
    s_setprio 1
    v_exp_f32 v8, v8
    v_exp_f32 v9, v9
    v_exp_f32 v10, v10
    v_exp_f32 v11, v11
    v_cvt_pk_bf16_f32 v72, v8, v9
    v_cvt_pk_bf16_f32 v73, v10, v11
    v_mfma_f32_32x32x16_bf16 v[56:71], v[92:95], v[76:79], v[56:71]
    ds_read_b128 v[88:91], v3 offset:16640
    v_exp_f32 v12, v12
    v_exp_f32 v13, v13
    v_exp_f32 v14, v14
    v_exp_f32 v15, v15
    v_cvt_pk_bf16_f32 v74, v12, v13
    v_cvt_pk_bf16_f32 v75, v14, v15
    v_mfma_f32_32x32x16_bf16 v[24:39], v[96:99], v[114:117], v[24:39]
    s_waitcnt lgkmcnt(1)
    v_exp_f32 v16, v16
    v_exp_f32 v17, v17
    v_exp_f32 v18, v18
    v_exp_f32 v19, v19
    v_cvt_pk_bf16_f32 v76, v16, v17
    v_cvt_pk_bf16_f32 v77, v18, v19
    v_mfma_f32_32x32x16_bf16 v[40:55], v[80:83], v[72:75], v[40:55]
    ds_read_b128 v[92:95], v7 offset:16640
    v_exp_f32 v20, v20
    v_exp_f32 v21, v21
    v_exp_f32 v22, v22
    v_exp_f32 v23, v23
    v_cvt_pk_bf16_f32 v78, v20, v21
    v_cvt_pk_bf16_f32 v79, v22, v23
    v_mfma_f32_32x32x8_bf16 v[8:23], v[106:107], v[112:113], 0
    s_setprio 0
    v_exp_f32 v24, v24
    v_exp_f32 v25, v25
    v_exp_f32 v26, v26
    v_exp_f32 v27, v27
    v_cvt_pk_bf16_f32 v72, v24, v25
    v_cvt_pk_bf16_f32 v73, v26, v27
    v_mfma_f32_32x32x16_bf16 v[40:55], v[84:87], v[76:79], v[40:55]
    v_exp_f32 v28, v28
    v_exp_f32 v29, v29
    v_exp_f32 v30, v30
    v_exp_f32 v31, v31
    v_cvt_pk_bf16_f32 v74, v28, v29
    v_cvt_pk_bf16_f32 v75, v30, v31
    v_mfma_f32_32x32x16_bf16 v[8:23], v[102:105], v[108:111], v[8:23]
    s_waitcnt vmcnt(13) lgkmcnt(0)
    s_barrier
    ds_read2st64_b64 v[96:99], v1 offset0:48 offset1:49
    v_exp_f32 v32, v32
    v_exp_f32 v33, v33
    v_exp_f32 v34, v34
    v_exp_f32 v35, v35
    v_cvt_pk_bf16_f32 v76, v32, v33
    v_cvt_pk_bf16_f32 v77, v34, v35
    v_mfma_f32_32x32x16_bf16 v[56:71], v[80:83], v[72:75], v[56:71]
    ds_read_b64 v[100:101], v2 offset:25600
    s_add_u32 s78, s76, 8192
    buffer_load_dwordx4 v[192:195], v4, s[20:23], s78 offen offset:1024 sc1
    v_exp_f32 v36, v36
    v_exp_f32 v37, v37
    v_exp_f32 v38, v38
    v_exp_f32 v39, v39
    v_cvt_pk_bf16_f32 v78, v36, v37
    v_cvt_pk_bf16_f32 v79, v38, v39
    v_mfma_f32_32x32x8_bf16 v[24:39], v[106:107], v[118:119], 0
    s_setprio 3
    buffer_load_dwordx4 v[200:203], v4, s[20:23], s78 offen offset:2048 sc1
    v_exp_f32 v8, v8
    v_exp_f32 v9, v9
    v_exp_f32 v10, v10
    v_exp_f32 v11, v11
    v_cvt_pk_bf16_f32 v72, v8, v9
    v_cvt_pk_bf16_f32 v73, v10, v11
    v_mfma_f32_32x32x16_bf16 v[56:71], v[84:87], v[76:79], v[56:71]
    ds_read_b128 v[80:83], v3 offset:25856
    buffer_load_dwordx4 v[208:211], v4, s[20:23], s78 offen offset:3072 sc1
    v_exp_f32 v12, v12
    v_exp_f32 v13, v13
    v_exp_f32 v14, v14
    v_exp_f32 v15, v15
    v_cvt_pk_bf16_f32 v74, v12, v13
    v_cvt_pk_bf16_f32 v75, v14, v15
    v_mfma_f32_32x32x16_bf16 v[24:39], v[102:105], v[114:117], v[24:39]
    s_waitcnt lgkmcnt(1)
    s_add_u32 m0, s77, 81920
    s_add_u32 s87, s75, 20480
    buffer_load_dwordx4 v4, s[20:23], s87 offen sc1 lds
    v_exp_f32 v16, v16
    v_exp_f32 v17, v17
    v_exp_f32 v18, v18
    v_exp_f32 v19, v19
    v_cvt_pk_bf16_f32 v76, v16, v17
    v_cvt_pk_bf16_f32 v77, v18, v19
    v_mfma_f32_32x32x16_bf16 v[40:55], v[88:91], v[72:75], v[40:55]
    ds_read_b128 v[84:87], v7 offset:25856
    s_add_u32 m0, s77, 82944
    s_add_u32 s87, s75, 21504
    buffer_load_dwordx4 v4, s[20:23], s87 offen sc1 lds
    v_exp_f32 v20, v20
    v_exp_f32 v21, v21
    v_exp_f32 v22, v22
    v_exp_f32 v23, v23
    v_cvt_pk_bf16_f32 v78, v20, v21
    v_cvt_pk_bf16_f32 v79, v22, v23
    v_mfma_f32_32x32x8_bf16 v[8:23], v[100:101], v[112:113], 0
    s_setprio 2
    v_exp_f32 v24, v24
    v_exp_f32 v25, v25
    v_exp_f32 v26, v26
    v_exp_f32 v27, v27
    v_cvt_pk_bf16_f32 v72, v24, v25
    v_cvt_pk_bf16_f32 v73, v26, v27
    v_mfma_f32_32x32x16_bf16 v[40:55], v[92:95], v[76:79], v[40:55]
    v_exp_f32 v28, v28
    v_exp_f32 v29, v29
    v_exp_f32 v30, v30
    v_exp_f32 v31, v31
    v_cvt_pk_bf16_f32 v74, v28, v29
    v_cvt_pk_bf16_f32 v75, v30, v31
    v_mfma_f32_32x32x16_bf16 v[8:23], v[96:99], v[108:111], v[8:23]
    ds_read2st64_b64 v[102:105], v1 offset0:54 offset1:55
    v_exp_f32 v32, v32
    v_exp_f32 v33, v33
    v_exp_f32 v34, v34
    v_exp_f32 v35, v35
    v_cvt_pk_bf16_f32 v76, v32, v33
    v_cvt_pk_bf16_f32 v77, v34, v35
    v_mfma_f32_32x32x16_bf16 v[56:71], v[88:91], v[72:75], v[56:71]
    ds_read_b64 v[106:107], v2 offset:28672
    v_exp_f32 v36, v36
    v_exp_f32 v37, v37
    v_exp_f32 v38, v38
    v_exp_f32 v39, v39
    v_cvt_pk_bf16_f32 v78, v36, v37
    v_cvt_pk_bf16_f32 v79, v38, v39
    v_mfma_f32_32x32x8_bf16 v[24:39], v[100:101], v[118:119], 0
    s_setprio 1
    v_exp_f32 v8, v8
    v_exp_f32 v9, v9
    v_exp_f32 v10, v10
    v_exp_f32 v11, v11
    v_cvt_pk_bf16_f32 v72, v8, v9
    v_cvt_pk_bf16_f32 v73, v10, v11
    v_mfma_f32_32x32x16_bf16 v[56:71], v[92:95], v[76:79], v[56:71]
    ds_read_b128 v[88:91], v3 offset:28928
    v_exp_f32 v12, v12
    v_exp_f32 v13, v13
    v_exp_f32 v14, v14
    v_exp_f32 v15, v15
    v_cvt_pk_bf16_f32 v74, v12, v13
    v_cvt_pk_bf16_f32 v75, v14, v15
    v_mfma_f32_32x32x16_bf16 v[24:39], v[96:99], v[114:117], v[24:39]
    s_waitcnt lgkmcnt(1)
    v_exp_f32 v16, v16
    v_exp_f32 v17, v17
    v_exp_f32 v18, v18
    v_exp_f32 v19, v19
    v_cvt_pk_bf16_f32 v76, v16, v17
    v_cvt_pk_bf16_f32 v77, v18, v19
    v_mfma_f32_32x32x16_bf16 v[40:55], v[80:83], v[72:75], v[40:55]
    ds_read_b128 v[92:95], v7 offset:28928
    v_exp_f32 v20, v20
    v_exp_f32 v21, v21
    v_exp_f32 v22, v22
    v_exp_f32 v23, v23
    v_cvt_pk_bf16_f32 v78, v20, v21
    v_cvt_pk_bf16_f32 v79, v22, v23
    v_mfma_f32_32x32x8_bf16 v[8:23], v[106:107], v[112:113], 0
    s_setprio 0
    v_exp_f32 v24, v24
    v_exp_f32 v25, v25
    v_exp_f32 v26, v26
    v_exp_f32 v27, v27
    v_cvt_pk_bf16_f32 v72, v24, v25
    v_cvt_pk_bf16_f32 v73, v26, v27
    v_mfma_f32_32x32x16_bf16 v[40:55], v[84:87], v[76:79], v[40:55]
    v_exp_f32 v28, v28
    v_exp_f32 v29, v29
    v_exp_f32 v30, v30
    v_exp_f32 v31, v31
    v_cvt_pk_bf16_f32 v74, v28, v29
    v_cvt_pk_bf16_f32 v75, v30, v31
    v_mfma_f32_32x32x16_bf16 v[8:23], v[102:105], v[108:111], v[8:23]
    s_waitcnt vmcnt(11) lgkmcnt(0)
    s_barrier
    ds_read2st64_b64 v[96:99], v1 offset0:0 offset1:1
    v_exp_f32 v32, v32
    v_exp_f32 v33, v33
    v_exp_f32 v34, v34
    v_exp_f32 v35, v35
    v_cvt_pk_bf16_f32 v76, v32, v33
    v_cvt_pk_bf16_f32 v77, v34, v35
    v_mfma_f32_32x32x16_bf16 v[56:71], v[80:83], v[72:75], v[56:71]
    ds_read_b64 v[100:101], v2 offset:1024
    s_add_u32 s78, s76, 77824
    buffer_load_dwordx4 v[188:191], v4, s[20:23], s78 offen sc1
    v_exp_f32 v36, v36
    v_exp_f32 v37, v37
    v_exp_f32 v38, v38
    v_exp_f32 v39, v39
    v_cvt_pk_bf16_f32 v78, v36, v37
    v_cvt_pk_bf16_f32 v79, v38, v39
    v_mfma_f32_32x32x8_bf16 v[24:39], v[106:107], v[118:119], 0
    s_setprio 3
    buffer_load_dwordx4 v[196:199], v4, s[20:23], s78 offen offset:1024 sc1
    v_exp_f32 v8, v8
    v_exp_f32 v9, v9
    v_exp_f32 v10, v10
    v_exp_f32 v11, v11
    v_cvt_pk_bf16_f32 v72, v8, v9
    v_cvt_pk_bf16_f32 v73, v10, v11
    v_mfma_f32_32x32x16_bf16 v[56:71], v[84:87], v[76:79], v[56:71]
    ds_read_b128 v[80:83], v3 offset:1280
    buffer_load_dwordx4 v[204:207], v4, s[20:23], s78 offen offset:2048 sc1
    v_exp_f32 v12, v12
    v_exp_f32 v13, v13
    v_exp_f32 v14, v14
    v_exp_f32 v15, v15
    v_cvt_pk_bf16_f32 v74, v12, v13
    v_cvt_pk_bf16_f32 v75, v14, v15
    v_mfma_f32_32x32x16_bf16 v[24:39], v[102:105], v[114:117], v[24:39]
    s_waitcnt lgkmcnt(1)
    buffer_load_dwordx4 v[212:215], v4, s[20:23], s78 offen offset:3072 sc1
    v_exp_f32 v16, v16
    v_exp_f32 v17, v17
    v_exp_f32 v18, v18
    v_exp_f32 v19, v19
    v_cvt_pk_bf16_f32 v76, v16, v17
    v_cvt_pk_bf16_f32 v77, v18, v19
    v_mfma_f32_32x32x16_bf16 v[40:55], v[88:91], v[72:75], v[40:55]
    ds_read_b128 v[84:87], v7 offset:1280
    s_add_u32 m0, s77, 83968
    s_add_u32 s87, s75, 22528
    buffer_load_dwordx4 v4, s[20:23], s87 offen sc1 lds
    v_exp_f32 v20, v20
    v_exp_f32 v21, v21
    v_exp_f32 v22, v22
    v_exp_f32 v23, v23
    v_cvt_pk_bf16_f32 v78, v20, v21
    v_cvt_pk_bf16_f32 v79, v22, v23
    v_mfma_f32_32x32x8_bf16 v[8:23], v[100:101], v[112:113], 0
    s_add_u32 m0, s77, 84992
    s_add_u32 s87, s75, 23552
    buffer_load_dwordx4 v4, s[20:23], s87 offen sc1 lds
    v_exp_f32 v24, v24
    v_exp_f32 v25, v25
    v_exp_f32 v26, v26
    v_exp_f32 v27, v27
    v_cvt_pk_bf16_f32 v72, v24, v25
    v_cvt_pk_bf16_f32 v73, v26, v27
    v_mfma_f32_32x32x16_bf16 v[40:55], v[92:95], v[76:79], v[40:55]
    s_add_u32 m0, s77, 86016
    s_add_u32 s87, s75, 24576
    buffer_load_dwordx4 v4, s[20:23], s87 offen sc1 lds
    v_exp_f32 v28, v28
    v_exp_f32 v29, v29
    v_exp_f32 v30, v30
    v_exp_f32 v31, v31
    v_cvt_pk_bf16_f32 v74, v28, v29
    v_cvt_pk_bf16_f32 v75, v30, v31
    v_mfma_f32_32x32x16_bf16 v[8:23], v[96:99], v[108:111], v[8:23]
    ds_read2st64_b64 v[102:105], v1 offset0:6 offset1:7
    s_mov_b32 s28, s42
    s_mov_b32 s29, s43
    s_mov_b32 s30, 1280
    s_mov_b32 s31, 0x00020000
    v_lshrrev_b32 v244, 4, v0
    v_lshlrev_b32 v245, 3, v244
    v_lshlrev_b32 v244, 4, v244
    s_mul_i32 s51, s74, 160
    buffer_load_dwordx4 v[232:235], v244, s[28:31], s51 offen
    buffer_load_dwordx4 v[236:239], v244, s[28:31], s51 offen offset:64
    buffer_load_dwordx2 v[240:241], v245, s[28:31], s51 offen offset:128
    s_and_b32 s51, s48, 1
    s_lshl_b32 s52, s73, 1
    s_add_u32 s51, s51, s52
    s_lshl_b32 s51, s51, 7
    s_add_u32 s51, s51, 19562496
    v_and_b32 v244, 15, v0
    v_lshlrev_b32 v244, 2, v244
    buffer_load_dword v242, v244, s[20:23], s51 offen sc1
    buffer_load_dword v243, v244, s[20:23], s51 offen offset:64 sc1
    v_exp_f32 v32, v32
    v_exp_f32 v33, v33
    v_exp_f32 v34, v34
    v_exp_f32 v35, v35
    v_cvt_pk_bf16_f32 v76, v32, v33
    v_cvt_pk_bf16_f32 v77, v34, v35
    v_mfma_f32_32x32x16_bf16 v[56:71], v[88:91], v[72:75], v[56:71]
    ds_read_b64 v[106:107], v2 offset:4096
    v_exp_f32 v36, v36
    v_exp_f32 v37, v37
    v_exp_f32 v38, v38
    v_exp_f32 v39, v39
    v_cvt_pk_bf16_f32 v78, v36, v37
    v_cvt_pk_bf16_f32 v79, v38, v39
    v_mfma_f32_32x32x8_bf16 v[24:39], v[100:101], v[118:119], 0
    s_setprio 2
    v_exp_f32 v8, v8
    v_exp_f32 v9, v9
    v_exp_f32 v10, v10
    v_exp_f32 v11, v11
    v_cvt_pk_bf16_f32 v72, v8, v9
    v_cvt_pk_bf16_f32 v73, v10, v11
    v_mfma_f32_32x32x16_bf16 v[56:71], v[92:95], v[76:79], v[56:71]
    ds_read_b128 v[88:91], v3 offset:4352
    v_exp_f32 v12, v12
    v_exp_f32 v13, v13
    v_exp_f32 v14, v14
    v_exp_f32 v15, v15
    v_cvt_pk_bf16_f32 v74, v12, v13
    v_cvt_pk_bf16_f32 v75, v14, v15
    v_mfma_f32_32x32x16_bf16 v[24:39], v[96:99], v[114:117], v[24:39]
    s_waitcnt lgkmcnt(1)
    v_exp_f32 v16, v16
    v_exp_f32 v17, v17
    v_exp_f32 v18, v18
    v_exp_f32 v19, v19
    v_cvt_pk_bf16_f32 v76, v16, v17
    v_cvt_pk_bf16_f32 v77, v18, v19
    v_mfma_f32_32x32x16_bf16 v[40:55], v[80:83], v[72:75], v[40:55]
    ds_read_b128 v[92:95], v7 offset:4352
    v_exp_f32 v20, v20
    v_exp_f32 v21, v21
    v_exp_f32 v22, v22
    v_exp_f32 v23, v23
    v_cvt_pk_bf16_f32 v78, v20, v21
    v_cvt_pk_bf16_f32 v79, v22, v23
    v_mfma_f32_32x32x8_bf16 v[8:23], v[106:107], v[112:113], 0
    v_exp_f32 v24, v24
    v_exp_f32 v25, v25
    v_exp_f32 v26, v26
    v_exp_f32 v27, v27
    v_cvt_pk_bf16_f32 v72, v24, v25
    v_cvt_pk_bf16_f32 v73, v26, v27
    v_mfma_f32_32x32x16_bf16 v[40:55], v[84:87], v[76:79], v[40:55]
    v_exp_f32 v28, v28
    v_exp_f32 v29, v29
    v_exp_f32 v30, v30
    v_exp_f32 v31, v31
    v_cvt_pk_bf16_f32 v74, v28, v29
    v_cvt_pk_bf16_f32 v75, v30, v31
    v_mfma_f32_32x32x16_bf16 v[8:23], v[102:105], v[108:111], v[8:23]
    v_exp_f32 v32, v32
    v_exp_f32 v33, v33
    v_exp_f32 v34, v34
    v_exp_f32 v35, v35
    v_cvt_pk_bf16_f32 v76, v32, v33
    v_cvt_pk_bf16_f32 v77, v34, v35
    v_mfma_f32_32x32x16_bf16 v[56:71], v[80:83], v[72:75], v[56:71]
    v_exp_f32 v36, v36
    v_exp_f32 v37, v37
    v_exp_f32 v38, v38
    v_exp_f32 v39, v39
    v_cvt_pk_bf16_f32 v78, v36, v37
    v_cvt_pk_bf16_f32 v79, v38, v39
    v_mfma_f32_32x32x8_bf16 v[24:39], v[106:107], v[118:119], 0
    s_setprio 1
    v_exp_f32 v8, v8
    v_exp_f32 v9, v9
    v_exp_f32 v10, v10
    v_exp_f32 v11, v11
    v_cvt_pk_bf16_f32 v72, v8, v9
    v_cvt_pk_bf16_f32 v73, v10, v11
    v_mfma_f32_32x32x16_bf16 v[56:71], v[84:87], v[76:79], v[56:71]
    v_exp_f32 v12, v12
    v_exp_f32 v13, v13
    v_exp_f32 v14, v14
    v_exp_f32 v15, v15
    v_cvt_pk_bf16_f32 v74, v12, v13
    v_cvt_pk_bf16_f32 v75, v14, v15
    v_mfma_f32_32x32x16_bf16 v[24:39], v[102:105], v[114:117], v[24:39]
    s_waitcnt lgkmcnt(0)
    v_exp_f32 v16, v16
    v_exp_f32 v17, v17
    v_exp_f32 v18, v18
    v_exp_f32 v19, v19
    v_cvt_pk_bf16_f32 v76, v16, v17
    v_cvt_pk_bf16_f32 v77, v18, v19
    v_mfma_f32_32x32x16_bf16 v[40:55], v[88:91], v[72:75], v[40:55]
    v_exp_f32 v20, v20
    v_exp_f32 v21, v21
    v_exp_f32 v22, v22
    v_exp_f32 v23, v23
    v_cvt_pk_bf16_f32 v78, v20, v21
    v_cvt_pk_bf16_f32 v79, v22, v23
    s_setprio 0
    v_exp_f32 v24, v24
    v_exp_f32 v25, v25
    v_exp_f32 v26, v26
    v_exp_f32 v27, v27
    v_cvt_pk_bf16_f32 v72, v24, v25
    v_cvt_pk_bf16_f32 v73, v26, v27
    v_mfma_f32_32x32x16_bf16 v[40:55], v[92:95], v[76:79], v[40:55]
    v_exp_f32 v28, v28
    v_exp_f32 v29, v29
    v_exp_f32 v30, v30
    v_exp_f32 v31, v31
    v_cvt_pk_bf16_f32 v74, v28, v29
    v_cvt_pk_bf16_f32 v75, v30, v31
    v_exp_f32 v32, v32
    v_exp_f32 v33, v33
    v_exp_f32 v34, v34
    v_exp_f32 v35, v35
    v_cvt_pk_bf16_f32 v76, v32, v33
    v_cvt_pk_bf16_f32 v77, v34, v35
    v_mfma_f32_32x32x16_bf16 v[56:71], v[88:91], v[72:75], v[56:71]
    v_exp_f32 v36, v36
    v_exp_f32 v37, v37
    v_exp_f32 v38, v38
    v_exp_f32 v39, v39
    v_cvt_pk_bf16_f32 v78, v36, v37
    v_cvt_pk_bf16_f32 v79, v38, v39
    s_nop 1
    v_mfma_f32_32x32x16_bf16 v[56:71], v[92:95], v[76:79], v[56:71]
    s_setprio 0
    s_nop 10
    ds_write_b128 v224, v[56:59] offset:0
    ds_write_b128 v224, v[60:63] offset:1024
    ds_write_b128 v224, v[64:67] offset:2048
    ds_write_b32 v225, v68 offset:3072
    s_waitcnt lgkmcnt(0)
    s_barrier
    ds_read_b32 v20, v227 offset:3072
    ds_read_b128 v[8:11], v226 offset:0
    ds_read_b128 v[12:15], v226 offset:1024
    ds_read_b128 v[16:19], v226 offset:2048
    s_mov_b32 s51, 0x53800000
    s_waitcnt lgkmcnt(3)
    v_add_f32 v52, v52, v20
    v_mov_b32 v25, v52
    s_waitcnt lgkmcnt(2)
    v_add_f32 v40, v40, v8
    v_add_f32 v41, v41, v9
    v_add_f32 v42, v42, v10
    v_add_f32 v43, v43, v11
    v_fma_f32 v25, v40, 0, v25
    v_fma_f32 v25, v41, 0, v25
    v_fma_f32 v25, v42, 0, v25
    v_fma_f32 v25, v43, 0, v25
    s_waitcnt lgkmcnt(1)
    v_add_f32 v44, v44, v12
    v_add_f32 v45, v45, v13
    v_add_f32 v46, v46, v14
    v_add_f32 v47, v47, v15
    v_fma_f32 v25, v44, 0, v25
    v_fma_f32 v25, v45, 0, v25
    v_fma_f32 v25, v46, 0, v25
    v_fma_f32 v25, v47, 0, v25
    s_waitcnt lgkmcnt(0)
    v_add_f32 v48, v48, v16
    v_add_f32 v49, v49, v17
    v_add_f32 v50, v50, v18
    v_add_f32 v51, v51, v19
    v_fma_f32 v25, v48, 0, v25
    v_fma_f32 v25, v49, 0, v25
    v_fma_f32 v25, v50, 0, v25
    v_fma_f32 v25, v51, 0, v25
    v_cmp_le_f32 vcc, 0x33800000, v25
    v_cmp_ge_f32 s[66:67], s51, v25
    s_nop 1
    s_and_b64 vcc, vcc, s[66:67]
    s_cmp_eq_u64 vcc, -1
    s_cbranch_scc1 L_fast_120
    s_waitcnt vmcnt(0)
    s_mov_b32 s64, 0x000fffff
    s_mov_b32 s65, 0x000fffff
    v_mov_b32 v80, 0x3f803f80
    v_mov_b32 v81, 0x3f803f80
    v_mov_b32 v82, 0x3f803f80
    v_mov_b32 v83, 0x3f803f80
    v_mov_b32 v84, 0x3f803f80
    v_mov_b32 v85, 0x3f803f80
    v_mov_b32 v86, 0x3f803f80
    v_mov_b32 v87, 0x3f803f80
    s_mul_i32 s51, s71, 6144
    s_add_u32 s51, s51, 122880
    v_subrev_u32 v1, s51, v1
    v_and_b32 v2, 31, v0
    v_lshlrev_b32 v2, 3, v2
    v_subrev_u32 v3, s51, v3
    s_mul_i32 s53, s68, 163840
    s_add_u32 s53, s53, 2621440
    v_mov_b32 v79, 0xff800000
    s_mov_b32 s52, 0
L_fb1_121:
    s_add_u32 s51, s53, s52
    buffer_load_dwordx2 v[96:97], v1, s[20:23], s51 offen sc1
    buffer_load_dwordx2 v[98:99], v1, s[20:23], s51 offen offset:512 sc1
    buffer_load_dwordx2 v[100:101], v2, s[20:23], s51 offen offset:1024 sc1
    s_waitcnt vmcnt(0)
    v_mfma_f32_32x32x8_bf16 v[8:23], v[100:101], v[112:113], 0
    s_nop 9
    v_mfma_f32_32x32x16_bf16 v[8:23], v[96:99], v[108:111], v[8:23]
    s_nop 11
    v_max3_f32 v79, v79, v8, v9
    v_max3_f32 v79, v79, v10, v11
    v_max3_f32 v79, v79, v12, v13
    v_max3_f32 v79, v79, v14, v15
    v_max3_f32 v79, v79, v16, v17
    v_max3_f32 v79, v79, v18, v19
    v_max3_f32 v79, v79, v20, v21
    v_max3_f32 v79, v79, v22, v23
    s_add_u32 s52, s52, 2560
    s_cmp_lt_u32 s52, 163840
    s_cbranch_scc1 L_fb1_121
    v_mov_b32 v78, v79
    s_nop 1
    v_permlane32_swap_b32 v79, v78
    s_nop 1
    v_max_f32 v79, v79, v78
    v_sub_f32 v56, 0, v79
    v_mov_b32 v40, 0
    v_sub_f32 v57, 0, v79
    v_mov_b32 v41, 0
    v_sub_f32 v58, 0, v79
    v_mov_b32 v42, 0
    v_sub_f32 v59, 0, v79
    v_mov_b32 v43, 0
    v_sub_f32 v60, 0, v79
    v_mov_b32 v44, 0
    v_sub_f32 v61, 0, v79
    v_mov_b32 v45, 0
    v_sub_f32 v62, 0, v79
    v_mov_b32 v46, 0
    v_sub_f32 v63, 0, v79
    v_mov_b32 v47, 0
    v_sub_f32 v64, 0, v79
    v_mov_b32 v48, 0
    v_sub_f32 v65, 0, v79
    v_mov_b32 v49, 0
    v_sub_f32 v66, 0, v79
    v_mov_b32 v50, 0
    v_sub_f32 v67, 0, v79
    v_mov_b32 v51, 0
    v_sub_f32 v68, 0, v79
    v_mov_b32 v52, 0
    v_sub_f32 v69, 0, v79
    v_mov_b32 v53, 0
    v_sub_f32 v70, 0, v79
    v_mov_b32 v54, 0
    v_sub_f32 v71, 0, v79
    v_mov_b32 v55, 0
    s_mov_b32 s52, 0
L_fb2_122:
    s_add_u32 s51, s53, s52
    buffer_load_dwordx2 v[96:97], v1, s[20:23], s51 offen sc1
    buffer_load_dwordx2 v[98:99], v1, s[20:23], s51 offen offset:512 sc1
    buffer_load_dwordx2 v[100:101], v2, s[20:23], s51 offen offset:1024 sc1
    s_mov_b64 exec, s[64:65]
    buffer_load_dwordx4 v[80:83], v3, s[20:23], s51 offen offset:1280 sc1
    buffer_load_dwordx4 v[84:87], v3, s[20:23], s51 offen offset:1920 sc1
    s_mov_b64 exec, -1
    s_waitcnt vmcnt(0)
    v_mfma_f32_32x32x8_bf16 v[8:23], v[100:101], v[112:113], v[56:71]
    s_nop 9
    v_mfma_f32_32x32x16_bf16 v[8:23], v[96:99], v[108:111], v[8:23]
    s_nop 11
    v_exp_f32 v8, v8
    v_exp_f32 v9, v9
    v_exp_f32 v10, v10
    v_exp_f32 v11, v11
    v_exp_f32 v12, v12
    v_exp_f32 v13, v13
    v_exp_f32 v14, v14
    v_exp_f32 v15, v15
    v_exp_f32 v16, v16
    v_exp_f32 v17, v17
    v_exp_f32 v18, v18
    v_exp_f32 v19, v19
    v_exp_f32 v20, v20
    v_exp_f32 v21, v21
    v_exp_f32 v22, v22
    v_exp_f32 v23, v23
    s_nop 0
    v_cvt_pk_bf16_f32 v72, v8, v9
    v_cvt_pk_bf16_f32 v73, v10, v11
    v_cvt_pk_bf16_f32 v74, v12, v13
    v_cvt_pk_bf16_f32 v75, v14, v15
    v_cvt_pk_bf16_f32 v76, v16, v17
    v_cvt_pk_bf16_f32 v77, v18, v19
    v_cvt_pk_bf16_f32 v78, v20, v21
    v_cvt_pk_bf16_f32 v79, v22, v23
    s_nop 1
    v_mfma_f32_32x32x16_bf16 v[40:55], v[80:83], v[72:75], v[40:55]
    v_mfma_f32_32x32x16_bf16 v[40:55], v[84:87], v[76:79], v[40:55]
    s_add_u32 s52, s52, 2560
    s_cmp_lt_u32 s52, 163840
    s_cbranch_scc1 L_fb2_122
    s_nop 11
L_fast_120:
    v_rcp_f32 v24, v52
    s_nop 0
    v_mul_f32 v24, v222, v24
    v_mul_f32 v40, v24, v40
    v_mul_f32 v41, v24, v41
    v_mul_f32 v42, v24, v42
    v_mul_f32 v43, v24, v43
    v_mul_f32 v44, v24, v44
    v_mul_f32 v45, v24, v45
    v_mul_f32 v46, v24, v46
    v_mul_f32 v47, v24, v47
    v_mul_f32 v48, v24, v48
    v_mul_f32 v49, v24, v49
    v_mul_f32 v50, v24, v50
    v_mul_f32 v51, v24, v51
    v_cvt_pk_bf16_f32 v8, v40, v41
    v_cvt_pk_bf16_f32 v9, v42, v43
    v_cvt_pk_bf16_f32 v10, v44, v45
    v_cvt_pk_bf16_f32 v11, v46, v47
    v_cvt_pk_bf16_f32 v12, v48, v49
    v_cvt_pk_bf16_f32 v13, v50, v51
    v_min_u32 v8, -2, v8
    v_min_u32 v9, -2, v9
    v_min_u32 v10, -2, v10
    v_min_u32 v11, -2, v11
    v_min_u32 v12, -2, v12
    v_min_u32 v13, -2, v13
    buffer_store_dwordx4 v[8:11], v220, s[20:23], s4 offen sc1
    s_mov_b32 exec_hi, 0
    buffer_store_dwordx2 v[12:13], v221, s[20:23], s5 offen sc1
    s_mov_b32 exec_hi, -1
    s_waitcnt vmcnt(2)
    s_cmp_lt_u32 s48, 2
    s_cselect_b32 s53, 0xffff0000, 0
    v_lshlrev_b32 v88, 16, v232
    v_and_b32 v88, s53, v88
    v_and_b32 v89, s53, v232
    v_lshlrev_b32 v90, 16, v233
    v_and_b32 v90, s53, v90
    v_and_b32 v91, s53, v233
    v_lshlrev_b32 v92, 16, v234
    v_and_b32 v92, s53, v92
    v_and_b32 v93, s53, v234
    v_lshlrev_b32 v94, 16, v235
    v_and_b32 v94, s53, v94
    v_and_b32 v95, s53, v235
    v_lshlrev_b32 v96, 16, v236
    v_and_b32 v96, s53, v96
    v_and_b32 v97, s53, v236
    v_lshlrev_b32 v98, 16, v237
    v_and_b32 v98, s53, v98
    v_and_b32 v99, s53, v237
    v_lshlrev_b32 v100, 16, v238
    v_and_b32 v100, s53, v100
    v_and_b32 v101, s53, v238
    v_lshlrev_b32 v102, 16, v239
    v_and_b32 v102, s53, v102
    v_and_b32 v103, s53, v239
    v_lshlrev_b32 v104, 16, v240
    v_and_b32 v104, s53, v104
    v_and_b32 v105, s53, v240
    v_lshlrev_b32 v106, 16, v241
    v_and_b32 v106, s53, v106
    v_and_b32 v107, s53, v241
    v_sub_f32 v108, 1.0, v242
    v_cvt_pk_bf16_f32 v108, v108, v108
    v_and_b32 v108, 0xffff0000, v108
    v_sub_f32 v109, 1.0, v243
    v_cvt_pk_bf16_f32 v109, v109, v109
    v_and_b32 v109, 0xffff0000, v109
    s_lshr_b32 s51, s48, 1
    s_mul_i32 s51, s51, 10240
    v_add_u32 v1, s51, v4
    v_add_u32 v2, 81920, v1
    s_waitcnt lgkmcnt(0)
    s_barrier
    ds_read_b128 v[48:51], v1 offset:0
    s_add_u32 m0, s77, 122880
    s_add_u32 s87, s75, 30720
    buffer_load_dwordx4 v4, s[20:23], s87 offen sc1 lds
    ds_read_b128 v[52:55], v1 offset:1024
    ds_read_b128 v[56:59], v1 offset:2048
    buffer_load_dwordx4 v4, s[20:23], s87 offen offset:1024 sc1 lds
    ds_read_b128 v[60:63], v1 offset:3072
    ds_read_b128 v[64:67], v1 offset:4096
    buffer_load_dwordx4 v4, s[20:23], s87 offen offset:2048 sc1 lds
    s_waitcnt lgkmcnt(4)
    v_mfma_f32_16x16x32_bf16 v[8:11], v[48:51], v[120:123], v[88:91]
    ds_read_b128 v[68:71], v1 offset:5120
    ds_read_b128 v[72:75], v1 offset:6144
    v_mfma_f32_16x16x32_bf16 v[28:31], v[48:51], v[124:127], v[88:91]
    buffer_load_dwordx4 v4, s[20:23], s87 offen offset:3072 sc1 lds
    s_waitcnt lgkmcnt(5)
    v_mfma_f32_16x16x32_bf16 v[12:15], v[52:55], v[120:123], v[92:95]
    ds_read_b128 v[76:79], v1 offset:7168
    ds_read_b128 v[80:83], v1 offset:8192
    v_mfma_f32_16x16x32_bf16 v[32:35], v[52:55], v[124:127], v[92:95]
    s_waitcnt lgkmcnt(6)
    v_mfma_f32_16x16x32_bf16 v[16:19], v[56:59], v[120:123], v[96:99]
    ds_read_b128 v[84:87], v1 offset:9216
    v_mfma_f32_16x16x32_bf16 v[36:39], v[56:59], v[124:127], v[96:99]
    s_add_u32 m0, s77, 126976
    s_add_u32 s87, s75, 34816
    buffer_load_dwordx4 v4, s[20:23], s87 offen sc1 lds
    s_waitcnt lgkmcnt(6)
    v_mfma_f32_16x16x32_bf16 v[20:23], v[60:63], v[120:123], v[100:103]
    v_mfma_f32_16x16x32_bf16 v[40:43], v[60:63], v[124:127], v[100:103]
    s_waitcnt lgkmcnt(5)
    v_mfma_f32_16x16x32_bf16 v[24:27], v[64:67], v[120:123], v[104:107]
    v_mfma_f32_16x16x32_bf16 v[44:47], v[64:67], v[124:127], v[104:107]
    s_waitcnt lgkmcnt(0)
    s_barrier
    v_mfma_f32_16x16x32_bf16 v[8:11], v[68:71], v[128:131], v[8:11]
    ds_read_b128 v[48:51], v1 offset:40960
    v_mfma_f32_16x16x32_bf16 v[28:31], v[68:71], v[132:135], v[28:31]
    s_add_u32 m0, s77, 0
    s_add_u32 s87, s75, 40960
    buffer_load_dwordx4 v4, s[20:23], s87 offen sc1 lds
    v_mfma_f32_16x16x32_bf16 v[12:15], v[72:75], v[128:131], v[12:15]
    ds_read_b128 v[52:55], v1 offset:41984
    v_mfma_f32_16x16x32_bf16 v[32:35], v[72:75], v[132:135], v[32:35]
    v_mfma_f32_16x16x32_bf16 v[16:19], v[76:79], v[128:131], v[16:19]
    ds_read_b128 v[56:59], v1 offset:43008
    v_mfma_f32_16x16x32_bf16 v[36:39], v[76:79], v[132:135], v[36:39]
    buffer_load_dwordx4 v4, s[20:23], s87 offen offset:1024 sc1 lds
    v_mfma_f32_16x16x32_bf16 v[20:23], v[80:83], v[128:131], v[20:23]
    ds_read_b128 v[60:63], v1 offset:44032
    v_mfma_f32_16x16x32_bf16 v[40:43], v[80:83], v[132:135], v[40:43]
    v_mfma_f32_16x16x32_bf16 v[24:27], v[84:87], v[128:131], v[24:27]
    ds_read_b128 v[64:67], v1 offset:45056
    v_mfma_f32_16x16x32_bf16 v[44:47], v[84:87], v[132:135], v[44:47]
    buffer_load_dwordx4 v4, s[20:23], s87 offen offset:2048 sc1 lds
    s_waitcnt lgkmcnt(4)
    v_mfma_f32_16x16x32_bf16 v[8:11], v[48:51], v[136:139], v[8:11]
    ds_read_b128 v[68:71], v1 offset:46080
    ds_read_b128 v[72:75], v1 offset:47104
    v_mfma_f32_16x16x32_bf16 v[28:31], v[48:51], v[140:143], v[28:31]
    buffer_load_dwordx4 v4, s[20:23], s87 offen offset:3072 sc1 lds
    s_waitcnt lgkmcnt(5)
    v_mfma_f32_16x16x32_bf16 v[12:15], v[52:55], v[136:139], v[12:15]
    ds_read_b128 v[76:79], v1 offset:48128
    ds_read_b128 v[80:83], v1 offset:49152
    v_mfma_f32_16x16x32_bf16 v[32:35], v[52:55], v[140:143], v[32:35]
    s_waitcnt lgkmcnt(6)
    v_mfma_f32_16x16x32_bf16 v[16:19], v[56:59], v[136:139], v[16:19]
    ds_read_b128 v[84:87], v1 offset:50176
    v_mfma_f32_16x16x32_bf16 v[36:39], v[56:59], v[140:143], v[36:39]
    s_add_u32 m0, s77, 4096
    s_add_u32 s87, s75, 45056
    buffer_load_dwordx4 v4, s[20:23], s87 offen sc1 lds
    s_waitcnt lgkmcnt(6)
    v_mfma_f32_16x16x32_bf16 v[20:23], v[60:63], v[136:139], v[20:23]
    v_mfma_f32_16x16x32_bf16 v[40:43], v[60:63], v[140:143], v[40:43]
    s_waitcnt lgkmcnt(5)
    v_mfma_f32_16x16x32_bf16 v[24:27], v[64:67], v[136:139], v[24:27]
    v_mfma_f32_16x16x32_bf16 v[44:47], v[64:67], v[140:143], v[44:47]
    s_and_b32 s51, s48, 1
    s_mul_i32 s52, s51, 30720
    s_add_u32 s52, s52, 40960
    v_add_u32 v112, s52, v4
    s_lshl_b32 s52, s73, 1
    s_add_u32 s51, s51, s52
    s_lshl_b32 s51, s51, 1
    s_lshr_b32 s52, s48, 2
    s_add_u32 s51, s51, s52
    s_mul_i32 s51, s51, 20480
    s_mul_i32 s52, s74, 160
    s_add_u32 s4, s51, s52
    v_and_b32 v113, 15, v0
    v_mul_u32_u24 v113, 1280, v113
    v_lshrrev_b32 v115, 4, v0
    v_lshl_add_u32 v114, v115, 3, v113
    v_lshl_add_u32 v113, v115, 4, v113
    s_waitcnt lgkmcnt(0)
    s_barrier
    v_mfma_f32_16x16x32_bf16 v[8:11], v[68:71], v[144:147], v[8:11]
    ds_read_b128 v[48:51], v2 offset:0
    v_mfma_f32_16x16x32_bf16 v[28:31], v[68:71], v[148:151], v[28:31]
    s_add_u32 m0, s77, 40960
    s_add_u32 s87, s75, 51200
    buffer_load_dwordx4 v4, s[20:23], s87 offen sc1 lds
    v_mfma_f32_16x16x32_bf16 v[12:15], v[72:75], v[144:147], v[12:15]
    ds_read_b128 v[52:55], v2 offset:1024
    v_mfma_f32_16x16x32_bf16 v[32:35], v[72:75], v[148:151], v[32:35]
    v_mfma_f32_16x16x32_bf16 v[16:19], v[76:79], v[144:147], v[16:19]
    ds_read_b128 v[56:59], v2 offset:2048
    v_mfma_f32_16x16x32_bf16 v[36:39], v[76:79], v[148:151], v[36:39]
    buffer_load_dwordx4 v4, s[20:23], s87 offen offset:1024 sc1 lds
    v_mfma_f32_16x16x32_bf16 v[20:23], v[80:83], v[144:147], v[20:23]
    ds_read_b128 v[60:63], v2 offset:3072
    v_mfma_f32_16x16x32_bf16 v[40:43], v[80:83], v[148:151], v[40:43]
    v_mfma_f32_16x16x32_bf16 v[24:27], v[84:87], v[144:147], v[24:27]
    ds_read_b128 v[64:67], v2 offset:4096
    v_mfma_f32_16x16x32_bf16 v[44:47], v[84:87], v[148:151], v[44:47]
    buffer_load_dwordx4 v4, s[20:23], s87 offen offset:2048 sc1 lds
    s_waitcnt lgkmcnt(4)
    v_mfma_f32_16x16x32_bf16 v[8:11], v[48:51], v[152:155], v[8:11]
    ds_read_b128 v[68:71], v2 offset:5120
    ds_read_b128 v[72:75], v2 offset:6144
    v_mfma_f32_16x16x32_bf16 v[28:31], v[48:51], v[156:159], v[28:31]
    buffer_load_dwordx4 v4, s[20:23], s87 offen offset:3072 sc1 lds
    s_waitcnt lgkmcnt(5)
    v_mfma_f32_16x16x32_bf16 v[12:15], v[52:55], v[152:155], v[12:15]
    ds_read_b128 v[76:79], v2 offset:7168
    ds_read_b128 v[80:83], v2 offset:8192
    v_mfma_f32_16x16x32_bf16 v[32:35], v[52:55], v[156:159], v[32:35]
    s_waitcnt lgkmcnt(6)
    v_mfma_f32_16x16x32_bf16 v[16:19], v[56:59], v[152:155], v[16:19]
    ds_read_b128 v[84:87], v2 offset:9216
    v_mfma_f32_16x16x32_bf16 v[36:39], v[56:59], v[156:159], v[36:39]
    s_add_u32 m0, s77, 45056
    s_add_u32 s87, s75, 55296
    buffer_load_dwordx4 v4, s[20:23], s87 offen sc1 lds
    s_waitcnt lgkmcnt(6)
    v_mfma_f32_16x16x32_bf16 v[20:23], v[60:63], v[152:155], v[20:23]
    v_mfma_f32_16x16x32_bf16 v[40:43], v[60:63], v[156:159], v[40:43]
    s_waitcnt lgkmcnt(5)
    v_mfma_f32_16x16x32_bf16 v[24:27], v[64:67], v[152:155], v[24:27]
    v_mfma_f32_16x16x32_bf16 v[44:47], v[64:67], v[156:159], v[44:47]
    s_add_u32 s78, s76, 12288
    buffer_load_dwordx4 v[216:219], v4, s[20:23], s78 offen sc1
    s_waitcnt vmcnt(11) lgkmcnt(0)
    s_barrier
    v_mfma_f32_16x16x32_bf16 v[8:11], v[68:71], v[160:163], v[8:11]
    ds_read_b128 v[48:51], v2 offset:40960
    v_mfma_f32_16x16x32_bf16 v[28:31], v[68:71], v[164:167], v[28:31]
    s_add_u32 s78, s76, 81920
    buffer_load_dwordx4 v[220:223], v4, s[20:23], s78 offen sc1
    v_mfma_f32_16x16x32_bf16 v[12:15], v[72:75], v[160:163], v[12:15]
    ds_read_b128 v[52:55], v2 offset:41984
    v_mfma_f32_16x16x32_bf16 v[32:35], v[72:75], v[164:167], v[32:35]
    v_mfma_f32_16x16x32_bf16 v[16:19], v[76:79], v[160:163], v[16:19]
    ds_read_b128 v[56:59], v2 offset:43008
    v_mfma_f32_16x16x32_bf16 v[36:39], v[76:79], v[164:167], v[36:39]
    s_add_u32 m0, s77, 81920
    s_add_u32 s87, s75, 61440
    buffer_load_dwordx4 v4, s[20:23], s87 offen sc1 lds
    v_mfma_f32_16x16x32_bf16 v[20:23], v[80:83], v[160:163], v[20:23]
    ds_read_b128 v[60:63], v2 offset:44032
    v_mfma_f32_16x16x32_bf16 v[40:43], v[80:83], v[164:167], v[40:43]
    v_mfma_f32_16x16x32_bf16 v[24:27], v[84:87], v[160:163], v[24:27]
    ds_read_b128 v[64:67], v2 offset:45056
    v_mfma_f32_16x16x32_bf16 v[44:47], v[84:87], v[164:167], v[44:47]
    buffer_load_dwordx4 v4, s[20:23], s87 offen offset:1024 sc1 lds
    s_waitcnt lgkmcnt(4)
    v_mfma_f32_16x16x32_bf16 v[8:11], v[48:51], v[168:171], v[8:11]
    ds_read_b128 v[68:71], v2 offset:46080
    ds_read_b128 v[72:75], v2 offset:47104
    v_mfma_f32_16x16x32_bf16 v[28:31], v[48:51], v[172:175], v[28:31]
    buffer_load_dwordx4 v4, s[20:23], s87 offen offset:2048 sc1 lds
    s_waitcnt lgkmcnt(5)
    v_mfma_f32_16x16x32_bf16 v[12:15], v[52:55], v[168:171], v[12:15]
    ds_read_b128 v[76:79], v2 offset:48128
    ds_read_b128 v[80:83], v2 offset:49152
    v_mfma_f32_16x16x32_bf16 v[32:35], v[52:55], v[172:175], v[32:35]
    s_waitcnt lgkmcnt(6)
    v_mfma_f32_16x16x32_bf16 v[16:19], v[56:59], v[168:171], v[16:19]
    ds_read_b128 v[84:87], v2 offset:50176
    v_mfma_f32_16x16x32_bf16 v[36:39], v[56:59], v[172:175], v[36:39]
    buffer_load_dwordx4 v4, s[20:23], s87 offen offset:3072 sc1 lds
    s_waitcnt lgkmcnt(6)
    v_mfma_f32_16x16x32_bf16 v[20:23], v[60:63], v[168:171], v[20:23]
    v_mfma_f32_16x16x32_bf16 v[40:43], v[60:63], v[172:175], v[40:43]
    s_waitcnt lgkmcnt(5)
    v_mfma_f32_16x16x32_bf16 v[24:27], v[64:67], v[168:171], v[24:27]
    v_mfma_f32_16x16x32_bf16 v[44:47], v[64:67], v[172:175], v[44:47]
    s_add_u32 m0, s77, 86016
    s_add_u32 s87, s75, 65536
    buffer_load_dwordx4 v4, s[20:23], s87 offen sc1 lds
    s_waitcnt vmcnt(12) lgkmcnt(0)
    s_barrier
    v_mfma_f32_16x16x32_bf16 v[8:11], v[68:71], v[176:179], v[8:11]
    ds_read_b128 v[48:51], v1 offset:0
    v_mfma_f32_16x16x32_bf16 v[28:31], v[68:71], v[180:183], v[28:31]
    s_add_u32 s78, s76, 12288
    buffer_load_dwordx4 v[224:227], v4, s[20:23], s78 offen offset:1024 sc1
    v_mfma_f32_16x16x32_bf16 v[12:15], v[72:75], v[176:179], v[12:15]
    ds_read_b128 v[52:55], v1 offset:1024
    v_mfma_f32_16x16x32_bf16 v[32:35], v[72:75], v[180:183], v[32:35]
    v_mfma_f32_16x16x32_bf16 v[16:19], v[76:79], v[176:179], v[16:19]
    ds_read_b128 v[56:59], v1 offset:2048
    v_mfma_f32_16x16x32_bf16 v[36:39], v[76:79], v[180:183], v[36:39]
    s_add_u32 s78, s76, 81920
    buffer_load_dwordx4 v[228:231], v4, s[20:23], s78 offen offset:1024 sc1
    v_mfma_f32_16x16x32_bf16 v[20:23], v[80:83], v[176:179], v[20:23]
    ds_read_b128 v[60:63], v1 offset:3072
    v_mfma_f32_16x16x32_bf16 v[40:43], v[80:83], v[180:183], v[40:43]
    v_mfma_f32_16x16x32_bf16 v[24:27], v[84:87], v[176:179], v[24:27]
    ds_read_b128 v[64:67], v1 offset:4096
    v_mfma_f32_16x16x32_bf16 v[44:47], v[84:87], v[180:183], v[44:47]
    s_add_u32 m0, s77, 122880
    s_add_u32 s87, s75, 71680
    buffer_load_dwordx4 v4, s[20:23], s87 offen sc1 lds
    s_waitcnt lgkmcnt(4)
    v_mfma_f32_16x16x32_bf16 v[8:11], v[48:51], v[184:187], v[8:11]
    ds_read_b128 v[68:71], v1 offset:5120
    ds_read_b128 v[72:75], v1 offset:6144
    v_mfma_f32_16x16x32_bf16 v[28:31], v[48:51], v[188:191], v[28:31]
    buffer_load_dwordx4 v4, s[20:23], s87 offen offset:1024 sc1 lds
    s_waitcnt lgkmcnt(5)
    v_mfma_f32_16x16x32_bf16 v[12:15], v[52:55], v[184:187], v[12:15]
    ds_read_b128 v[76:79], v1 offset:7168
    ds_read_b128 v[80:83], v1 offset:8192
    v_mfma_f32_16x16x32_bf16 v[32:35], v[52:55], v[188:191], v[32:35]
    s_waitcnt lgkmcnt(6)
    v_mfma_f32_16x16x32_bf16 v[16:19], v[56:59], v[184:187], v[16:19]
    ds_read_b128 v[84:87], v1 offset:9216
    v_mfma_f32_16x16x32_bf16 v[36:39], v[56:59], v[188:191], v[36:39]
    buffer_load_dwordx4 v4, s[20:23], s87 offen offset:2048 sc1 lds
    s_waitcnt lgkmcnt(6)
    v_mfma_f32_16x16x32_bf16 v[20:23], v[60:63], v[184:187], v[20:23]
    v_mfma_f32_16x16x32_bf16 v[40:43], v[60:63], v[188:191], v[40:43]
    s_waitcnt lgkmcnt(5)
    v_mfma_f32_16x16x32_bf16 v[24:27], v[64:67], v[184:187], v[24:27]
    v_mfma_f32_16x16x32_bf16 v[44:47], v[64:67], v[188:191], v[44:47]
    buffer_load_dwordx4 v4, s[20:23], s87 offen offset:3072 sc1 lds
    s_waitcnt vmcnt(13) lgkmcnt(0)
    s_barrier
    v_mfma_f32_16x16x32_bf16 v[8:11], v[68:71], v[192:195], v[8:11]
    ds_read_b128 v[48:51], v1 offset:40960
    v_mfma_f32_16x16x32_bf16 v[28:31], v[68:71], v[196:199], v[28:31]
    s_add_u32 m0, s77, 126976
    s_add_u32 s87, s75, 75776
    buffer_load_dwordx4 v4, s[20:23], s87 offen sc1 lds
    v_mfma_f32_16x16x32_bf16 v[12:15], v[72:75], v[192:195], v[12:15]
    ds_read_b128 v[52:55], v1 offset:41984
    v_mfma_f32_16x16x32_bf16 v[32:35], v[72:75], v[196:199], v[32:35]
    v_mfma_f32_16x16x32_bf16 v[16:19], v[76:79], v[192:195], v[16:19]
    ds_read_b128 v[56:59], v1 offset:43008
    v_mfma_f32_16x16x32_bf16 v[36:39], v[76:79], v[196:199], v[36:39]
    s_add_u32 s78, s76, 12288
    buffer_load_dwordx4 v[232:235], v4, s[20:23], s78 offen offset:2048 sc1
    v_mfma_f32_16x16x32_bf16 v[20:23], v[80:83], v[192:195], v[20:23]
    ds_read_b128 v[60:63], v1 offset:44032
    v_mfma_f32_16x16x32_bf16 v[40:43], v[80:83], v[196:199], v[40:43]
    v_mfma_f32_16x16x32_bf16 v[24:27], v[84:87], v[192:195], v[24:27]
    ds_read_b128 v[64:67], v1 offset:45056
    v_mfma_f32_16x16x32_bf16 v[44:47], v[84:87], v[196:199], v[44:47]
    s_add_u32 s78, s76, 81920
    buffer_load_dwordx4 v[236:239], v4, s[20:23], s78 offen offset:2048 sc1
    s_waitcnt lgkmcnt(4)
    v_mfma_f32_16x16x32_bf16 v[8:11], v[48:51], v[200:203], v[8:11]
    ds_read_b128 v[68:71], v1 offset:46080
    ds_read_b128 v[72:75], v1 offset:47104
    v_mfma_f32_16x16x32_bf16 v[28:31], v[48:51], v[204:207], v[28:31]
    s_bitcmp1_b32 s48, 0
    s_cbranch_scc1 L_nod_123
    s_add_u32 m0, s77, 0
    s_add_u32 s87, s75, 81920
    buffer_load_dwordx4 v4, s[20:23], s87 offen sc1 lds
    buffer_load_dwordx4 v4, s[20:23], s87 offen offset:1024 sc1 lds
    buffer_load_dwordx4 v4, s[20:23], s87 offen offset:2048 sc1 lds
    buffer_load_dwordx4 v4, s[20:23], s87 offen offset:3072 sc1 lds
    s_add_u32 m0, s77, 4096
    s_add_u32 s87, s75, 86016
    buffer_load_dwordx4 v4, s[20:23], s87 offen sc1 lds
L_nod_123:
    s_waitcnt lgkmcnt(5)
    v_mfma_f32_16x16x32_bf16 v[12:15], v[52:55], v[200:203], v[12:15]
    ds_read_b128 v[76:79], v1 offset:48128
    ds_read_b128 v[80:83], v1 offset:49152
    v_mfma_f32_16x16x32_bf16 v[32:35], v[52:55], v[204:207], v[32:35]
    s_waitcnt lgkmcnt(6)
    v_mfma_f32_16x16x32_bf16 v[16:19], v[56:59], v[200:203], v[16:19]
    ds_read_b128 v[84:87], v1 offset:50176
    v_mfma_f32_16x16x32_bf16 v[36:39], v[56:59], v[204:207], v[36:39]
    s_add_u32 s78, s76, 12288
    buffer_load_dwordx4 v[240:243], v4, s[20:23], s78 offen offset:3072 sc1
    s_waitcnt lgkmcnt(6)
    v_mfma_f32_16x16x32_bf16 v[20:23], v[60:63], v[200:203], v[20:23]
    v_mfma_f32_16x16x32_bf16 v[40:43], v[60:63], v[204:207], v[40:43]
    s_waitcnt lgkmcnt(5)
    v_mfma_f32_16x16x32_bf16 v[24:27], v[64:67], v[200:203], v[24:27]
    v_mfma_f32_16x16x32_bf16 v[44:47], v[64:67], v[204:207], v[44:47]
    s_add_u32 s78, s76, 81920
    buffer_load_dwordx4 v[244:247], v4, s[20:23], s78 offen offset:3072 sc1
    s_waitcnt vmcnt(11) lgkmcnt(0)
    s_barrier
    v_mfma_f32_16x16x32_bf16 v[8:11], v[68:71], v[208:211], v[8:11]
    ds_read_b128 v[48:51], v2 offset:0
    v_mfma_f32_16x16x32_bf16 v[28:31], v[68:71], v[212:215], v[28:31]
    s_add_u32 s78, s76, 16384
    buffer_load_dwordx4 v[248:251], v4, s[20:23], s78 offen sc1
    v_mfma_f32_16x16x32_bf16 v[12:15], v[72:75], v[208:211], v[12:15]
    ds_read_b128 v[52:55], v2 offset:1024
    v_mfma_f32_16x16x32_bf16 v[32:35], v[72:75], v[212:215], v[32:35]
    v_mfma_f32_16x16x32_bf16 v[16:19], v[76:79], v[208:211], v[16:19]
    ds_read_b128 v[56:59], v2 offset:2048
    v_mfma_f32_16x16x32_bf16 v[36:39], v[76:79], v[212:215], v[36:39]
    s_add_u32 s78, s76, 86016
    buffer_load_dwordx4 v[252:255], v4, s[20:23], s78 offen sc1
    v_mfma_f32_16x16x32_bf16 v[20:23], v[80:83], v[208:211], v[20:23]
    ds_read_b128 v[60:63], v2 offset:3072
    v_mfma_f32_16x16x32_bf16 v[40:43], v[80:83], v[212:215], v[40:43]
    v_mfma_f32_16x16x32_bf16 v[24:27], v[84:87], v[208:211], v[24:27]
    ds_read_b128 v[64:67], v2 offset:4096
    v_mfma_f32_16x16x32_bf16 v[44:47], v[84:87], v[212:215], v[44:47]
    s_nop 4
    v_mul_f32 v8, v108, v8
    v_mul_f32 v9, v108, v9
    v_mul_f32 v10, v108, v10
    v_mul_f32 v11, v108, v11
    v_mul_f32 v28, v109, v28
    v_mul_f32 v29, v109, v29
    v_mul_f32 v30, v109, v30
    v_mul_f32 v31, v109, v31
    v_mul_f32 v12, v108, v12
    v_mul_f32 v13, v108, v13
    v_mul_f32 v14, v108, v14
    v_mul_f32 v15, v108, v15
    v_mul_f32 v32, v109, v32
    v_mul_f32 v33, v109, v33
    v_mul_f32 v34, v109, v34
    v_mul_f32 v35, v109, v35
    v_mul_f32 v16, v108, v16
    v_mul_f32 v17, v108, v17
    v_mul_f32 v18, v108, v18
    v_mul_f32 v19, v108, v19
    v_mul_f32 v36, v109, v36
    v_mul_f32 v37, v109, v37
    v_mul_f32 v38, v109, v38
    v_mul_f32 v39, v109, v39
    v_mul_f32 v20, v108, v20
    v_mul_f32 v21, v108, v21
    v_mul_f32 v22, v108, v22
    v_mul_f32 v23, v108, v23
    v_mul_f32 v40, v109, v40
    v_mul_f32 v41, v109, v41
    v_mul_f32 v42, v109, v42
    v_mul_f32 v43, v109, v43
    v_mul_f32 v24, v108, v24
    v_mul_f32 v25, v108, v25
    v_mul_f32 v26, v108, v26
    v_mul_f32 v27, v108, v27
    v_mul_f32 v44, v109, v44
    v_mul_f32 v45, v109, v45
    v_mul_f32 v46, v109, v46
    v_mul_f32 v47, v109, v47
L_ospin_124:
    v_max_u32 v3, v216, v218
    v_max3_u32 v3, v220, v222, v3
    v_cmp_eq_u32 vcc, -1, v3
    s_cbranch_vccz L_ogot_125
    s_add_u32 s96, s96, 1
    s_cmp_gt_u32 s96, 0x100000
    s_cbranch_scc1 L_ogot_125
    s_add_u32 s56, s76, 12288
    buffer_load_dwordx4 v[216:219], v4, s[20:23], s56 offen sc1
    s_add_u32 s56, s76, 81920
    buffer_load_dwordx4 v[220:223], v4, s[20:23], s56 offen sc1
    s_waitcnt vmcnt(0)
    s_branch L_ospin_124
L_ogot_125:
    s_waitcnt lgkmcnt(4)
    v_mfma_f32_16x16x32_bf16 v[8:11], v[48:51], v[216:219], v[8:11]
    ds_read_b128 v[68:71], v2 offset:5120
    ds_read_b128 v[72:75], v2 offset:6144
    v_mfma_f32_16x16x32_bf16 v[28:31], v[48:51], v[220:223], v[28:31]
    s_waitcnt lgkmcnt(5)
    v_mfma_f32_16x16x32_bf16 v[12:15], v[52:55], v[216:219], v[12:15]
    ds_read_b128 v[76:79], v2 offset:7168
    ds_read_b128 v[80:83], v2 offset:8192
    v_mfma_f32_16x16x32_bf16 v[32:35], v[52:55], v[220:223], v[32:35]
    s_waitcnt lgkmcnt(6)
    v_mfma_f32_16x16x32_bf16 v[16:19], v[56:59], v[216:219], v[16:19]
    ds_read_b128 v[84:87], v2 offset:9216
    v_mfma_f32_16x16x32_bf16 v[36:39], v[56:59], v[220:223], v[36:39]
    s_waitcnt lgkmcnt(6)
    v_mfma_f32_16x16x32_bf16 v[20:23], v[60:63], v[216:219], v[20:23]
    v_mfma_f32_16x16x32_bf16 v[40:43], v[60:63], v[220:223], v[40:43]
    s_waitcnt lgkmcnt(5)
    v_mfma_f32_16x16x32_bf16 v[24:27], v[64:67], v[216:219], v[24:27]
    v_mfma_f32_16x16x32_bf16 v[44:47], v[64:67], v[220:223], v[44:47]
    s_waitcnt vmcnt(6) lgkmcnt(0)
    s_barrier
L_ospin_126:
    v_max_u32 v3, v224, v226
    v_max3_u32 v3, v228, v230, v3
    v_cmp_eq_u32 vcc, -1, v3
    s_cbranch_vccz L_ogot_127
    s_add_u32 s96, s96, 1
    s_cmp_gt_u32 s96, 0x100000
    s_cbranch_scc1 L_ogot_127
    s_add_u32 s56, s76, 12288
    buffer_load_dwordx4 v[224:227], v4, s[20:23], s56 offen offset:1024 sc1
    s_add_u32 s56, s76, 81920
    buffer_load_dwordx4 v[228:231], v4, s[20:23], s56 offen offset:1024 sc1
    s_waitcnt vmcnt(0)
    s_branch L_ospin_126
L_ogot_127:
    v_mfma_f32_16x16x32_bf16 v[8:11], v[68:71], v[224:227], v[8:11]
    ds_read_b128 v[48:51], v2 offset:40960
    v_mfma_f32_16x16x32_bf16 v[28:31], v[68:71], v[228:231], v[28:31]
    v_mfma_f32_16x16x32_bf16 v[12:15], v[72:75], v[224:227], v[12:15]
    ds_read_b128 v[52:55], v2 offset:41984
    v_mfma_f32_16x16x32_bf16 v[32:35], v[72:75], v[228:231], v[32:35]
    v_mfma_f32_16x16x32_bf16 v[16:19], v[76:79], v[224:227], v[16:19]
    ds_read_b128 v[56:59], v2 offset:43008
    v_mfma_f32_16x16x32_bf16 v[36:39], v[76:79], v[228:231], v[36:39]
    v_mfma_f32_16x16x32_bf16 v[20:23], v[80:83], v[224:227], v[20:23]
    ds_read_b128 v[60:63], v2 offset:44032
    v_mfma_f32_16x16x32_bf16 v[40:43], v[80:83], v[228:231], v[40:43]
    v_mfma_f32_16x16x32_bf16 v[24:27], v[84:87], v[224:227], v[24:27]
    ds_read_b128 v[64:67], v2 offset:45056
    v_mfma_f32_16x16x32_bf16 v[44:47], v[84:87], v[228:231], v[44:47]
    s_waitcnt vmcnt(4)
L_ospin_128:
    v_max_u32 v3, v232, v234
    v_max3_u32 v3, v236, v238, v3
    v_cmp_eq_u32 vcc, -1, v3
    s_cbranch_vccz L_ogot_129
    s_add_u32 s96, s96, 1
    s_cmp_gt_u32 s96, 0x100000
    s_cbranch_scc1 L_ogot_129
    s_add_u32 s56, s76, 12288
    buffer_load_dwordx4 v[232:235], v4, s[20:23], s56 offen offset:2048 sc1
    s_add_u32 s56, s76, 81920
    buffer_load_dwordx4 v[236:239], v4, s[20:23], s56 offen offset:2048 sc1
    s_waitcnt vmcnt(0)
    s_branch L_ospin_128
L_ogot_129:
    s_waitcnt lgkmcnt(4)
    v_mfma_f32_16x16x32_bf16 v[8:11], v[48:51], v[232:235], v[8:11]
    ds_read_b128 v[68:71], v2 offset:46080
    ds_read_b128 v[72:75], v2 offset:47104
    v_mfma_f32_16x16x32_bf16 v[28:31], v[48:51], v[236:239], v[28:31]
    s_waitcnt lgkmcnt(5)
    v_mfma_f32_16x16x32_bf16 v[12:15], v[52:55], v[232:235], v[12:15]
    ds_read_b128 v[76:79], v2 offset:48128
    ds_read_b128 v[80:83], v2 offset:49152
    v_mfma_f32_16x16x32_bf16 v[32:35], v[52:55], v[236:239], v[32:35]
    s_waitcnt lgkmcnt(6)
    v_mfma_f32_16x16x32_bf16 v[16:19], v[56:59], v[232:235], v[16:19]
    ds_read_b128 v[84:87], v2 offset:50176
    v_mfma_f32_16x16x32_bf16 v[36:39], v[56:59], v[236:239], v[36:39]
    s_waitcnt lgkmcnt(6)
    v_mfma_f32_16x16x32_bf16 v[20:23], v[60:63], v[232:235], v[20:23]
    v_mfma_f32_16x16x32_bf16 v[40:43], v[60:63], v[236:239], v[40:43]
    s_waitcnt lgkmcnt(5)
    v_mfma_f32_16x16x32_bf16 v[24:27], v[64:67], v[232:235], v[24:27]
    v_mfma_f32_16x16x32_bf16 v[44:47], v[64:67], v[236:239], v[44:47]
    s_waitcnt vmcnt(4) lgkmcnt(0)
    s_barrier
    s_waitcnt vmcnt(2)
L_ospin_130:
    v_max_u32 v3, v240, v242
    v_max3_u32 v3, v244, v246, v3
    v_cmp_eq_u32 vcc, -1, v3
    s_cbranch_vccz L_ogot_131
    s_add_u32 s96, s96, 1
    s_cmp_gt_u32 s96, 0x100000
    s_cbranch_scc1 L_ogot_131
    s_add_u32 s56, s76, 12288
    buffer_load_dwordx4 v[240:243], v4, s[20:23], s56 offen offset:3072 sc1
    s_add_u32 s56, s76, 81920
    buffer_load_dwordx4 v[244:247], v4, s[20:23], s56 offen offset:3072 sc1
    s_waitcnt vmcnt(0)
    s_branch L_ospin_130
L_ogot_131:
    v_mfma_f32_16x16x32_bf16 v[8:11], v[68:71], v[240:243], v[8:11]
    ds_read_b128 v[48:51], v1 offset:0
    v_mfma_f32_16x16x32_bf16 v[28:31], v[68:71], v[244:247], v[28:31]
    v_mfma_f32_16x16x32_bf16 v[12:15], v[72:75], v[240:243], v[12:15]
    ds_read_b128 v[52:55], v1 offset:1024
    v_mfma_f32_16x16x32_bf16 v[32:35], v[72:75], v[244:247], v[32:35]
    v_mfma_f32_16x16x32_bf16 v[16:19], v[76:79], v[240:243], v[16:19]
    ds_read_b128 v[56:59], v1 offset:2048
    v_mfma_f32_16x16x32_bf16 v[36:39], v[76:79], v[244:247], v[36:39]
    v_mfma_f32_16x16x32_bf16 v[20:23], v[80:83], v[240:243], v[20:23]
    ds_read_b128 v[60:63], v1 offset:3072
    v_mfma_f32_16x16x32_bf16 v[40:43], v[80:83], v[244:247], v[40:43]
    v_mfma_f32_16x16x32_bf16 v[24:27], v[84:87], v[240:243], v[24:27]
    ds_read_b128 v[64:67], v1 offset:4096
    v_mfma_f32_16x16x32_bf16 v[44:47], v[84:87], v[244:247], v[44:47]
    s_waitcnt vmcnt(0)
L_ospin_132:
    v_max_u32 v3, v248, v250
    v_max3_u32 v3, v252, v254, v3
    v_cmp_eq_u32 vcc, -1, v3
    s_cbranch_vccz L_ogot_133
    s_add_u32 s96, s96, 1
    s_cmp_gt_u32 s96, 0x100000
    s_cbranch_scc1 L_ogot_133
    s_add_u32 s56, s76, 16384
    buffer_load_dwordx4 v[248:251], v4, s[20:23], s56 offen sc1
    s_add_u32 s56, s76, 86016
    buffer_load_dwordx4 v[252:255], v4, s[20:23], s56 offen sc1
    s_waitcnt vmcnt(0)
    s_branch L_ospin_132
L_ogot_133:
    s_lshr_b32 s52, s48, 1
    s_cmp_eq_u32 s52, 1
    s_cbranch_scc1 L_mix_136
    s_cmp_eq_u32 s52, 2
    s_cbranch_scc1 L_mix_137
    s_cmp_eq_u32 s52, 3
    s_cbranch_scc1 L_mix_138
L_mix_135:
    s_waitcnt lgkmcnt(4)
    v_mfma_f32_16x16x32_bf16 v[28:31], v[48:51], v[252:255], v[28:31]
    s_waitcnt lgkmcnt(3)
    v_mfma_f32_16x16x32_bf16 v[32:35], v[52:55], v[252:255], v[32:35]
    s_waitcnt lgkmcnt(2)
    v_mfma_f32_16x16x32_bf16 v[16:19], v[56:59], v[248:251], v[16:19]
    v_mfma_f32_16x16x32_bf16 v[36:39], v[56:59], v[252:255], v[36:39]
    s_waitcnt lgkmcnt(1)
    v_mfma_f32_16x16x32_bf16 v[20:23], v[60:63], v[248:251], v[20:23]
    v_mfma_f32_16x16x32_bf16 v[40:43], v[60:63], v[252:255], v[40:43]
    s_waitcnt lgkmcnt(0)
    v_mfma_f32_16x16x32_bf16 v[44:47], v[64:67], v[252:255], v[44:47]
    v_mfma_f32_16x16x32_bf16 v[8:11], v[48:51], v[248:251], v[8:11]
    v_mfma_f32_16x16x32_bf16 v[12:15], v[52:55], v[248:251], v[12:15]
    ds_write_b128 v112, v[28:31] offset:15360
    v_mfma_f32_16x16x32_bf16 v[24:27], v[64:67], v[248:251], v[24:27]
    ds_write_b128 v112, v[32:35] offset:18432
    ds_write_b128 v112, v[16:19] offset:6144
    ds_write_b128 v112, v[36:39] offset:21504
    ds_write_b128 v112, v[20:23] offset:9216
    ds_write_b128 v112, v[40:43] offset:24576
    ds_write_b128 v112, v[44:47] offset:27648
    s_waitcnt lgkmcnt(0)
    s_barrier
    ds_read_b128 v[48:51], v112 offset:0
    ds_read_b128 v[52:55], v112 offset:1024
    ds_read_b128 v[56:59], v112 offset:2048
    ds_read_b128 v[60:63], v112 offset:3072
    ds_read_b128 v[64:67], v112 offset:4096
    ds_read_b128 v[68:71], v112 offset:5120
    ds_read_b128 v[72:75], v112 offset:12288
    ds_read_b128 v[76:79], v112 offset:13312
    ds_read_b128 v[80:83], v112 offset:14336
    s_waitcnt lgkmcnt(6)
    v_add_f32 v48, v48, v52
    v_add_f32 v8, v8, v56
    v_add_f32 v49, v49, v53
    v_add_f32 v9, v9, v57
    v_add_f32 v50, v50, v54
    v_add_f32 v10, v10, v58
    v_add_f32 v51, v51, v55
    v_add_f32 v11, v11, v59
    v_add_f32 v8, v8, v48
    v_add_f32 v9, v9, v49
    v_add_f32 v10, v10, v50
    v_add_f32 v11, v11, v51
    v_cvt_pk_bf16_f32 v100, v8, v9
    v_cvt_pk_bf16_f32 v101, v10, v11
    s_waitcnt lgkmcnt(3)
    v_add_f32 v60, v60, v64
    v_add_f32 v12, v12, v68
    v_add_f32 v61, v61, v65
    v_add_f32 v13, v13, v69
    v_add_f32 v62, v62, v66
    v_add_f32 v14, v14, v70
    v_add_f32 v63, v63, v67
    v_add_f32 v15, v15, v71
    v_add_f32 v12, v12, v60
    v_add_f32 v13, v13, v61
    v_add_f32 v14, v14, v62
    v_add_f32 v15, v15, v63
    v_cvt_pk_bf16_f32 v102, v12, v13
    v_cvt_pk_bf16_f32 v103, v14, v15
    buffer_store_dwordx4 v[100:103], v113, s[24:27], s4 offen offset:0
    s_waitcnt lgkmcnt(0)
    v_add_f32 v72, v72, v76
    v_add_f32 v24, v24, v80
    v_add_f32 v73, v73, v77
    v_add_f32 v25, v25, v81
    v_add_f32 v74, v74, v78
    v_add_f32 v26, v26, v82
    v_add_f32 v75, v75, v79
    v_add_f32 v27, v27, v83
    v_add_f32 v24, v24, v72
    v_add_f32 v25, v25, v73
    v_add_f32 v26, v26, v74
    v_add_f32 v27, v27, v75
    v_cvt_pk_bf16_f32 v104, v24, v25
    v_cvt_pk_bf16_f32 v105, v26, v27
    buffer_store_dwordx2 v[104:105], v114, s[24:27], s4 offen offset:128
    s_branch L_mixE_134
L_mix_136:
    s_waitcnt lgkmcnt(4)
    v_mfma_f32_16x16x32_bf16 v[8:11], v[48:51], v[248:251], v[8:11]
    v_mfma_f32_16x16x32_bf16 v[28:31], v[48:51], v[252:255], v[28:31]
    s_waitcnt lgkmcnt(3)
    v_mfma_f32_16x16x32_bf16 v[12:15], v[52:55], v[248:251], v[12:15]
    v_mfma_f32_16x16x32_bf16 v[32:35], v[52:55], v[252:255], v[32:35]
    s_waitcnt lgkmcnt(2)
    v_mfma_f32_16x16x32_bf16 v[36:39], v[56:59], v[252:255], v[36:39]
    s_waitcnt lgkmcnt(1)
    v_mfma_f32_16x16x32_bf16 v[40:43], v[60:63], v[252:255], v[40:43]
    s_waitcnt lgkmcnt(0)
    v_mfma_f32_16x16x32_bf16 v[24:27], v[64:67], v[248:251], v[24:27]
    v_mfma_f32_16x16x32_bf16 v[44:47], v[64:67], v[252:255], v[44:47]
    v_mfma_f32_16x16x32_bf16 v[16:19], v[56:59], v[248:251], v[16:19]
    ds_write_b128 v112, v[8:11] offset:0
    v_mfma_f32_16x16x32_bf16 v[20:23], v[60:63], v[248:251], v[20:23]
    ds_write_b128 v112, v[28:31] offset:16384
    ds_write_b128 v112, v[12:15] offset:3072
    ds_write_b128 v112, v[32:35] offset:19456
    ds_write_b128 v112, v[36:39] offset:22528
    ds_write_b128 v112, v[40:43] offset:25600
    ds_write_b128 v112, v[24:27] offset:12288
    ds_write_b128 v112, v[44:47] offset:28672
    s_waitcnt lgkmcnt(0)
    s_barrier
    ds_read_b128 v[48:51], v112 offset:6144
    ds_read_b128 v[52:55], v112 offset:7168
    ds_read_b128 v[56:59], v112 offset:8192
    ds_read_b128 v[60:63], v112 offset:9216
    ds_read_b128 v[64:67], v112 offset:10240
    ds_read_b128 v[68:71], v112 offset:11264
    s_waitcnt lgkmcnt(3)
    v_add_f32 v48, v48, v52
    v_add_f32 v16, v16, v56
    v_add_f32 v49, v49, v53
    v_add_f32 v17, v17, v57
    v_add_f32 v50, v50, v54
    v_add_f32 v18, v18, v58
    v_add_f32 v51, v51, v55
    v_add_f32 v19, v19, v59
    v_add_f32 v16, v16, v48
    v_add_f32 v17, v17, v49
    v_add_f32 v18, v18, v50
    v_add_f32 v19, v19, v51
    v_cvt_pk_bf16_f32 v100, v16, v17
    v_cvt_pk_bf16_f32 v101, v18, v19
    s_waitcnt lgkmcnt(0)
    v_add_f32 v60, v60, v64
    v_add_f32 v20, v20, v68
    v_add_f32 v61, v61, v65
    v_add_f32 v21, v21, v69
    v_add_f32 v62, v62, v66
    v_add_f32 v22, v22, v70
    v_add_f32 v63, v63, v67
    v_add_f32 v23, v23, v71
    v_add_f32 v20, v20, v60
    v_add_f32 v21, v21, v61
    v_add_f32 v22, v22, v62
    v_add_f32 v23, v23, v63
    v_cvt_pk_bf16_f32 v102, v20, v21
    v_cvt_pk_bf16_f32 v103, v22, v23
    buffer_store_dwordx4 v[100:103], v113, s[24:27], s4 offen offset:64
    s_branch L_mixE_134
L_mix_137:
    s_waitcnt lgkmcnt(4)
    v_mfma_f32_16x16x32_bf16 v[8:11], v[48:51], v[248:251], v[8:11]
    s_waitcnt lgkmcnt(3)
    v_mfma_f32_16x16x32_bf16 v[12:15], v[52:55], v[248:251], v[12:15]
    s_waitcnt lgkmcnt(2)
    v_mfma_f32_16x16x32_bf16 v[16:19], v[56:59], v[248:251], v[16:19]
    v_mfma_f32_16x16x32_bf16 v[36:39], v[56:59], v[252:255], v[36:39]
    s_waitcnt lgkmcnt(1)
    v_mfma_f32_16x16x32_bf16 v[20:23], v[60:63], v[248:251], v[20:23]
    v_mfma_f32_16x16x32_bf16 v[40:43], v[60:63], v[252:255], v[40:43]
    s_waitcnt lgkmcnt(0)
    v_mfma_f32_16x16x32_bf16 v[24:27], v[64:67], v[248:251], v[24:27]
    v_mfma_f32_16x16x32_bf16 v[28:31], v[48:51], v[252:255], v[28:31]
    v_mfma_f32_16x16x32_bf16 v[32:35], v[52:55], v[252:255], v[32:35]
    ds_write_b128 v112, v[8:11] offset:1024
    v_mfma_f32_16x16x32_bf16 v[44:47], v[64:67], v[252:255], v[44:47]
    ds_write_b128 v112, v[12:15] offset:4096
    ds_write_b128 v112, v[16:19] offset:7168
    ds_write_b128 v112, v[36:39] offset:23552
    ds_write_b128 v112, v[20:23] offset:10240
    ds_write_b128 v112, v[40:43] offset:26624
    ds_write_b128 v112, v[24:27] offset:13312
    s_waitcnt lgkmcnt(0)
    s_barrier
    ds_read_b128 v[48:51], v112 offset:15360
    ds_read_b128 v[52:55], v112 offset:16384
    ds_read_b128 v[56:59], v112 offset:17408
    ds_read_b128 v[60:63], v112 offset:18432
    ds_read_b128 v[64:67], v112 offset:19456
    ds_read_b128 v[68:71], v112 offset:20480
    ds_read_b128 v[72:75], v112 offset:27648
    ds_read_b128 v[76:79], v112 offset:28672
    ds_read_b128 v[80:83], v112 offset:29696
    s_waitcnt lgkmcnt(6)
    v_add_f32 v48, v48, v52
    v_add_f32 v28, v28, v56
    v_add_f32 v49, v49, v53
    v_add_f32 v29, v29, v57
    v_add_f32 v50, v50, v54
    v_add_f32 v30, v30, v58
    v_add_f32 v51, v51, v55
    v_add_f32 v31, v31, v59
    v_add_f32 v28, v28, v48
    v_add_f32 v29, v29, v49
    v_add_f32 v30, v30, v50
    v_add_f32 v31, v31, v51
    v_cvt_pk_bf16_f32 v100, v28, v29
    v_cvt_pk_bf16_f32 v101, v30, v31
    s_waitcnt lgkmcnt(3)
    v_add_f32 v60, v60, v64
    v_add_f32 v32, v32, v68
    v_add_f32 v61, v61, v65
    v_add_f32 v33, v33, v69
    v_add_f32 v62, v62, v66
    v_add_f32 v34, v34, v70
    v_add_f32 v63, v63, v67
    v_add_f32 v35, v35, v71
    v_add_f32 v32, v32, v60
    v_add_f32 v33, v33, v61
    v_add_f32 v34, v34, v62
    v_add_f32 v35, v35, v63
    v_cvt_pk_bf16_f32 v102, v32, v33
    v_cvt_pk_bf16_f32 v103, v34, v35
    buffer_store_dwordx4 v[100:103], v113, s[24:27], s4 offen offset:0
    s_waitcnt lgkmcnt(0)
    v_add_f32 v72, v72, v76
    v_add_f32 v44, v44, v80
    v_add_f32 v73, v73, v77
    v_add_f32 v45, v45, v81
    v_add_f32 v74, v74, v78
    v_add_f32 v46, v46, v82
    v_add_f32 v75, v75, v79
    v_add_f32 v47, v47, v83
    v_add_f32 v44, v44, v72
    v_add_f32 v45, v45, v73
    v_add_f32 v46, v46, v74
    v_add_f32 v47, v47, v75
    v_cvt_pk_bf16_f32 v104, v44, v45
    v_cvt_pk_bf16_f32 v105, v46, v47
    buffer_store_dwordx2 v[104:105], v114, s[24:27], s4 offen offset:128
    s_branch L_mixE_134
L_mix_138:
    s_waitcnt lgkmcnt(4)
    v_mfma_f32_16x16x32_bf16 v[8:11], v[48:51], v[248:251], v[8:11]
    v_mfma_f32_16x16x32_bf16 v[28:31], v[48:51], v[252:255], v[28:31]
    s_waitcnt lgkmcnt(3)
    v_mfma_f32_16x16x32_bf16 v[12:15], v[52:55], v[248:251], v[12:15]
    v_mfma_f32_16x16x32_bf16 v[32:35], v[52:55], v[252:255], v[32:35]
    s_waitcnt lgkmcnt(2)
    v_mfma_f32_16x16x32_bf16 v[16:19], v[56:59], v[248:251], v[16:19]
    s_waitcnt lgkmcnt(1)
    v_mfma_f32_16x16x32_bf16 v[20:23], v[60:63], v[248:251], v[20:23]
    s_waitcnt lgkmcnt(0)
    v_mfma_f32_16x16x32_bf16 v[24:27], v[64:67], v[248:251], v[24:27]
    v_mfma_f32_16x16x32_bf16 v[44:47], v[64:67], v[252:255], v[44:47]
    v_mfma_f32_16x16x32_bf16 v[36:39], v[56:59], v[252:255], v[36:39]
    ds_write_b128 v112, v[8:11] offset:2048
    v_mfma_f32_16x16x32_bf16 v[40:43], v[60:63], v[252:255], v[40:43]
    ds_write_b128 v112, v[28:31] offset:17408
    ds_write_b128 v112, v[12:15] offset:5120
    ds_write_b128 v112, v[32:35] offset:20480
    ds_write_b128 v112, v[16:19] offset:8192
    ds_write_b128 v112, v[20:23] offset:11264
    ds_write_b128 v112, v[24:27] offset:14336
    ds_write_b128 v112, v[44:47] offset:29696
    s_waitcnt lgkmcnt(0)
    s_barrier
    ds_read_b128 v[48:51], v112 offset:21504
    ds_read_b128 v[52:55], v112 offset:22528
    ds_read_b128 v[56:59], v112 offset:23552
    ds_read_b128 v[60:63], v112 offset:24576
    ds_read_b128 v[64:67], v112 offset:25600
    ds_read_b128 v[68:71], v112 offset:26624
    s_waitcnt lgkmcnt(3)
    v_add_f32 v48, v48, v52
    v_add_f32 v36, v36, v56
    v_add_f32 v49, v49, v53
    v_add_f32 v37, v37, v57
    v_add_f32 v50, v50, v54
    v_add_f32 v38, v38, v58
    v_add_f32 v51, v51, v55
    v_add_f32 v39, v39, v59
    v_add_f32 v36, v36, v48
    v_add_f32 v37, v37, v49
    v_add_f32 v38, v38, v50
    v_add_f32 v39, v39, v51
    v_cvt_pk_bf16_f32 v100, v36, v37
    v_cvt_pk_bf16_f32 v101, v38, v39
    s_waitcnt lgkmcnt(0)
    v_add_f32 v60, v60, v64
    v_add_f32 v40, v40, v68
    v_add_f32 v61, v61, v65
    v_add_f32 v41, v41, v69
    v_add_f32 v62, v62, v66
    v_add_f32 v42, v42, v70
    v_add_f32 v63, v63, v67
    v_add_f32 v43, v43, v71
    v_add_f32 v40, v40, v60
    v_add_f32 v41, v41, v61
    v_add_f32 v42, v42, v62
    v_add_f32 v43, v43, v63
    v_cvt_pk_bf16_f32 v102, v40, v41
    v_cvt_pk_bf16_f32 v103, v42, v43
    buffer_store_dwordx4 v[100:103], v113, s[24:27], s4 offen offset:64
L_mixE_134:
L_exit:
    s_endpgm
.section .rodata,"a"
.p2align 6
.amdhsa_kernel gated_mix__softmax_full_mha__dense_activation_squared_relu__prompt_kernel
.amdhsa_next_free_vgpr 256
.amdhsa_next_free_sgpr 102
.amdhsa_accum_offset 256
.amdhsa_group_segment_fixed_size 0
.amdhsa_kernarg_size 96
.amdhsa_user_sgpr_count 2
.amdhsa_user_sgpr_kernarg_segment_ptr 1
.amdhsa_system_sgpr_workgroup_id_x 1
.end_amdhsa_kernel
```
